```python
import torch

def _softmax(x, axis=-1):
    return torch.softmax(x, dim=axis)

def _gelu(x):
    return torch.nn.functional.gelu(x, approximate='tanh')

def _silu(x):
    return torch.nn.functional.silu(x)

def _sigmoid(x):
    return torch.sigmoid(x)

def _layernorm(x, axis=-1, eps=1e-05):
    m = x.mean(dim=axis, keepdim=True)
    v = x.var(dim=axis, keepdim=True, unbiased=False)
    return (x - m) / torch.sqrt(v + eps)

def _scatter_add(tgt, idx, src, axis=0):
    return tgt.clone().index_add_(axis, idx, src)

def _segment_sum(src, seg, n):
    out = torch.zeros((n,) + src.shape[1:], dtype=src.dtype)
    return out.index_add_(0, seg, src)

def _pad(x, pw):
    flat = tuple((v for pair in reversed(pw) for v in pair))
    return torch.nn.functional.pad(x, flat)
kernel_name = 'adaLN_cond__mha_block__glu_gated_swiglu__prompt'

def setup_inputs():

    _w = lambda a: (lambda t: t.to(torch.bfloat16) if t.is_floating_point() else t)(torch.as_tensor(a))

    def _A_setup():
        B, S, D, H = (1, 2048, 512, 32)
        return {'x': _w((lambda *s: torch.randn(*s, dtype=torch.bfloat16) * 0.05)(B, S, D)), 'wqkv': _w((lambda *s: torch.randn(*s, dtype=torch.bfloat16) * 0.05)(D, 3 * D)), 'wo': _w((lambda *s: torch.randn(*s, dtype=torch.bfloat16) * 0.05)(D, D))}
    _A_in = _A_setup()

    def _B_setup():
        B, S, D, F = (1, 2048, 512, 1376)
        return {'x': _w((lambda *s: torch.randn(*s, dtype=torch.bfloat16) * 0.05)(B, S, D)), 'w1': _w((lambda *s: torch.randn(*s, dtype=torch.bfloat16) * 0.8)(D, F) * (2.0 / D) ** 0.5), 'w3': _w((lambda *s: torch.randn(*s, dtype=torch.bfloat16) * 0.8)(D, F) * (2.0 / D) ** 0.5), 'w2': _w((lambda *s: torch.randn(*s, dtype=torch.bfloat16) * 0.8)(F, D) * (2.0 / F) ** 0.5)}
    _B_in = _B_setup()
    return {'A_x': _A_in['x'], 'A_wqkv': _A_in['wqkv'], 'A_wo': _A_in['wo'], 'B_x': _B_in['x'], 'B_w1': _B_in['w1'], 'B_w3': _B_in['w3'], 'B_w2': _B_in['w2'], 'c': _w((lambda *s: torch.randn(*s, dtype=torch.bfloat16) * 0.2)(1, 512) * 8.0), 'w_mod': _w((lambda *s: torch.randn(*s, dtype=torch.bfloat16) * 0.2)(512, 6 * 512) * 512 ** (-0.5) * 8.0)}

def reference(A_x, A_wqkv, A_wo, B_x, B_w1, B_w3, B_w2, c, w_mod):

    def _A_ref(x, wqkv, wo):
        B, S, D = x.shape
        H = 32
        Dh = D // H
        qkv = (lambda x, *d: x.permute(*d))((x @ wqkv).reshape(B, S, 3, H, Dh), 2, 0, 3, 1, 4)
        q, k, v = (qkv[0], qkv[1], qkv[2])
        scores = torch.einsum('bhqd,bhkd->bhqk', q, k) * Dh ** (-0.5)
        p = _softmax(scores, axis=-1)
        o = torch.einsum('bhqk,bhkd->bhqd', p, v)
        return (lambda x, *d: x.permute(*d))(o, 0, 2, 1, 3).reshape(B, S, D) @ wo

    def _B_ref(x, w1, w3, w2):
        gate = torch.einsum('bsd,df->bsf', x, w1)
        up = torch.einsum('bsd,df->bsf', x, w3)
        h = _silu(gate) * up
        out = torch.einsum('bsf,fd->bsd', h, w2)
        return out
    x = A_x
    mod = (_silu(c) @ w_mod).reshape(c.shape[0], 6, 1, -1)
    sa, ca, ga, sb, cb, gb = (mod[:, 0].clone(), mod[:, 1].clone(), mod[:, 2].clone(), mod[:, 3].clone(), mod[:, 4].clone(), mod[:, 5].clone())
    h = _layernorm(x, axis=-1) * (1 + ca) + sa
    x = x + ga * _A_ref(h, A_wqkv, A_wo)
    h = _layernorm(x, axis=-1) * (1 + cb) + sb
    x = x + gb * _B_ref(h, B_w1, B_w3, B_w2)
    return x
```

```asm
; @launch kernel=mega_kernel grid=(256,1,1) block=(512,1,1) lds=163840
.amdgcn_target "amdgcn-amd-amdhsa--gfx950"
.text
.globl mega_kernel
.p2align 8
.type mega_kernel,@function
mega_kernel:
  s_load_dwordx2 s[8:9], s[0:1], 88
  s_load_dwordx2 s[18:19], s[0:1], 0
  s_load_dwordx2 s[20:21], s[0:1], 8
  s_load_dwordx4 s[4:7], s[0:1], 56
  s_load_dwordx2 s[14:15], s[0:1], 32
  s_load_dwordx2 s[16:17], s[0:1], 40
  s_cmp_ge_u32 s2, 256
  s_cbranch_scc1 L_end
  v_lshrrev_b32 v1, 6, v0
  v_and_b32 v2, 63, v0
  v_readfirstlane_b32 s22, v1
  v_lshlrev_b32 v3, 4, v2
  s_waitcnt lgkmcnt(0)
  s_add_u32 s30, s8, 35651456
  s_addc_u32 s31, s9, 0
  s_load_dword s72, s[30:31], 0
  s_mov_b32 s24, s8
  s_and_b32 s25, s9, 0xffff
  s_mov_b32 s26, 0x10000000
  s_mov_b32 s27, 0x20000
  s_cmp_lg_u32 s22, 2
  s_cbranch_scc1 L_p0_n2
  s_lshr_b32 s30, s2, 5
  s_and_b32 s31, s2, 31
  v_lshrrev_b32 v4, 3, v2
  v_mul_u32_u24 v4, 3072, v4
  v_and_b32 v5, 7, v2
  v_lshl_add_u32 v4, v5, 4, v4
  s_mul_i32 s32, s31, 49152
  s_lshl_b32 s33, s30, 7
  s_add_u32 s32, s32, s33
  v_add_u32 v4, s32, v4
  v_add_u32 v5, 24576, v4
  s_mov_b32 m0, 16384
  s_nop 0
  global_load_lds_dwordx4 v4, s[20:21] offset:0
  s_mov_b32 m0, 17408
  s_nop 0
  global_load_lds_dwordx4 v5, s[20:21] offset:0
  s_mov_b32 m0, 17408
  s_nop 0
  global_load_lds_dwordx4 v4, s[20:21] offset:1024
  s_mov_b32 m0, 18432
  s_nop 0
  global_load_lds_dwordx4 v5, s[20:21] offset:1024
  s_mov_b32 m0, 18432
  s_nop 0
  global_load_lds_dwordx4 v4, s[20:21] offset:2048
  s_mov_b32 m0, 19456
  s_nop 0
  global_load_lds_dwordx4 v5, s[20:21] offset:2048
  s_branch L_p0_wqkv
L_p0_n2:
  s_cmp_lg_u32 s22, 1
  s_cbranch_scc1 L_p0_n1
  v_and_b32 v4, 7, v2
  v_lshrrev_b32 v5, 3, v2
  s_lshl_b32 s30, s2, 13
  v_lshlrev_b32 v6, 10, v4
  v_lshl_add_u32 v6, v5, 4, v6
  v_add_u32 v6, s30, v6
  global_load_dwordx4 v[8:11], v6, s[18:19] offset:0
  global_load_dwordx4 v[12:15], v6, s[18:19] offset:128
  global_load_dwordx4 v[16:19], v6, s[18:19] offset:256
  global_load_dwordx4 v[20:23], v6, s[18:19] offset:384
  global_load_dwordx4 v[24:27], v6, s[18:19] offset:512
  global_load_dwordx4 v[28:31], v6, s[18:19] offset:640
  global_load_dwordx4 v[32:35], v6, s[18:19] offset:768
  global_load_dwordx4 v[36:39], v6, s[18:19] offset:896
  s_branch L_p0_xhat
L_p0_n1:
  s_cmp_eq_u32 s22, 4
  s_cbranch_scc1 L_p0_zero
  s_cmp_eq_u32 s22, 5
  s_cbranch_scc1 L_p0_pf
  s_cmp_ge_u32 s22, 6
  s_cbranch_scc1 L_p0_slow
  s_and_b32 s30, s2, 7
  s_lshl_b32 s30, s30, 2
  s_bfe_u32 s32, s2, 0x20003
  s_add_u32 s30, s30, s32
  s_lshr_b32 s33, s2, 5
  s_lshl_b32 s34, s33, 6
  s_cmp_eq_u32 s22, 3
  s_cselect_b32 s35, 48, 0
  s_cselect_b32 s36, 32768, 0
  s_add_u32 s36, s36, 720896
  s_add_u32 s35, s35, s30
  v_lshrrev_b32 v1, 2, v2
  v_add_u32 v1, s34, v1
  v_lshlrev_b32 v4, 1, v1
  global_load_ushort v24, v4, s[4:5] offset:0
  global_load_ushort v25, v4, s[4:5] offset:32
  global_load_ushort v26, v4, s[4:5] offset:64
  global_load_ushort v27, v4, s[4:5] offset:96
  v_mul_u32_u24 v6, 6144, v1
  v_and_b32 v7, 3, v2
  v_lshl_add_u32 v6, v7, 4, v6
  s_lshl_b32 s31, s35, 6
  v_add_u32 v6, s31, v6
  global_load_dwordx4 v[8:11], v6, s[6:7]
  v_add_u32 v6, 98304, v6
  global_load_dwordx4 v[12:15], v6, s[6:7]
  v_add_u32 v6, 98304, v6
  global_load_dwordx4 v[16:19], v6, s[6:7]
  v_add_u32 v6, 98304, v6
  global_load_dwordx4 v[20:23], v6, s[6:7]
  s_waitcnt vmcnt(0)
  v_lshlrev_b32 v24, 16, v24
  v_mul_f32 v40, 0xbfb8aa3b, v24
  v_exp_f32 v40, v40
  s_nop 0
  v_add_f32 v40, 1.0, v40
  v_rcp_f32 v40, v40
  s_nop 0
  v_mul_f32 v24, v24, v40
  v_cvt_pk_bf16_f32 v24, v24, v24
  v_lshlrev_b32 v24, 16, v24
  v_lshlrev_b32 v25, 16, v25
  v_mul_f32 v40, 0xbfb8aa3b, v25
  v_exp_f32 v40, v40
  s_nop 0
  v_add_f32 v40, 1.0, v40
  v_rcp_f32 v40, v40
  s_nop 0
  v_mul_f32 v25, v25, v40
  v_cvt_pk_bf16_f32 v25, v25, v25
  v_lshlrev_b32 v25, 16, v25
  v_lshlrev_b32 v26, 16, v26
  v_mul_f32 v40, 0xbfb8aa3b, v26
  v_exp_f32 v40, v40
  s_nop 0
  v_add_f32 v40, 1.0, v40
  v_rcp_f32 v40, v40
  s_nop 0
  v_mul_f32 v26, v26, v40
  v_cvt_pk_bf16_f32 v26, v26, v26
  v_lshlrev_b32 v26, 16, v26
  v_lshlrev_b32 v27, 16, v27
  v_mul_f32 v40, 0xbfb8aa3b, v27
  v_exp_f32 v40, v40
  s_nop 0
  v_add_f32 v40, 1.0, v40
  v_rcp_f32 v40, v40
  s_nop 0
  v_mul_f32 v27, v27, v40
  v_cvt_pk_bf16_f32 v27, v27, v27
  v_lshlrev_b32 v27, 16, v27
  v_lshlrev_b32 v40, 16, v8
  v_and_b32 v41, 0xffff0000, v8
  v_mul_f32 v32, v24, v40
  v_mul_f32 v33, v24, v41
  v_lshlrev_b32 v40, 16, v9
  v_and_b32 v41, 0xffff0000, v9
  v_mul_f32 v34, v24, v40
  v_mul_f32 v35, v24, v41
  v_lshlrev_b32 v40, 16, v10
  v_and_b32 v41, 0xffff0000, v10
  v_mul_f32 v36, v24, v40
  v_mul_f32 v37, v24, v41
  v_lshlrev_b32 v40, 16, v11
  v_and_b32 v41, 0xffff0000, v11
  v_mul_f32 v38, v24, v40
  v_mul_f32 v39, v24, v41
  v_lshlrev_b32 v40, 16, v12
  v_and_b32 v41, 0xffff0000, v12
  v_fmac_f32 v32, v25, v40
  v_fmac_f32 v33, v25, v41
  v_lshlrev_b32 v40, 16, v13
  v_and_b32 v41, 0xffff0000, v13
  v_fmac_f32 v34, v25, v40
  v_fmac_f32 v35, v25, v41
  v_lshlrev_b32 v40, 16, v14
  v_and_b32 v41, 0xffff0000, v14
  v_fmac_f32 v36, v25, v40
  v_fmac_f32 v37, v25, v41
  v_lshlrev_b32 v40, 16, v15
  v_and_b32 v41, 0xffff0000, v15
  v_fmac_f32 v38, v25, v40
  v_fmac_f32 v39, v25, v41
  v_lshlrev_b32 v40, 16, v16
  v_and_b32 v41, 0xffff0000, v16
  v_fmac_f32 v32, v26, v40
  v_fmac_f32 v33, v26, v41
  v_lshlrev_b32 v40, 16, v17
  v_and_b32 v41, 0xffff0000, v17
  v_fmac_f32 v34, v26, v40
  v_fmac_f32 v35, v26, v41
  v_lshlrev_b32 v40, 16, v18
  v_and_b32 v41, 0xffff0000, v18
  v_fmac_f32 v36, v26, v40
  v_fmac_f32 v37, v26, v41
  v_lshlrev_b32 v40, 16, v19
  v_and_b32 v41, 0xffff0000, v19
  v_fmac_f32 v38, v26, v40
  v_fmac_f32 v39, v26, v41
  v_lshlrev_b32 v40, 16, v20
  v_and_b32 v41, 0xffff0000, v20
  v_fmac_f32 v32, v27, v40
  v_fmac_f32 v33, v27, v41
  v_lshlrev_b32 v40, 16, v21
  v_and_b32 v41, 0xffff0000, v21
  v_fmac_f32 v34, v27, v40
  v_fmac_f32 v35, v27, v41
  v_lshlrev_b32 v40, 16, v22
  v_and_b32 v41, 0xffff0000, v22
  v_fmac_f32 v36, v27, v40
  v_fmac_f32 v37, v27, v41
  v_lshlrev_b32 v40, 16, v23
  v_and_b32 v41, 0xffff0000, v23
  v_fmac_f32 v38, v27, v40
  v_fmac_f32 v39, v27, v41
  v_add_f32_dpp v32, v32, v32 row_ror:4 row_mask:0xf bank_mask:0xf
  v_add_f32_dpp v33, v33, v33 row_ror:4 row_mask:0xf bank_mask:0xf
  v_add_f32_dpp v34, v34, v34 row_ror:4 row_mask:0xf bank_mask:0xf
  v_add_f32_dpp v35, v35, v35 row_ror:4 row_mask:0xf bank_mask:0xf
  v_add_f32_dpp v36, v36, v36 row_ror:4 row_mask:0xf bank_mask:0xf
  v_add_f32_dpp v37, v37, v37 row_ror:4 row_mask:0xf bank_mask:0xf
  v_add_f32_dpp v38, v38, v38 row_ror:4 row_mask:0xf bank_mask:0xf
  v_add_f32_dpp v39, v39, v39 row_ror:4 row_mask:0xf bank_mask:0xf
  v_add_f32_dpp v32, v32, v32 row_ror:8 row_mask:0xf bank_mask:0xf
  v_add_f32_dpp v33, v33, v33 row_ror:8 row_mask:0xf bank_mask:0xf
  v_add_f32_dpp v34, v34, v34 row_ror:8 row_mask:0xf bank_mask:0xf
  v_add_f32_dpp v35, v35, v35 row_ror:8 row_mask:0xf bank_mask:0xf
  v_add_f32_dpp v36, v36, v36 row_ror:8 row_mask:0xf bank_mask:0xf
  v_add_f32_dpp v37, v37, v37 row_ror:8 row_mask:0xf bank_mask:0xf
  v_add_f32_dpp v38, v38, v38 row_ror:8 row_mask:0xf bank_mask:0xf
  v_add_f32_dpp v39, v39, v39 row_ror:8 row_mask:0xf bank_mask:0xf
  v_mov_b32 v44, v32
  v_mov_b32 v45, v33
  v_mov_b32 v46, v34
  v_mov_b32 v47, v35
  v_mov_b32 v48, v36
  v_mov_b32 v49, v37
  v_mov_b32 v50, v38
  v_mov_b32 v51, v39
  v_permlane16_swap_b32 v32, v44
  v_permlane16_swap_b32 v33, v45
  v_permlane16_swap_b32 v34, v46
  v_permlane16_swap_b32 v35, v47
  v_permlane16_swap_b32 v36, v48
  v_permlane16_swap_b32 v37, v49
  v_permlane16_swap_b32 v38, v50
  v_permlane16_swap_b32 v39, v51
  v_add_f32 v32, v32, v44
  v_add_f32 v33, v33, v45
  v_add_f32 v34, v34, v46
  v_add_f32 v35, v35, v47
  v_add_f32 v36, v36, v48
  v_add_f32 v37, v37, v49
  v_add_f32 v38, v38, v50
  v_add_f32 v39, v39, v51
  v_mov_b32 v44, v32
  v_mov_b32 v45, v33
  v_mov_b32 v46, v34
  v_mov_b32 v47, v35
  v_mov_b32 v48, v36
  v_mov_b32 v49, v37
  v_mov_b32 v50, v38
  v_mov_b32 v51, v39
  v_permlane32_swap_b32 v32, v44
  v_permlane32_swap_b32 v33, v45
  v_permlane32_swap_b32 v34, v46
  v_permlane32_swap_b32 v35, v47
  v_permlane32_swap_b32 v36, v48
  v_permlane32_swap_b32 v37, v49
  v_permlane32_swap_b32 v38, v50
  v_permlane32_swap_b32 v39, v51
  v_add_f32 v32, v32, v44
  v_add_f32 v33, v33, v45
  v_add_f32 v34, v34, v46
  v_add_f32 v35, v35, v47
  v_add_f32 v36, v36, v48
  v_add_f32 v37, v37, v49
  v_add_f32 v38, v38, v50
  v_add_f32 v39, v39, v51
  s_lshl_b32 s33, s33, 12
  s_lshl_b32 s30, s30, 7
  s_add_u32 s33, s33, s30
  s_add_u32 s33, s33, s36
  v_lshlrev_b32 v4, 5, v2
  s_mov_b64 exec, 15
  buffer_store_dwordx4 v[32:35], v4, s[24:27], s33 offen sc1
  buffer_store_dwordx4 v[36:39], v4, s[24:27], s33 offen offset:16 sc1
  s_mov_b64 exec, -1
  s_branch L_p0_done
L_p0_xhat:
  v_lshrrev_b32 v6, 1, v5
  v_lshlrev_b32 v6, 10, v6
  v_and_b32 v7, 1, v5
  v_lshl_add_u32 v6, v7, 9, v6
  v_lshl_add_u32 v6, v4, 4, v6
  s_lshr_b32 s30, s2, 2
  s_lshl_b32 s30, s30, 15
  s_and_b32 s31, s2, 3
  s_lshl_b32 s31, s31, 7
  s_add_u32 s30, s30, s31
  s_add_u32 s30, s30, 1048576
  v_mov_b32 v40, 0x3f803f80
  v_mov_b32 v41, 0
  v_mov_b32 v42, 0
  v_mov_b32 v43, 0
  v_mov_b32 v44, 0
  s_waitcnt vmcnt(0)
  v_dot2_f32_bf16 v41, v8, v40, v41
  v_dot2_f32_bf16 v43, v8, v8, v43
  v_dot2_f32_bf16 v42, v9, v40, v42
  v_dot2_f32_bf16 v44, v9, v9, v44
  v_dot2_f32_bf16 v41, v10, v40, v41
  v_dot2_f32_bf16 v43, v10, v10, v43
  v_dot2_f32_bf16 v42, v11, v40, v42
  v_dot2_f32_bf16 v44, v11, v11, v44
  v_dot2_f32_bf16 v41, v12, v40, v41
  v_dot2_f32_bf16 v43, v12, v12, v43
  v_dot2_f32_bf16 v42, v13, v40, v42
  v_dot2_f32_bf16 v44, v13, v13, v44
  v_dot2_f32_bf16 v41, v14, v40, v41
  v_dot2_f32_bf16 v43, v14, v14, v43
  v_dot2_f32_bf16 v42, v15, v40, v42
  v_dot2_f32_bf16 v44, v15, v15, v44
  v_dot2_f32_bf16 v41, v16, v40, v41
  v_dot2_f32_bf16 v43, v16, v16, v43
  v_dot2_f32_bf16 v42, v17, v40, v42
  v_dot2_f32_bf16 v44, v17, v17, v44
  v_dot2_f32_bf16 v41, v18, v40, v41
  v_dot2_f32_bf16 v43, v18, v18, v43
  v_dot2_f32_bf16 v42, v19, v40, v42
  v_dot2_f32_bf16 v44, v19, v19, v44
  v_dot2_f32_bf16 v41, v20, v40, v41
  v_dot2_f32_bf16 v43, v20, v20, v43
  v_dot2_f32_bf16 v42, v21, v40, v42
  v_dot2_f32_bf16 v44, v21, v21, v44
  v_dot2_f32_bf16 v41, v22, v40, v41
  v_dot2_f32_bf16 v43, v22, v22, v43
  v_dot2_f32_bf16 v42, v23, v40, v42
  v_dot2_f32_bf16 v44, v23, v23, v44
  v_dot2_f32_bf16 v41, v24, v40, v41
  v_dot2_f32_bf16 v43, v24, v24, v43
  v_dot2_f32_bf16 v42, v25, v40, v42
  v_dot2_f32_bf16 v44, v25, v25, v44
  v_dot2_f32_bf16 v41, v26, v40, v41
  v_dot2_f32_bf16 v43, v26, v26, v43
  v_dot2_f32_bf16 v42, v27, v40, v42
  v_dot2_f32_bf16 v44, v27, v27, v44
  v_dot2_f32_bf16 v41, v28, v40, v41
  v_dot2_f32_bf16 v43, v28, v28, v43
  v_dot2_f32_bf16 v42, v29, v40, v42
  v_dot2_f32_bf16 v44, v29, v29, v44
  v_dot2_f32_bf16 v41, v30, v40, v41
  v_dot2_f32_bf16 v43, v30, v30, v43
  v_dot2_f32_bf16 v42, v31, v40, v42
  v_dot2_f32_bf16 v44, v31, v31, v44
  v_dot2_f32_bf16 v41, v32, v40, v41
  v_dot2_f32_bf16 v43, v32, v32, v43
  v_dot2_f32_bf16 v42, v33, v40, v42
  v_dot2_f32_bf16 v44, v33, v33, v44
  v_dot2_f32_bf16 v41, v34, v40, v41
  v_dot2_f32_bf16 v43, v34, v34, v43
  v_dot2_f32_bf16 v42, v35, v40, v42
  v_dot2_f32_bf16 v44, v35, v35, v44
  v_dot2_f32_bf16 v41, v36, v40, v41
  v_dot2_f32_bf16 v43, v36, v36, v43
  v_dot2_f32_bf16 v42, v37, v40, v42
  v_dot2_f32_bf16 v44, v37, v37, v44
  v_dot2_f32_bf16 v41, v38, v40, v41
  v_dot2_f32_bf16 v43, v38, v38, v43
  v_dot2_f32_bf16 v42, v39, v40, v42
  v_dot2_f32_bf16 v44, v39, v39, v44
  s_nop 1
  v_add_f32 v41, v41, v42
  v_add_f32 v43, v43, v44
  s_nop 0
  v_add_f32_dpp v41, v41, v41 row_ror:8 row_mask:0xf bank_mask:0xf
  v_add_f32_dpp v43, v43, v43 row_ror:8 row_mask:0xf bank_mask:0xf
  v_mov_b32 v42, v41
  v_mov_b32 v44, v43
  s_nop 0
  v_permlane16_swap_b32 v41, v42
  v_permlane16_swap_b32 v43, v44
  v_add_f32 v41, v41, v42
  v_add_f32 v43, v43, v44
  v_mov_b32 v42, v41
  v_mov_b32 v44, v43
  s_nop 0
  v_permlane32_swap_b32 v41, v42
  v_permlane32_swap_b32 v43, v44
  v_add_f32 v41, v41, v42
  v_add_f32 v43, v43, v44
  v_mul_f32 v41, 0x3b000000, v41
  v_mul_f32 v43, 0x3b000000, v43
  v_fma_f32 v43, -v41, v41, v43
  v_max_f32 v43, 0, v43
  v_add_f32 v43, 0x3727c5ac, v43
  v_rsq_f32 v43, v43
  s_nop 0
  v_mul_f32 v41, v41, v43
  v_lshlrev_b32 v46, 16, v8
  v_and_b32 v47, 0xffff0000, v8
  v_fma_f32 v46, v46, v43, -v41
  v_fma_f32 v47, v47, v43, -v41
  v_cvt_pk_f16_f32 v8, v46, v47
  v_lshlrev_b32 v48, 16, v9
  v_and_b32 v49, 0xffff0000, v9
  v_fma_f32 v48, v48, v43, -v41
  v_fma_f32 v49, v49, v43, -v41
  v_cvt_pk_f16_f32 v9, v48, v49
  v_lshlrev_b32 v50, 16, v10
  v_and_b32 v51, 0xffff0000, v10
  v_fma_f32 v50, v50, v43, -v41
  v_fma_f32 v51, v51, v43, -v41
  v_cvt_pk_f16_f32 v10, v50, v51
  v_lshlrev_b32 v52, 16, v11
  v_and_b32 v53, 0xffff0000, v11
  v_fma_f32 v52, v52, v43, -v41
  v_fma_f32 v53, v53, v43, -v41
  v_cvt_pk_f16_f32 v11, v52, v53
  buffer_store_dwordx4 v[8:11], v6, s[24:27], s30 offen sc1
  s_add_u32 s30, s30, 4096
  v_lshlrev_b32 v46, 16, v12
  v_and_b32 v47, 0xffff0000, v12
  v_fma_f32 v46, v46, v43, -v41
  v_fma_f32 v47, v47, v43, -v41
  v_cvt_pk_f16_f32 v12, v46, v47
  v_lshlrev_b32 v48, 16, v13
  v_and_b32 v49, 0xffff0000, v13
  v_fma_f32 v48, v48, v43, -v41
  v_fma_f32 v49, v49, v43, -v41
  v_cvt_pk_f16_f32 v13, v48, v49
  v_lshlrev_b32 v50, 16, v14
  v_and_b32 v51, 0xffff0000, v14
  v_fma_f32 v50, v50, v43, -v41
  v_fma_f32 v51, v51, v43, -v41
  v_cvt_pk_f16_f32 v14, v50, v51
  v_lshlrev_b32 v52, 16, v15
  v_and_b32 v53, 0xffff0000, v15
  v_fma_f32 v52, v52, v43, -v41
  v_fma_f32 v53, v53, v43, -v41
  v_cvt_pk_f16_f32 v15, v52, v53
  buffer_store_dwordx4 v[12:15], v6, s[24:27], s30 offen sc1
  s_add_u32 s30, s30, 4096
  v_lshlrev_b32 v46, 16, v16
  v_and_b32 v47, 0xffff0000, v16
  v_fma_f32 v46, v46, v43, -v41
  v_fma_f32 v47, v47, v43, -v41
  v_cvt_pk_f16_f32 v16, v46, v47
  v_lshlrev_b32 v48, 16, v17
  v_and_b32 v49, 0xffff0000, v17
  v_fma_f32 v48, v48, v43, -v41
  v_fma_f32 v49, v49, v43, -v41
  v_cvt_pk_f16_f32 v17, v48, v49
  v_lshlrev_b32 v50, 16, v18
  v_and_b32 v51, 0xffff0000, v18
  v_fma_f32 v50, v50, v43, -v41
  v_fma_f32 v51, v51, v43, -v41
  v_cvt_pk_f16_f32 v18, v50, v51
  v_lshlrev_b32 v52, 16, v19
  v_and_b32 v53, 0xffff0000, v19
  v_fma_f32 v52, v52, v43, -v41
  v_fma_f32 v53, v53, v43, -v41
  v_cvt_pk_f16_f32 v19, v52, v53
  buffer_store_dwordx4 v[16:19], v6, s[24:27], s30 offen sc1
  s_add_u32 s30, s30, 4096
  v_lshlrev_b32 v46, 16, v20
  v_and_b32 v47, 0xffff0000, v20
  v_fma_f32 v46, v46, v43, -v41
  v_fma_f32 v47, v47, v43, -v41
  v_cvt_pk_f16_f32 v20, v46, v47
  v_lshlrev_b32 v48, 16, v21
  v_and_b32 v49, 0xffff0000, v21
  v_fma_f32 v48, v48, v43, -v41
  v_fma_f32 v49, v49, v43, -v41
  v_cvt_pk_f16_f32 v21, v48, v49
  v_lshlrev_b32 v50, 16, v22
  v_and_b32 v51, 0xffff0000, v22
  v_fma_f32 v50, v50, v43, -v41
  v_fma_f32 v51, v51, v43, -v41
  v_cvt_pk_f16_f32 v22, v50, v51
  v_lshlrev_b32 v52, 16, v23
  v_and_b32 v53, 0xffff0000, v23
  v_fma_f32 v52, v52, v43, -v41
  v_fma_f32 v53, v53, v43, -v41
  v_cvt_pk_f16_f32 v23, v52, v53
  buffer_store_dwordx4 v[20:23], v6, s[24:27], s30 offen sc1
  s_add_u32 s30, s30, 4096
  v_lshlrev_b32 v46, 16, v24
  v_and_b32 v47, 0xffff0000, v24
  v_fma_f32 v46, v46, v43, -v41
  v_fma_f32 v47, v47, v43, -v41
  v_cvt_pk_f16_f32 v24, v46, v47
  v_lshlrev_b32 v48, 16, v25
  v_and_b32 v49, 0xffff0000, v25
  v_fma_f32 v48, v48, v43, -v41
  v_fma_f32 v49, v49, v43, -v41
  v_cvt_pk_f16_f32 v25, v48, v49
  v_lshlrev_b32 v50, 16, v26
  v_and_b32 v51, 0xffff0000, v26
  v_fma_f32 v50, v50, v43, -v41
  v_fma_f32 v51, v51, v43, -v41
  v_cvt_pk_f16_f32 v26, v50, v51
  v_lshlrev_b32 v52, 16, v27
  v_and_b32 v53, 0xffff0000, v27
  v_fma_f32 v52, v52, v43, -v41
  v_fma_f32 v53, v53, v43, -v41
  v_cvt_pk_f16_f32 v27, v52, v53
  buffer_store_dwordx4 v[24:27], v6, s[24:27], s30 offen sc1
  s_add_u32 s30, s30, 4096
  v_lshlrev_b32 v46, 16, v28
  v_and_b32 v47, 0xffff0000, v28
  v_fma_f32 v46, v46, v43, -v41
  v_fma_f32 v47, v47, v43, -v41
  v_cvt_pk_f16_f32 v28, v46, v47
  v_lshlrev_b32 v48, 16, v29
  v_and_b32 v49, 0xffff0000, v29
  v_fma_f32 v48, v48, v43, -v41
  v_fma_f32 v49, v49, v43, -v41
  v_cvt_pk_f16_f32 v29, v48, v49
  v_lshlrev_b32 v50, 16, v30
  v_and_b32 v51, 0xffff0000, v30
  v_fma_f32 v50, v50, v43, -v41
  v_fma_f32 v51, v51, v43, -v41
  v_cvt_pk_f16_f32 v30, v50, v51
  v_lshlrev_b32 v52, 16, v31
  v_and_b32 v53, 0xffff0000, v31
  v_fma_f32 v52, v52, v43, -v41
  v_fma_f32 v53, v53, v43, -v41
  v_cvt_pk_f16_f32 v31, v52, v53
  buffer_store_dwordx4 v[28:31], v6, s[24:27], s30 offen sc1
  s_add_u32 s30, s30, 4096
  v_lshlrev_b32 v46, 16, v32
  v_and_b32 v47, 0xffff0000, v32
  v_fma_f32 v46, v46, v43, -v41
  v_fma_f32 v47, v47, v43, -v41
  v_cvt_pk_f16_f32 v32, v46, v47
  v_lshlrev_b32 v48, 16, v33
  v_and_b32 v49, 0xffff0000, v33
  v_fma_f32 v48, v48, v43, -v41
  v_fma_f32 v49, v49, v43, -v41
  v_cvt_pk_f16_f32 v33, v48, v49
  v_lshlrev_b32 v50, 16, v34
  v_and_b32 v51, 0xffff0000, v34
  v_fma_f32 v50, v50, v43, -v41
  v_fma_f32 v51, v51, v43, -v41
  v_cvt_pk_f16_f32 v34, v50, v51
  v_lshlrev_b32 v52, 16, v35
  v_and_b32 v53, 0xffff0000, v35
  v_fma_f32 v52, v52, v43, -v41
  v_fma_f32 v53, v53, v43, -v41
  v_cvt_pk_f16_f32 v35, v52, v53
  buffer_store_dwordx4 v[32:35], v6, s[24:27], s30 offen sc1
  s_add_u32 s30, s30, 4096
  v_lshlrev_b32 v46, 16, v36
  v_and_b32 v47, 0xffff0000, v36
  v_fma_f32 v46, v46, v43, -v41
  v_fma_f32 v47, v47, v43, -v41
  v_cvt_pk_f16_f32 v36, v46, v47
  v_lshlrev_b32 v48, 16, v37
  v_and_b32 v49, 0xffff0000, v37
  v_fma_f32 v48, v48, v43, -v41
  v_fma_f32 v49, v49, v43, -v41
  v_cvt_pk_f16_f32 v37, v48, v49
  v_lshlrev_b32 v50, 16, v38
  v_and_b32 v51, 0xffff0000, v38
  v_fma_f32 v50, v50, v43, -v41
  v_fma_f32 v51, v51, v43, -v41
  v_cvt_pk_f16_f32 v38, v50, v51
  v_lshlrev_b32 v52, 16, v39
  v_and_b32 v53, 0xffff0000, v39
  v_fma_f32 v52, v52, v43, -v41
  v_fma_f32 v53, v53, v43, -v41
  v_cvt_pk_f16_f32 v39, v52, v53
  buffer_store_dwordx4 v[36:39], v6, s[24:27], s30 offen sc1
  s_branch L_p0_done
L_p0_wqkv:
  v_bfe_u32 v6, v2, 2, 2
  v_lshrrev_b32 v7, 5, v2
  v_lshl_add_u32 v6, v7, 3, v6
  v_lshlrev_b32 v8, 7, v6
  v_bfe_u32 v6, v2, 4, 1
  v_lshl_add_u32 v8, v6, 5, v8
  v_and_b32 v6, 3, v2
  v_lshl_add_u32 v8, v6, 3, v8
  v_add_u32 v8, 16384, v8
  s_mul_i32 s32, s30, 196608
  s_lshl_b32 s33, s31, 10
  s_add_u32 s32, s32, s33
  s_add_u32 s32, s32, 3145728
  s_waitcnt vmcnt(0)
  ds_read_b64_tr_b16 v[12:13], v8 offset:0
  ds_read_b64_tr_b16 v[14:15], v8 offset:512
  ds_read_b64_tr_b16 v[16:17], v8 offset:64
  ds_read_b64_tr_b16 v[18:19], v8 offset:576
  ds_read_b64_tr_b16 v[20:21], v8 offset:2048
  ds_read_b64_tr_b16 v[22:23], v8 offset:2560
  ds_read_b64_tr_b16 v[24:25], v8 offset:2112
  ds_read_b64_tr_b16 v[26:27], v8 offset:2624
  ds_read_b64_tr_b16 v[28:29], v8 offset:4096
  ds_read_b64_tr_b16 v[30:31], v8 offset:4608
  ds_read_b64_tr_b16 v[32:33], v8 offset:4160
  ds_read_b64_tr_b16 v[34:35], v8 offset:4672
  s_waitcnt lgkmcnt(0)
  s_add_u32 s33, s32, 0
  buffer_store_dwordx4 v[12:15], v3, s[24:27], s33 offen sc1
  s_add_u32 s33, s32, 98304
  buffer_store_dwordx4 v[16:19], v3, s[24:27], s33 offen sc1
  s_add_u32 s33, s32, 32768
  buffer_store_dwordx4 v[20:23], v3, s[24:27], s33 offen sc1
  s_add_u32 s33, s32, 131072
  buffer_store_dwordx4 v[24:27], v3, s[24:27], s33 offen sc1
  s_add_u32 s33, s32, 65536
  buffer_store_dwordx4 v[28:31], v3, s[24:27], s33 offen sc1
  s_add_u32 s33, s32, 163840
  buffer_store_dwordx4 v[32:35], v3, s[24:27], s33 offen sc1
  s_branch L_p0_done
L_p0_slow:
  s_branch L_p0_done
L_p0_zero:
  s_cmp_ge_u32 s2, 22
  s_cbranch_scc1 L_p0_done
  v_mov_b64 v[8:9], 0
  v_mov_b64 v[10:11], 0
  s_lshl_b32 s30, s2, 10
  s_add_u32 s30, s30, 655360
  buffer_store_dwordx4 v[8:11], v3, s[24:27], s30 offen sc1
  s_branch L_p0_done
L_p0_pf:
  s_getpc_b64 s[30:31]
L_p0_pc:
  s_sub_u32 s30, s30, L_p0_pc-mega_kernel
  s_subb_u32 s31, s31, 0
  s_lshr_b32 s32, s2, 3
  s_lshl_b32 s32, s32, 11
  v_add_u32 v60, s32, v3
  v_add_u32 v61, 1024, v60
  v_min_u32 v60, L_text_end-mega_kernel-16, v60
  v_min_u32 v61, L_text_end-mega_kernel-16, v61
  global_load_dwordx4 v[64:67], v60, s[30:31]
  global_load_dwordx4 v[68:71], v61, s[30:31]
  s_branch L_p0_done
L_p0_done:
  s_waitcnt lgkmcnt(0)
  s_add_u32 s72, s72, 1
  s_mov_b32 s30, s2
  s_cmp_ge_u32 s22, 5
  s_cbranch_scc1 Lpw_mega_kernel_2
  s_waitcnt vmcnt(0)
Lpw_mega_kernel_2:
  s_barrier
  s_cmp_lg_u32 s22, 0
  s_cbranch_scc1 Lpub_mega_kernel_1
  s_lshl_b32 s73, s30, 7
  s_add_u32 s73, s73, 35651584
  v_mov_b32 v4, s73
  v_mov_b32 v5, s72
  s_mov_b64 exec, 1
  global_store_dword v4, v5, s[8:9] sc1
  s_mov_b64 exec, -1
Lpub_mega_kernel_1:
  s_cmp_ge_u32 s22, 4
  s_cbranch_scc1 Lw_mega_kernel_3
  s_lshl_b32 s73, s22, 13
  s_add_u32 s73, s73, 35651584
  v_lshlrev_b32 v4, 7, v2
  v_add_u32 v4, s73, v4
  s_mov_b32 s73, 0
  global_load_dword v5, v4, s[8:9] sc1
Lp_mega_kernel_4:
  s_waitcnt vmcnt(0)
  v_cmp_ne_u32 vcc, s72, v5
  s_nop 1
  s_cbranch_vccz Lx_mega_kernel_5
  s_sleep 4
  global_load_dword v5, v4, s[8:9] sc1
  s_add_u32 s73, s73, 1
  s_cmp_lt_u32 s73, 100000
  s_cbranch_scc1 Lp_mega_kernel_4
Lx_mega_kernel_5:
  s_waitcnt vmcnt(0)
Lw_mega_kernel_3:
  s_and_b32 s34, s2, 7
  s_lshr_b32 s35, s2, 3
  s_and_b32 s20, s34, 3
  s_lshl_b32 s20, s20, 2
  s_and_b32 s18, s35, 3
  s_add_u32 s20, s20, s18
  s_lshr_b32 s21, s34, 2
  s_lshl_b32 s21, s21, 3
  s_lshr_b32 s18, s35, 2
  s_add_u32 s21, s21, s18
  s_cmp_ge_u32 s22, 4
  s_cbranch_scc1 L_p1_loader
  s_lshl_b32 s28, s20, 2
  s_add_u32 s28, s28, s22
  s_lshl_b32 s28, s28, 15
  s_add_u32 s28, s28, 1048576
  s_lshl_b32 s19, s22, 9
  s_add_u32 s19, s19, 720896
  v_lshlrev_b32 v60, 3, v2
  s_barrier
  s_add_u32 s31, s19, 0
  buffer_load_dwordx2 v[44:45], v60, s[24:27], s31 offen sc1
  s_add_u32 s31, s19, 4096
  buffer_load_dwordx2 v[46:47], v60, s[24:27], s31 offen sc1
  s_add_u32 s31, s19, 8192
  buffer_load_dwordx2 v[48:49], v60, s[24:27], s31 offen sc1
  s_add_u32 s31, s19, 12288
  buffer_load_dwordx2 v[50:51], v60, s[24:27], s31 offen sc1
  s_add_u32 s31, s19, 16384
  buffer_load_dwordx2 v[52:53], v60, s[24:27], s31 offen sc1
  s_add_u32 s31, s19, 20480
  buffer_load_dwordx2 v[54:55], v60, s[24:27], s31 offen sc1
  s_add_u32 s31, s19, 24576
  buffer_load_dwordx2 v[56:57], v60, s[24:27], s31 offen sc1
  s_add_u32 s31, s19, 28672
  buffer_load_dwordx2 v[58:59], v60, s[24:27], s31 offen sc1
  buffer_load_dwordx4 v[128:131], v3, s[24:27], s28 offen offset:0 sc1
  buffer_load_dwordx4 v[132:135], v3, s[24:27], s28 offen offset:1024 sc1
  buffer_load_dwordx4 v[136:139], v3, s[24:27], s28 offen offset:2048 sc1
  buffer_load_dwordx4 v[140:143], v3, s[24:27], s28 offen offset:3072 sc1
  s_add_u32 s28, s28, 4096
  buffer_load_dwordx4 v[144:147], v3, s[24:27], s28 offen offset:0 sc1
  buffer_load_dwordx4 v[148:151], v3, s[24:27], s28 offen offset:1024 sc1
  v_lshrrev_b32 v4, 5, v2
  v_lshlrev_b32 v4, 5, v4
  v_add_u32 v4, 98304, v4
  v_add_u32 v5, 65536, v3
  v_mov_b64 v[64:65], 0
  v_mov_b64 v[66:67], 0
  v_mov_b64 v[68:69], 0
  v_mov_b64 v[70:71], 0
  v_mov_b64 v[72:73], 0
  v_mov_b64 v[74:75], 0
  v_mov_b64 v[76:77], 0
  v_mov_b64 v[78:79], 0
  v_mov_b64 v[80:81], 0
  v_mov_b64 v[82:83], 0
  v_mov_b64 v[84:85], 0
  v_mov_b64 v[86:87], 0
  v_mov_b64 v[88:89], 0
  v_mov_b64 v[90:91], 0
  v_mov_b64 v[92:93], 0
  v_mov_b64 v[94:95], 0
  v_mov_b64 v[96:97], 0
  v_mov_b64 v[98:99], 0
  v_mov_b64 v[100:101], 0
  v_mov_b64 v[102:103], 0
  v_mov_b64 v[104:105], 0
  v_mov_b64 v[106:107], 0
  v_mov_b64 v[108:109], 0
  v_mov_b64 v[110:111], 0
  s_waitcnt vmcnt(6)
  v_add_f32 v44, v44, v46
  v_add_f32 v45, v45, v47
  v_add_f32 v48, v48, v50
  v_add_f32 v49, v49, v51
  v_add_f32 v52, v52, v54
  v_add_f32 v53, v53, v55
  v_add_f32 v56, v56, v58
  v_add_f32 v57, v57, v59
  v_add_f32 v44, v44, v48
  v_add_f32 v45, v45, v49
  v_add_f32 v52, v52, v56
  v_add_f32 v53, v53, v57
  v_add_f32 v44, v44, v52
  v_add_f32 v45, v45, v53
  v_cvt_pk_bf16_f32 v44, v44, v44
  v_lshlrev_b32 v44, 16, v44
  v_cvt_pk_bf16_f32 v45, v45, v45
  v_lshlrev_b32 v45, 16, v45
  s_cmp_lt_u32 s22, 4
  s_cbranch_scc1 L_mega_kernel_6
  v_add_f32 v44, 1.0, v44
  v_add_f32 v45, 1.0, v45
  v_cvt_pk_bf16_f32 v44, v44, v44
  v_lshlrev_b32 v44, 16, v44
  v_cvt_pk_bf16_f32 v45, v45, v45
  v_lshlrev_b32 v45, 16, v45
L_mega_kernel_6:
  s_lshl_b32 s31, s22, 9
  s_add_u32 s31, s31, 98304
  v_add_u32 v60, s31, v60
  ds_write_b64 v60, v[44:45]
  s_waitcnt lgkmcnt(0)
  s_barrier
  ds_read_b128 v[32:35], v4 offset:2048
  ds_read_b128 v[36:39], v4 offset:2064
  ds_read_b128 v[40:43], v4 offset:0
  ds_read_b128 v[44:47], v4 offset:16
  ds_read_b128 v[8:11], v3 offset:0
  ds_read_b128 v[12:15], v3 offset:1024
  ds_read_b128 v[16:19], v3 offset:2048
  ds_read_b128 v[48:51], v4 offset:2112
  ds_read_b128 v[52:55], v4 offset:2128
  ds_read_b128 v[56:59], v4 offset:64
  ds_read_b128 v[60:63], v4 offset:80
  s_waitcnt vmcnt(5) lgkmcnt(7)
  v_fma_mix_f32 v112, v128, v32, v40 op_sel:[0,0,0] op_sel_hi:[1,0,0]
  v_fma_mix_f32 v113, v128, v33, v41 op_sel:[1,0,0] op_sel_hi:[1,0,0]
  v_fma_mix_f32 v114, v129, v34, v42 op_sel:[0,0,0] op_sel_hi:[1,0,0]
  v_fma_mix_f32 v115, v129, v35, v43 op_sel:[1,0,0] op_sel_hi:[1,0,0]
  v_fma_mix_f32 v116, v130, v36, v44 op_sel:[0,0,0] op_sel_hi:[1,0,0]
  v_fma_mix_f32 v117, v130, v37, v45 op_sel:[1,0,0] op_sel_hi:[1,0,0]
  v_fma_mix_f32 v118, v131, v38, v46 op_sel:[0,0,0] op_sel_hi:[1,0,0]
  v_fma_mix_f32 v119, v131, v39, v47 op_sel:[1,0,0] op_sel_hi:[1,0,0]
  v_cvt_pk_bf16_f32 v120, v112, v113
  v_cvt_pk_bf16_f32 v121, v114, v115
  v_cvt_pk_bf16_f32 v122, v116, v117
  v_cvt_pk_bf16_f32 v123, v118, v119
  s_waitcnt lgkmcnt(0)
  s_waitcnt vmcnt(4)
  v_mfma_f32_32x32x16_bf16 v[64:79], v[8:11], v[120:123], v[64:79]
  ds_read_b128 v[20:23], v3 offset:3072
  ds_read_b128 v[24:27], v3 offset:4096
  ds_read_b128 v[28:31], v3 offset:5120
  v_fma_mix_f32 v112, v132, v48, v56 op_sel:[0,0,0] op_sel_hi:[1,0,0]
  v_fma_mix_f32 v113, v132, v49, v57 op_sel:[1,0,0] op_sel_hi:[1,0,0]
  v_fma_mix_f32 v114, v133, v50, v58 op_sel:[0,0,0] op_sel_hi:[1,0,0]
  v_fma_mix_f32 v115, v133, v51, v59 op_sel:[1,0,0] op_sel_hi:[1,0,0]
  v_mfma_f32_32x32x16_bf16 v[80:95], v[12:15], v[120:123], v[80:95]
  ds_read_b128 v[32:35], v4 offset:2176
  ds_read_b128 v[40:43], v4 offset:128
  v_fma_mix_f32 v116, v134, v52, v60 op_sel:[0,0,0] op_sel_hi:[1,0,0]
  v_fma_mix_f32 v117, v134, v53, v61 op_sel:[1,0,0] op_sel_hi:[1,0,0]
  v_fma_mix_f32 v118, v135, v54, v62 op_sel:[0,0,0] op_sel_hi:[1,0,0]
  v_fma_mix_f32 v119, v135, v55, v63 op_sel:[1,0,0] op_sel_hi:[1,0,0]
  ds_read_b128 v[36:39], v4 offset:2192
  ds_read_b128 v[44:47], v4 offset:144
  v_mfma_f32_32x32x16_bf16 v[96:111], v[120:123], v[16:19], v[96:111]
  buffer_load_dwordx4 v[152:155], v3, s[24:27], s28 offen offset:2048 sc1
  v_cvt_pk_bf16_f32 v124, v112, v113
  v_cvt_pk_bf16_f32 v125, v114, v115
  v_cvt_pk_bf16_f32 v126, v116, v117
  v_cvt_pk_bf16_f32 v127, v118, v119
  s_waitcnt lgkmcnt(0)
  s_waitcnt vmcnt(4)
  v_mfma_f32_32x32x16_bf16 v[64:79], v[20:23], v[124:127], v[64:79]
  ds_read_b128 v[8:11], v3 offset:6144
  ds_read_b128 v[12:15], v3 offset:7168
  ds_read_b128 v[16:19], v3 offset:8192
  v_fma_mix_f32 v112, v136, v32, v40 op_sel:[0,0,0] op_sel_hi:[1,0,0]
  v_fma_mix_f32 v113, v136, v33, v41 op_sel:[1,0,0] op_sel_hi:[1,0,0]
  v_fma_mix_f32 v114, v137, v34, v42 op_sel:[0,0,0] op_sel_hi:[1,0,0]
  v_fma_mix_f32 v115, v137, v35, v43 op_sel:[1,0,0] op_sel_hi:[1,0,0]
  v_mfma_f32_32x32x16_bf16 v[80:95], v[24:27], v[124:127], v[80:95]
  ds_read_b128 v[48:51], v4 offset:2240
  ds_read_b128 v[56:59], v4 offset:192
  v_fma_mix_f32 v116, v138, v36, v44 op_sel:[0,0,0] op_sel_hi:[1,0,0]
  v_fma_mix_f32 v117, v138, v37, v45 op_sel:[1,0,0] op_sel_hi:[1,0,0]
  v_fma_mix_f32 v118, v139, v38, v46 op_sel:[0,0,0] op_sel_hi:[1,0,0]
  v_fma_mix_f32 v119, v139, v39, v47 op_sel:[1,0,0] op_sel_hi:[1,0,0]
  ds_read_b128 v[52:55], v4 offset:2256
  ds_read_b128 v[60:63], v4 offset:208
  v_mfma_f32_32x32x16_bf16 v[96:111], v[124:127], v[28:31], v[96:111]
  buffer_load_dwordx4 v[156:159], v3, s[24:27], s28 offen offset:3072 sc1
  v_cvt_pk_bf16_f32 v120, v112, v113
  v_cvt_pk_bf16_f32 v121, v114, v115
  v_cvt_pk_bf16_f32 v122, v116, v117
  v_cvt_pk_bf16_f32 v123, v118, v119
  s_waitcnt lgkmcnt(0)
  s_waitcnt vmcnt(4)
  v_mfma_f32_32x32x16_bf16 v[64:79], v[8:11], v[120:123], v[64:79]
  ds_read_b128 v[20:23], v3 offset:9216
  ds_read_b128 v[24:27], v3 offset:10240
  ds_read_b128 v[28:31], v3 offset:11264
  v_fma_mix_f32 v112, v140, v48, v56 op_sel:[0,0,0] op_sel_hi:[1,0,0]
  v_fma_mix_f32 v113, v140, v49, v57 op_sel:[1,0,0] op_sel_hi:[1,0,0]
  v_fma_mix_f32 v114, v141, v50, v58 op_sel:[0,0,0] op_sel_hi:[1,0,0]
  v_fma_mix_f32 v115, v141, v51, v59 op_sel:[1,0,0] op_sel_hi:[1,0,0]
  v_mfma_f32_32x32x16_bf16 v[80:95], v[12:15], v[120:123], v[80:95]
  ds_read_b128 v[32:35], v4 offset:2304
  ds_read_b128 v[40:43], v4 offset:256
  v_fma_mix_f32 v116, v142, v52, v60 op_sel:[0,0,0] op_sel_hi:[1,0,0]
  v_fma_mix_f32 v117, v142, v53, v61 op_sel:[1,0,0] op_sel_hi:[1,0,0]
  v_fma_mix_f32 v118, v143, v54, v62 op_sel:[0,0,0] op_sel_hi:[1,0,0]
  v_fma_mix_f32 v119, v143, v55, v63 op_sel:[1,0,0] op_sel_hi:[1,0,0]
  ds_read_b128 v[36:39], v4 offset:2320
  ds_read_b128 v[44:47], v4 offset:272
  v_mfma_f32_32x32x16_bf16 v[96:111], v[120:123], v[16:19], v[96:111]
  s_add_u32 s28, s28, 4096
  buffer_load_dwordx4 v[160:163], v3, s[24:27], s28 offen offset:0 sc1
  v_cvt_pk_bf16_f32 v124, v112, v113
  v_cvt_pk_bf16_f32 v125, v114, v115
  v_cvt_pk_bf16_f32 v126, v116, v117
  v_cvt_pk_bf16_f32 v127, v118, v119
  s_barrier
  s_waitcnt lgkmcnt(0)
  s_waitcnt vmcnt(4)
  v_mfma_f32_32x32x16_bf16 v[64:79], v[20:23], v[124:127], v[64:79]
  ds_read_b128 v[8:11], v3 offset:12288
  ds_read_b128 v[12:15], v3 offset:13312
  ds_read_b128 v[16:19], v3 offset:14336
  v_fma_mix_f32 v112, v144, v32, v40 op_sel:[0,0,0] op_sel_hi:[1,0,0]
  v_fma_mix_f32 v113, v144, v33, v41 op_sel:[1,0,0] op_sel_hi:[1,0,0]
  v_fma_mix_f32 v114, v145, v34, v42 op_sel:[0,0,0] op_sel_hi:[1,0,0]
  v_fma_mix_f32 v115, v145, v35, v43 op_sel:[1,0,0] op_sel_hi:[1,0,0]
  v_mfma_f32_32x32x16_bf16 v[80:95], v[24:27], v[124:127], v[80:95]
  ds_read_b128 v[48:51], v4 offset:2368
  ds_read_b128 v[56:59], v4 offset:320
  v_fma_mix_f32 v116, v146, v36, v44 op_sel:[0,0,0] op_sel_hi:[1,0,0]
  v_fma_mix_f32 v117, v146, v37, v45 op_sel:[1,0,0] op_sel_hi:[1,0,0]
  v_fma_mix_f32 v118, v147, v38, v46 op_sel:[0,0,0] op_sel_hi:[1,0,0]
  v_fma_mix_f32 v119, v147, v39, v47 op_sel:[1,0,0] op_sel_hi:[1,0,0]
  ds_read_b128 v[52:55], v4 offset:2384
  ds_read_b128 v[60:63], v4 offset:336
  v_mfma_f32_32x32x16_bf16 v[96:111], v[124:127], v[28:31], v[96:111]
  buffer_load_dwordx4 v[164:167], v3, s[24:27], s28 offen offset:1024 sc1
  v_cvt_pk_bf16_f32 v120, v112, v113
  v_cvt_pk_bf16_f32 v121, v114, v115
  v_cvt_pk_bf16_f32 v122, v116, v117
  v_cvt_pk_bf16_f32 v123, v118, v119
  s_waitcnt lgkmcnt(0)
  s_waitcnt vmcnt(4)
  v_mfma_f32_32x32x16_bf16 v[64:79], v[8:11], v[120:123], v[64:79]
  ds_read_b128 v[20:23], v3 offset:15360
  ds_read_b128 v[24:27], v3 offset:16384
  ds_read_b128 v[28:31], v3 offset:17408
  v_fma_mix_f32 v112, v148, v48, v56 op_sel:[0,0,0] op_sel_hi:[1,0,0]
  v_fma_mix_f32 v113, v148, v49, v57 op_sel:[1,0,0] op_sel_hi:[1,0,0]
  v_fma_mix_f32 v114, v149, v50, v58 op_sel:[0,0,0] op_sel_hi:[1,0,0]
  v_fma_mix_f32 v115, v149, v51, v59 op_sel:[1,0,0] op_sel_hi:[1,0,0]
  v_mfma_f32_32x32x16_bf16 v[80:95], v[12:15], v[120:123], v[80:95]
  ds_read_b128 v[32:35], v4 offset:2432
  ds_read_b128 v[40:43], v4 offset:384
  v_fma_mix_f32 v116, v150, v52, v60 op_sel:[0,0,0] op_sel_hi:[1,0,0]
  v_fma_mix_f32 v117, v150, v53, v61 op_sel:[1,0,0] op_sel_hi:[1,0,0]
  v_fma_mix_f32 v118, v151, v54, v62 op_sel:[0,0,0] op_sel_hi:[1,0,0]
  v_fma_mix_f32 v119, v151, v55, v63 op_sel:[1,0,0] op_sel_hi:[1,0,0]
  ds_read_b128 v[36:39], v4 offset:2448
  ds_read_b128 v[44:47], v4 offset:400
  v_mfma_f32_32x32x16_bf16 v[96:111], v[120:123], v[16:19], v[96:111]
  buffer_load_dwordx4 v[168:171], v3, s[24:27], s28 offen offset:2048 sc1
  v_cvt_pk_bf16_f32 v124, v112, v113
  v_cvt_pk_bf16_f32 v125, v114, v115
  v_cvt_pk_bf16_f32 v126, v116, v117
  v_cvt_pk_bf16_f32 v127, v118, v119
  s_waitcnt lgkmcnt(0)
  s_waitcnt vmcnt(4)
  v_mfma_f32_32x32x16_bf16 v[64:79], v[20:23], v[124:127], v[64:79]
  ds_read_b128 v[8:11], v3 offset:18432
  ds_read_b128 v[12:15], v3 offset:19456
  ds_read_b128 v[16:19], v3 offset:20480
  v_fma_mix_f32 v112, v152, v32, v40 op_sel:[0,0,0] op_sel_hi:[1,0,0]
  v_fma_mix_f32 v113, v152, v33, v41 op_sel:[1,0,0] op_sel_hi:[1,0,0]
  v_fma_mix_f32 v114, v153, v34, v42 op_sel:[0,0,0] op_sel_hi:[1,0,0]
  v_fma_mix_f32 v115, v153, v35, v43 op_sel:[1,0,0] op_sel_hi:[1,0,0]
  v_mfma_f32_32x32x16_bf16 v[80:95], v[24:27], v[124:127], v[80:95]
  ds_read_b128 v[48:51], v4 offset:2496
  ds_read_b128 v[56:59], v4 offset:448
  v_fma_mix_f32 v116, v154, v36, v44 op_sel:[0,0,0] op_sel_hi:[1,0,0]
  v_fma_mix_f32 v117, v154, v37, v45 op_sel:[1,0,0] op_sel_hi:[1,0,0]
  v_fma_mix_f32 v118, v155, v38, v46 op_sel:[0,0,0] op_sel_hi:[1,0,0]
  v_fma_mix_f32 v119, v155, v39, v47 op_sel:[1,0,0] op_sel_hi:[1,0,0]
  ds_read_b128 v[52:55], v4 offset:2512
  ds_read_b128 v[60:63], v4 offset:464
  v_mfma_f32_32x32x16_bf16 v[96:111], v[124:127], v[28:31], v[96:111]
  buffer_load_dwordx4 v[172:175], v3, s[24:27], s28 offen offset:3072 sc1
  v_cvt_pk_bf16_f32 v120, v112, v113
  v_cvt_pk_bf16_f32 v121, v114, v115
  v_cvt_pk_bf16_f32 v122, v116, v117
  v_cvt_pk_bf16_f32 v123, v118, v119
  s_waitcnt lgkmcnt(0)
  s_waitcnt vmcnt(4)
  v_mfma_f32_32x32x16_bf16 v[64:79], v[8:11], v[120:123], v[64:79]
  ds_read_b128 v[20:23], v3 offset:21504
  ds_read_b128 v[24:27], v3 offset:22528
  ds_read_b128 v[28:31], v3 offset:23552
  v_fma_mix_f32 v112, v156, v48, v56 op_sel:[0,0,0] op_sel_hi:[1,0,0]
  v_fma_mix_f32 v113, v156, v49, v57 op_sel:[1,0,0] op_sel_hi:[1,0,0]
  v_fma_mix_f32 v114, v157, v50, v58 op_sel:[0,0,0] op_sel_hi:[1,0,0]
  v_fma_mix_f32 v115, v157, v51, v59 op_sel:[1,0,0] op_sel_hi:[1,0,0]
  v_mfma_f32_32x32x16_bf16 v[80:95], v[12:15], v[120:123], v[80:95]
  ds_read_b128 v[32:35], v4 offset:2560
  ds_read_b128 v[40:43], v4 offset:512
  v_fma_mix_f32 v116, v158, v52, v60 op_sel:[0,0,0] op_sel_hi:[1,0,0]
  v_fma_mix_f32 v117, v158, v53, v61 op_sel:[1,0,0] op_sel_hi:[1,0,0]
  v_fma_mix_f32 v118, v159, v54, v62 op_sel:[0,0,0] op_sel_hi:[1,0,0]
  v_fma_mix_f32 v119, v159, v55, v63 op_sel:[1,0,0] op_sel_hi:[1,0,0]
  ds_read_b128 v[36:39], v4 offset:2576
  ds_read_b128 v[44:47], v4 offset:528
  v_mfma_f32_32x32x16_bf16 v[96:111], v[120:123], v[16:19], v[96:111]
  s_add_u32 s28, s28, 4096
  buffer_load_dwordx4 v[176:179], v3, s[24:27], s28 offen offset:0 sc1
  v_cvt_pk_bf16_f32 v124, v112, v113
  v_cvt_pk_bf16_f32 v125, v114, v115
  v_cvt_pk_bf16_f32 v126, v116, v117
  v_cvt_pk_bf16_f32 v127, v118, v119
  s_barrier
  s_waitcnt lgkmcnt(0)
  s_waitcnt vmcnt(4)
  v_mfma_f32_32x32x16_bf16 v[64:79], v[20:23], v[124:127], v[64:79]
  ds_read_b128 v[8:11], v3 offset:24576
  ds_read_b128 v[12:15], v3 offset:25600
  ds_read_b128 v[16:19], v3 offset:26624
  v_fma_mix_f32 v112, v160, v32, v40 op_sel:[0,0,0] op_sel_hi:[1,0,0]
  v_fma_mix_f32 v113, v160, v33, v41 op_sel:[1,0,0] op_sel_hi:[1,0,0]
  v_fma_mix_f32 v114, v161, v34, v42 op_sel:[0,0,0] op_sel_hi:[1,0,0]
  v_fma_mix_f32 v115, v161, v35, v43 op_sel:[1,0,0] op_sel_hi:[1,0,0]
  v_mfma_f32_32x32x16_bf16 v[80:95], v[24:27], v[124:127], v[80:95]
  ds_read_b128 v[48:51], v4 offset:2624
  ds_read_b128 v[56:59], v4 offset:576
  v_fma_mix_f32 v116, v162, v36, v44 op_sel:[0,0,0] op_sel_hi:[1,0,0]
  v_fma_mix_f32 v117, v162, v37, v45 op_sel:[1,0,0] op_sel_hi:[1,0,0]
  v_fma_mix_f32 v118, v163, v38, v46 op_sel:[0,0,0] op_sel_hi:[1,0,0]
  v_fma_mix_f32 v119, v163, v39, v47 op_sel:[1,0,0] op_sel_hi:[1,0,0]
  ds_read_b128 v[52:55], v4 offset:2640
  ds_read_b128 v[60:63], v4 offset:592
  v_mfma_f32_32x32x16_bf16 v[96:111], v[124:127], v[28:31], v[96:111]
  buffer_load_dwordx4 v[180:183], v3, s[24:27], s28 offen offset:1024 sc1
  v_cvt_pk_bf16_f32 v120, v112, v113
  v_cvt_pk_bf16_f32 v121, v114, v115
  v_cvt_pk_bf16_f32 v122, v116, v117
  v_cvt_pk_bf16_f32 v123, v118, v119
  s_waitcnt lgkmcnt(0)
  s_waitcnt vmcnt(4)
  v_mfma_f32_32x32x16_bf16 v[64:79], v[8:11], v[120:123], v[64:79]
  ds_read_b128 v[20:23], v3 offset:27648
  ds_read_b128 v[24:27], v3 offset:28672
  ds_read_b128 v[28:31], v3 offset:29696
  v_fma_mix_f32 v112, v164, v48, v56 op_sel:[0,0,0] op_sel_hi:[1,0,0]
  v_fma_mix_f32 v113, v164, v49, v57 op_sel:[1,0,0] op_sel_hi:[1,0,0]
  v_fma_mix_f32 v114, v165, v50, v58 op_sel:[0,0,0] op_sel_hi:[1,0,0]
  v_fma_mix_f32 v115, v165, v51, v59 op_sel:[1,0,0] op_sel_hi:[1,0,0]
  v_mfma_f32_32x32x16_bf16 v[80:95], v[12:15], v[120:123], v[80:95]
  ds_read_b128 v[32:35], v4 offset:2688
  ds_read_b128 v[40:43], v4 offset:640
  v_fma_mix_f32 v116, v166, v52, v60 op_sel:[0,0,0] op_sel_hi:[1,0,0]
  v_fma_mix_f32 v117, v166, v53, v61 op_sel:[1,0,0] op_sel_hi:[1,0,0]
  v_fma_mix_f32 v118, v167, v54, v62 op_sel:[0,0,0] op_sel_hi:[1,0,0]
  v_fma_mix_f32 v119, v167, v55, v63 op_sel:[1,0,0] op_sel_hi:[1,0,0]
  ds_read_b128 v[36:39], v4 offset:2704
  ds_read_b128 v[44:47], v4 offset:656
  v_mfma_f32_32x32x16_bf16 v[96:111], v[120:123], v[16:19], v[96:111]
  buffer_load_dwordx4 v[184:187], v3, s[24:27], s28 offen offset:2048 sc1
  v_cvt_pk_bf16_f32 v124, v112, v113
  v_cvt_pk_bf16_f32 v125, v114, v115
  v_cvt_pk_bf16_f32 v126, v116, v117
  v_cvt_pk_bf16_f32 v127, v118, v119
  s_waitcnt lgkmcnt(0)
  s_waitcnt vmcnt(4)
  v_mfma_f32_32x32x16_bf16 v[64:79], v[20:23], v[124:127], v[64:79]
  ds_read_b128 v[8:11], v3 offset:30720
  ds_read_b128 v[12:15], v3 offset:31744
  ds_read_b128 v[16:19], v3 offset:32768
  v_fma_mix_f32 v112, v168, v32, v40 op_sel:[0,0,0] op_sel_hi:[1,0,0]
  v_fma_mix_f32 v113, v168, v33, v41 op_sel:[1,0,0] op_sel_hi:[1,0,0]
  v_fma_mix_f32 v114, v169, v34, v42 op_sel:[0,0,0] op_sel_hi:[1,0,0]
  v_fma_mix_f32 v115, v169, v35, v43 op_sel:[1,0,0] op_sel_hi:[1,0,0]
  v_mfma_f32_32x32x16_bf16 v[80:95], v[24:27], v[124:127], v[80:95]
  ds_read_b128 v[48:51], v4 offset:2752
  ds_read_b128 v[56:59], v4 offset:704
  v_fma_mix_f32 v116, v170, v36, v44 op_sel:[0,0,0] op_sel_hi:[1,0,0]
  v_fma_mix_f32 v117, v170, v37, v45 op_sel:[1,0,0] op_sel_hi:[1,0,0]
  v_fma_mix_f32 v118, v171, v38, v46 op_sel:[0,0,0] op_sel_hi:[1,0,0]
  v_fma_mix_f32 v119, v171, v39, v47 op_sel:[1,0,0] op_sel_hi:[1,0,0]
  ds_read_b128 v[52:55], v4 offset:2768
  ds_read_b128 v[60:63], v4 offset:720
  v_mfma_f32_32x32x16_bf16 v[96:111], v[124:127], v[28:31], v[96:111]
  buffer_load_dwordx4 v[188:191], v3, s[24:27], s28 offen offset:3072 sc1
  v_cvt_pk_bf16_f32 v120, v112, v113
  v_cvt_pk_bf16_f32 v121, v114, v115
  v_cvt_pk_bf16_f32 v122, v116, v117
  v_cvt_pk_bf16_f32 v123, v118, v119
  s_waitcnt lgkmcnt(0)
  s_waitcnt vmcnt(4)
  v_mfma_f32_32x32x16_bf16 v[64:79], v[8:11], v[120:123], v[64:79]
  ds_read_b128 v[20:23], v3 offset:33792
  ds_read_b128 v[24:27], v3 offset:34816
  ds_read_b128 v[28:31], v3 offset:35840
  v_fma_mix_f32 v112, v172, v48, v56 op_sel:[0,0,0] op_sel_hi:[1,0,0]
  v_fma_mix_f32 v113, v172, v49, v57 op_sel:[1,0,0] op_sel_hi:[1,0,0]
  v_fma_mix_f32 v114, v173, v50, v58 op_sel:[0,0,0] op_sel_hi:[1,0,0]
  v_fma_mix_f32 v115, v173, v51, v59 op_sel:[1,0,0] op_sel_hi:[1,0,0]
  v_mfma_f32_32x32x16_bf16 v[80:95], v[12:15], v[120:123], v[80:95]
  ds_read_b128 v[32:35], v4 offset:2816
  ds_read_b128 v[40:43], v4 offset:768
  v_fma_mix_f32 v116, v174, v52, v60 op_sel:[0,0,0] op_sel_hi:[1,0,0]
  v_fma_mix_f32 v117, v174, v53, v61 op_sel:[1,0,0] op_sel_hi:[1,0,0]
  v_fma_mix_f32 v118, v175, v54, v62 op_sel:[0,0,0] op_sel_hi:[1,0,0]
  v_fma_mix_f32 v119, v175, v55, v63 op_sel:[1,0,0] op_sel_hi:[1,0,0]
  ds_read_b128 v[36:39], v4 offset:2832
  ds_read_b128 v[44:47], v4 offset:784
  v_mfma_f32_32x32x16_bf16 v[96:111], v[120:123], v[16:19], v[96:111]
  s_add_u32 s28, s28, 4096
  buffer_load_dwordx4 v[192:195], v3, s[24:27], s28 offen offset:0 sc1
  v_cvt_pk_bf16_f32 v124, v112, v113
  v_cvt_pk_bf16_f32 v125, v114, v115
  v_cvt_pk_bf16_f32 v126, v116, v117
  v_cvt_pk_bf16_f32 v127, v118, v119
  s_barrier
  s_waitcnt lgkmcnt(0)
  s_waitcnt vmcnt(4)
  v_mfma_f32_32x32x16_bf16 v[64:79], v[20:23], v[124:127], v[64:79]
  ds_read_b128 v[8:11], v3 offset:36864
  ds_read_b128 v[12:15], v3 offset:37888
  ds_read_b128 v[16:19], v3 offset:38912
  v_fma_mix_f32 v112, v176, v32, v40 op_sel:[0,0,0] op_sel_hi:[1,0,0]
  v_fma_mix_f32 v113, v176, v33, v41 op_sel:[1,0,0] op_sel_hi:[1,0,0]
  v_fma_mix_f32 v114, v177, v34, v42 op_sel:[0,0,0] op_sel_hi:[1,0,0]
  v_fma_mix_f32 v115, v177, v35, v43 op_sel:[1,0,0] op_sel_hi:[1,0,0]
  v_mfma_f32_32x32x16_bf16 v[80:95], v[24:27], v[124:127], v[80:95]
  ds_read_b128 v[48:51], v4 offset:2880
  ds_read_b128 v[56:59], v4 offset:832
  v_fma_mix_f32 v116, v178, v36, v44 op_sel:[0,0,0] op_sel_hi:[1,0,0]
  v_fma_mix_f32 v117, v178, v37, v45 op_sel:[1,0,0] op_sel_hi:[1,0,0]
  v_fma_mix_f32 v118, v179, v38, v46 op_sel:[0,0,0] op_sel_hi:[1,0,0]
  v_fma_mix_f32 v119, v179, v39, v47 op_sel:[1,0,0] op_sel_hi:[1,0,0]
  ds_read_b128 v[52:55], v4 offset:2896
  ds_read_b128 v[60:63], v4 offset:848
  v_mfma_f32_32x32x16_bf16 v[96:111], v[124:127], v[28:31], v[96:111]
  buffer_load_dwordx4 v[196:199], v3, s[24:27], s28 offen offset:1024 sc1
  v_cvt_pk_bf16_f32 v120, v112, v113
  v_cvt_pk_bf16_f32 v121, v114, v115
  v_cvt_pk_bf16_f32 v122, v116, v117
  v_cvt_pk_bf16_f32 v123, v118, v119
  s_waitcnt lgkmcnt(0)
  s_waitcnt vmcnt(4)
  v_mfma_f32_32x32x16_bf16 v[64:79], v[8:11], v[120:123], v[64:79]
  ds_read_b128 v[20:23], v3 offset:39936
  ds_read_b128 v[24:27], v3 offset:40960
  ds_read_b128 v[28:31], v3 offset:41984
  v_fma_mix_f32 v112, v180, v48, v56 op_sel:[0,0,0] op_sel_hi:[1,0,0]
  v_fma_mix_f32 v113, v180, v49, v57 op_sel:[1,0,0] op_sel_hi:[1,0,0]
  v_fma_mix_f32 v114, v181, v50, v58 op_sel:[0,0,0] op_sel_hi:[1,0,0]
  v_fma_mix_f32 v115, v181, v51, v59 op_sel:[1,0,0] op_sel_hi:[1,0,0]
  v_mfma_f32_32x32x16_bf16 v[80:95], v[12:15], v[120:123], v[80:95]
  ds_read_b128 v[32:35], v4 offset:2944
  ds_read_b128 v[40:43], v4 offset:896
  v_fma_mix_f32 v116, v182, v52, v60 op_sel:[0,0,0] op_sel_hi:[1,0,0]
  v_fma_mix_f32 v117, v182, v53, v61 op_sel:[1,0,0] op_sel_hi:[1,0,0]
  v_fma_mix_f32 v118, v183, v54, v62 op_sel:[0,0,0] op_sel_hi:[1,0,0]
  v_fma_mix_f32 v119, v183, v55, v63 op_sel:[1,0,0] op_sel_hi:[1,0,0]
  ds_read_b128 v[36:39], v4 offset:2960
  ds_read_b128 v[44:47], v4 offset:912
  v_mfma_f32_32x32x16_bf16 v[96:111], v[120:123], v[16:19], v[96:111]
  buffer_load_dwordx4 v[200:203], v3, s[24:27], s28 offen offset:2048 sc1
  v_cvt_pk_bf16_f32 v124, v112, v113
  v_cvt_pk_bf16_f32 v125, v114, v115
  v_cvt_pk_bf16_f32 v126, v116, v117
  v_cvt_pk_bf16_f32 v127, v118, v119
  s_waitcnt lgkmcnt(0)
  s_waitcnt vmcnt(4)
  v_mfma_f32_32x32x16_bf16 v[64:79], v[20:23], v[124:127], v[64:79]
  ds_read_b128 v[8:11], v3 offset:43008
  ds_read_b128 v[12:15], v3 offset:44032
  ds_read_b128 v[16:19], v3 offset:45056
  v_fma_mix_f32 v112, v184, v32, v40 op_sel:[0,0,0] op_sel_hi:[1,0,0]
  v_fma_mix_f32 v113, v184, v33, v41 op_sel:[1,0,0] op_sel_hi:[1,0,0]
  v_fma_mix_f32 v114, v185, v34, v42 op_sel:[0,0,0] op_sel_hi:[1,0,0]
  v_fma_mix_f32 v115, v185, v35, v43 op_sel:[1,0,0] op_sel_hi:[1,0,0]
  v_mfma_f32_32x32x16_bf16 v[80:95], v[24:27], v[124:127], v[80:95]
  ds_read_b128 v[48:51], v4 offset:3008
  ds_read_b128 v[56:59], v4 offset:960
  v_fma_mix_f32 v116, v186, v36, v44 op_sel:[0,0,0] op_sel_hi:[1,0,0]
  v_fma_mix_f32 v117, v186, v37, v45 op_sel:[1,0,0] op_sel_hi:[1,0,0]
  v_fma_mix_f32 v118, v187, v38, v46 op_sel:[0,0,0] op_sel_hi:[1,0,0]
  v_fma_mix_f32 v119, v187, v39, v47 op_sel:[1,0,0] op_sel_hi:[1,0,0]
  ds_read_b128 v[52:55], v4 offset:3024
  ds_read_b128 v[60:63], v4 offset:976
  v_mfma_f32_32x32x16_bf16 v[96:111], v[124:127], v[28:31], v[96:111]
  buffer_load_dwordx4 v[204:207], v3, s[24:27], s28 offen offset:3072 sc1
  v_cvt_pk_bf16_f32 v120, v112, v113
  v_cvt_pk_bf16_f32 v121, v114, v115
  v_cvt_pk_bf16_f32 v122, v116, v117
  v_cvt_pk_bf16_f32 v123, v118, v119
  s_waitcnt lgkmcnt(0)
  s_waitcnt vmcnt(4)
  v_mfma_f32_32x32x16_bf16 v[64:79], v[8:11], v[120:123], v[64:79]
  ds_read_b128 v[20:23], v3 offset:46080
  ds_read_b128 v[24:27], v3 offset:47104
  ds_read_b128 v[28:31], v3 offset:48128
  v_fma_mix_f32 v112, v188, v48, v56 op_sel:[0,0,0] op_sel_hi:[1,0,0]
  v_fma_mix_f32 v113, v188, v49, v57 op_sel:[1,0,0] op_sel_hi:[1,0,0]
  v_fma_mix_f32 v114, v189, v50, v58 op_sel:[0,0,0] op_sel_hi:[1,0,0]
  v_fma_mix_f32 v115, v189, v51, v59 op_sel:[1,0,0] op_sel_hi:[1,0,0]
  v_mfma_f32_32x32x16_bf16 v[80:95], v[12:15], v[120:123], v[80:95]
  ds_read_b128 v[32:35], v4 offset:3072
  ds_read_b128 v[40:43], v4 offset:1024
  v_fma_mix_f32 v116, v190, v52, v60 op_sel:[0,0,0] op_sel_hi:[1,0,0]
  v_fma_mix_f32 v117, v190, v53, v61 op_sel:[1,0,0] op_sel_hi:[1,0,0]
  v_fma_mix_f32 v118, v191, v54, v62 op_sel:[0,0,0] op_sel_hi:[1,0,0]
  v_fma_mix_f32 v119, v191, v55, v63 op_sel:[1,0,0] op_sel_hi:[1,0,0]
  ds_read_b128 v[36:39], v4 offset:3088
  ds_read_b128 v[44:47], v4 offset:1040
  v_mfma_f32_32x32x16_bf16 v[96:111], v[120:123], v[16:19], v[96:111]
  s_add_u32 s28, s28, 4096
  buffer_load_dwordx4 v[208:211], v3, s[24:27], s28 offen offset:0 sc1
  v_cvt_pk_bf16_f32 v124, v112, v113
  v_cvt_pk_bf16_f32 v125, v114, v115
  v_cvt_pk_bf16_f32 v126, v116, v117
  v_cvt_pk_bf16_f32 v127, v118, v119
  s_barrier
  s_waitcnt lgkmcnt(0)
  s_waitcnt vmcnt(4)
  v_mfma_f32_32x32x16_bf16 v[64:79], v[20:23], v[124:127], v[64:79]
  ds_read_b128 v[8:11], v3 offset:49152
  ds_read_b128 v[12:15], v3 offset:50176
  ds_read_b128 v[16:19], v3 offset:51200
  v_fma_mix_f32 v112, v192, v32, v40 op_sel:[0,0,0] op_sel_hi:[1,0,0]
  v_fma_mix_f32 v113, v192, v33, v41 op_sel:[1,0,0] op_sel_hi:[1,0,0]
  v_fma_mix_f32 v114, v193, v34, v42 op_sel:[0,0,0] op_sel_hi:[1,0,0]
  v_fma_mix_f32 v115, v193, v35, v43 op_sel:[1,0,0] op_sel_hi:[1,0,0]
  v_mfma_f32_32x32x16_bf16 v[80:95], v[24:27], v[124:127], v[80:95]
  ds_read_b128 v[48:51], v4 offset:3136
  ds_read_b128 v[56:59], v4 offset:1088
  v_fma_mix_f32 v116, v194, v36, v44 op_sel:[0,0,0] op_sel_hi:[1,0,0]
  v_fma_mix_f32 v117, v194, v37, v45 op_sel:[1,0,0] op_sel_hi:[1,0,0]
  v_fma_mix_f32 v118, v195, v38, v46 op_sel:[0,0,0] op_sel_hi:[1,0,0]
  v_fma_mix_f32 v119, v195, v39, v47 op_sel:[1,0,0] op_sel_hi:[1,0,0]
  ds_read_b128 v[52:55], v4 offset:3152
  ds_read_b128 v[60:63], v4 offset:1104
  v_mfma_f32_32x32x16_bf16 v[96:111], v[124:127], v[28:31], v[96:111]
  buffer_load_dwordx4 v[212:215], v3, s[24:27], s28 offen offset:1024 sc1
  v_cvt_pk_bf16_f32 v120, v112, v113
  v_cvt_pk_bf16_f32 v121, v114, v115
  v_cvt_pk_bf16_f32 v122, v116, v117
  v_cvt_pk_bf16_f32 v123, v118, v119
  s_waitcnt lgkmcnt(0)
  s_waitcnt vmcnt(4)
  v_mfma_f32_32x32x16_bf16 v[64:79], v[8:11], v[120:123], v[64:79]
  ds_read_b128 v[20:23], v3 offset:52224
  ds_read_b128 v[24:27], v3 offset:53248
  ds_read_b128 v[28:31], v3 offset:54272
  v_fma_mix_f32 v112, v196, v48, v56 op_sel:[0,0,0] op_sel_hi:[1,0,0]
  v_fma_mix_f32 v113, v196, v49, v57 op_sel:[1,0,0] op_sel_hi:[1,0,0]
  v_fma_mix_f32 v114, v197, v50, v58 op_sel:[0,0,0] op_sel_hi:[1,0,0]
  v_fma_mix_f32 v115, v197, v51, v59 op_sel:[1,0,0] op_sel_hi:[1,0,0]
  v_mfma_f32_32x32x16_bf16 v[80:95], v[12:15], v[120:123], v[80:95]
  ds_read_b128 v[32:35], v4 offset:3200
  ds_read_b128 v[40:43], v4 offset:1152
  v_fma_mix_f32 v116, v198, v52, v60 op_sel:[0,0,0] op_sel_hi:[1,0,0]
  v_fma_mix_f32 v117, v198, v53, v61 op_sel:[1,0,0] op_sel_hi:[1,0,0]
  v_fma_mix_f32 v118, v199, v54, v62 op_sel:[0,0,0] op_sel_hi:[1,0,0]
  v_fma_mix_f32 v119, v199, v55, v63 op_sel:[1,0,0] op_sel_hi:[1,0,0]
  ds_read_b128 v[36:39], v4 offset:3216
  ds_read_b128 v[44:47], v4 offset:1168
  v_mfma_f32_32x32x16_bf16 v[96:111], v[120:123], v[16:19], v[96:111]
  buffer_load_dwordx4 v[216:219], v3, s[24:27], s28 offen offset:2048 sc1
  v_cvt_pk_bf16_f32 v124, v112, v113
  v_cvt_pk_bf16_f32 v125, v114, v115
  v_cvt_pk_bf16_f32 v126, v116, v117
  v_cvt_pk_bf16_f32 v127, v118, v119
  s_waitcnt lgkmcnt(0)
  s_waitcnt vmcnt(4)
  v_mfma_f32_32x32x16_bf16 v[64:79], v[20:23], v[124:127], v[64:79]
  ds_read_b128 v[8:11], v3 offset:55296
  ds_read_b128 v[12:15], v3 offset:56320
  ds_read_b128 v[16:19], v3 offset:57344
  v_fma_mix_f32 v112, v200, v32, v40 op_sel:[0,0,0] op_sel_hi:[1,0,0]
  v_fma_mix_f32 v113, v200, v33, v41 op_sel:[1,0,0] op_sel_hi:[1,0,0]
  v_fma_mix_f32 v114, v201, v34, v42 op_sel:[0,0,0] op_sel_hi:[1,0,0]
  v_fma_mix_f32 v115, v201, v35, v43 op_sel:[1,0,0] op_sel_hi:[1,0,0]
  v_mfma_f32_32x32x16_bf16 v[80:95], v[24:27], v[124:127], v[80:95]
  ds_read_b128 v[48:51], v4 offset:3264
  ds_read_b128 v[56:59], v4 offset:1216
  v_fma_mix_f32 v116, v202, v36, v44 op_sel:[0,0,0] op_sel_hi:[1,0,0]
  v_fma_mix_f32 v117, v202, v37, v45 op_sel:[1,0,0] op_sel_hi:[1,0,0]
  v_fma_mix_f32 v118, v203, v38, v46 op_sel:[0,0,0] op_sel_hi:[1,0,0]
  v_fma_mix_f32 v119, v203, v39, v47 op_sel:[1,0,0] op_sel_hi:[1,0,0]
  ds_read_b128 v[52:55], v4 offset:3280
  ds_read_b128 v[60:63], v4 offset:1232
  v_mfma_f32_32x32x16_bf16 v[96:111], v[124:127], v[28:31], v[96:111]
  buffer_load_dwordx4 v[220:223], v3, s[24:27], s28 offen offset:3072 sc1
  v_cvt_pk_bf16_f32 v120, v112, v113
  v_cvt_pk_bf16_f32 v121, v114, v115
  v_cvt_pk_bf16_f32 v122, v116, v117
  v_cvt_pk_bf16_f32 v123, v118, v119
  s_waitcnt lgkmcnt(0)
  s_waitcnt vmcnt(4)
  v_mfma_f32_32x32x16_bf16 v[64:79], v[8:11], v[120:123], v[64:79]
  ds_read_b128 v[20:23], v3 offset:58368
  ds_read_b128 v[24:27], v3 offset:59392
  ds_read_b128 v[28:31], v3 offset:60416
  v_fma_mix_f32 v112, v204, v48, v56 op_sel:[0,0,0] op_sel_hi:[1,0,0]
  v_fma_mix_f32 v113, v204, v49, v57 op_sel:[1,0,0] op_sel_hi:[1,0,0]
  v_fma_mix_f32 v114, v205, v50, v58 op_sel:[0,0,0] op_sel_hi:[1,0,0]
  v_fma_mix_f32 v115, v205, v51, v59 op_sel:[1,0,0] op_sel_hi:[1,0,0]
  v_mfma_f32_32x32x16_bf16 v[80:95], v[12:15], v[120:123], v[80:95]
  ds_read_b128 v[32:35], v4 offset:3328
  ds_read_b128 v[40:43], v4 offset:1280
  v_fma_mix_f32 v116, v206, v52, v60 op_sel:[0,0,0] op_sel_hi:[1,0,0]
  v_fma_mix_f32 v117, v206, v53, v61 op_sel:[1,0,0] op_sel_hi:[1,0,0]
  v_fma_mix_f32 v118, v207, v54, v62 op_sel:[0,0,0] op_sel_hi:[1,0,0]
  v_fma_mix_f32 v119, v207, v55, v63 op_sel:[1,0,0] op_sel_hi:[1,0,0]
  ds_read_b128 v[36:39], v4 offset:3344
  ds_read_b128 v[44:47], v4 offset:1296
  v_mfma_f32_32x32x16_bf16 v[96:111], v[120:123], v[16:19], v[96:111]
  s_add_u32 s28, s28, 4096
  buffer_load_dwordx4 v[224:227], v3, s[24:27], s28 offen offset:0 sc1
  v_cvt_pk_bf16_f32 v124, v112, v113
  v_cvt_pk_bf16_f32 v125, v114, v115
  v_cvt_pk_bf16_f32 v126, v116, v117
  v_cvt_pk_bf16_f32 v127, v118, v119
  s_barrier
  s_waitcnt lgkmcnt(0)
  s_waitcnt vmcnt(4)
  v_mfma_f32_32x32x16_bf16 v[64:79], v[20:23], v[124:127], v[64:79]
  ds_read_b128 v[8:11], v3 offset:61440
  ds_read_b128 v[12:15], v3 offset:62464
  ds_read_b128 v[16:19], v3 offset:63488
  v_fma_mix_f32 v112, v208, v32, v40 op_sel:[0,0,0] op_sel_hi:[1,0,0]
  v_fma_mix_f32 v113, v208, v33, v41 op_sel:[1,0,0] op_sel_hi:[1,0,0]
  v_fma_mix_f32 v114, v209, v34, v42 op_sel:[0,0,0] op_sel_hi:[1,0,0]
  v_fma_mix_f32 v115, v209, v35, v43 op_sel:[1,0,0] op_sel_hi:[1,0,0]
  v_mfma_f32_32x32x16_bf16 v[80:95], v[24:27], v[124:127], v[80:95]
  ds_read_b128 v[48:51], v4 offset:3392
  ds_read_b128 v[56:59], v4 offset:1344
  v_fma_mix_f32 v116, v210, v36, v44 op_sel:[0,0,0] op_sel_hi:[1,0,0]
  v_fma_mix_f32 v117, v210, v37, v45 op_sel:[1,0,0] op_sel_hi:[1,0,0]
  v_fma_mix_f32 v118, v211, v38, v46 op_sel:[0,0,0] op_sel_hi:[1,0,0]
  v_fma_mix_f32 v119, v211, v39, v47 op_sel:[1,0,0] op_sel_hi:[1,0,0]
  ds_read_b128 v[52:55], v4 offset:3408
  ds_read_b128 v[60:63], v4 offset:1360
  v_mfma_f32_32x32x16_bf16 v[96:111], v[124:127], v[28:31], v[96:111]
  buffer_load_dwordx4 v[228:231], v3, s[24:27], s28 offen offset:1024 sc1
  v_cvt_pk_bf16_f32 v120, v112, v113
  v_cvt_pk_bf16_f32 v121, v114, v115
  v_cvt_pk_bf16_f32 v122, v116, v117
  v_cvt_pk_bf16_f32 v123, v118, v119
  s_waitcnt lgkmcnt(0)
  s_waitcnt vmcnt(4)
  v_mfma_f32_32x32x16_bf16 v[64:79], v[8:11], v[120:123], v[64:79]
  ds_read_b128 v[20:23], v3 offset:64512
  ds_read_b128 v[24:27], v5 offset:0
  ds_read_b128 v[28:31], v5 offset:1024
  v_fma_mix_f32 v112, v212, v48, v56 op_sel:[0,0,0] op_sel_hi:[1,0,0]
  v_fma_mix_f32 v113, v212, v49, v57 op_sel:[1,0,0] op_sel_hi:[1,0,0]
  v_fma_mix_f32 v114, v213, v50, v58 op_sel:[0,0,0] op_sel_hi:[1,0,0]
  v_fma_mix_f32 v115, v213, v51, v59 op_sel:[1,0,0] op_sel_hi:[1,0,0]
  v_mfma_f32_32x32x16_bf16 v[80:95], v[12:15], v[120:123], v[80:95]
  ds_read_b128 v[32:35], v4 offset:3456
  ds_read_b128 v[40:43], v4 offset:1408
  v_fma_mix_f32 v116, v214, v52, v60 op_sel:[0,0,0] op_sel_hi:[1,0,0]
  v_fma_mix_f32 v117, v214, v53, v61 op_sel:[1,0,0] op_sel_hi:[1,0,0]
  v_fma_mix_f32 v118, v215, v54, v62 op_sel:[0,0,0] op_sel_hi:[1,0,0]
  v_fma_mix_f32 v119, v215, v55, v63 op_sel:[1,0,0] op_sel_hi:[1,0,0]
  ds_read_b128 v[36:39], v4 offset:3472
  ds_read_b128 v[44:47], v4 offset:1424
  v_mfma_f32_32x32x16_bf16 v[96:111], v[120:123], v[16:19], v[96:111]
  buffer_load_dwordx4 v[232:235], v3, s[24:27], s28 offen offset:2048 sc1
  v_cvt_pk_bf16_f32 v124, v112, v113
  v_cvt_pk_bf16_f32 v125, v114, v115
  v_cvt_pk_bf16_f32 v126, v116, v117
  v_cvt_pk_bf16_f32 v127, v118, v119
  s_waitcnt lgkmcnt(0)
  s_waitcnt vmcnt(4)
  v_mfma_f32_32x32x16_bf16 v[64:79], v[20:23], v[124:127], v[64:79]
  ds_read_b128 v[8:11], v5 offset:2048
  ds_read_b128 v[12:15], v5 offset:3072
  ds_read_b128 v[16:19], v5 offset:4096
  v_fma_mix_f32 v112, v216, v32, v40 op_sel:[0,0,0] op_sel_hi:[1,0,0]
  v_fma_mix_f32 v113, v216, v33, v41 op_sel:[1,0,0] op_sel_hi:[1,0,0]
  v_fma_mix_f32 v114, v217, v34, v42 op_sel:[0,0,0] op_sel_hi:[1,0,0]
  v_fma_mix_f32 v115, v217, v35, v43 op_sel:[1,0,0] op_sel_hi:[1,0,0]
  v_mfma_f32_32x32x16_bf16 v[80:95], v[24:27], v[124:127], v[80:95]
  ds_read_b128 v[48:51], v4 offset:3520
  ds_read_b128 v[56:59], v4 offset:1472
  v_fma_mix_f32 v116, v218, v36, v44 op_sel:[0,0,0] op_sel_hi:[1,0,0]
  v_fma_mix_f32 v117, v218, v37, v45 op_sel:[1,0,0] op_sel_hi:[1,0,0]
  v_fma_mix_f32 v118, v219, v38, v46 op_sel:[0,0,0] op_sel_hi:[1,0,0]
  v_fma_mix_f32 v119, v219, v39, v47 op_sel:[1,0,0] op_sel_hi:[1,0,0]
  ds_read_b128 v[52:55], v4 offset:3536
  ds_read_b128 v[60:63], v4 offset:1488
  v_mfma_f32_32x32x16_bf16 v[96:111], v[124:127], v[28:31], v[96:111]
  buffer_load_dwordx4 v[236:239], v3, s[24:27], s28 offen offset:3072 sc1
  v_cvt_pk_bf16_f32 v120, v112, v113
  v_cvt_pk_bf16_f32 v121, v114, v115
  v_cvt_pk_bf16_f32 v122, v116, v117
  v_cvt_pk_bf16_f32 v123, v118, v119
  s_waitcnt lgkmcnt(0)
  s_waitcnt vmcnt(4)
  v_mfma_f32_32x32x16_bf16 v[64:79], v[8:11], v[120:123], v[64:79]
  ds_read_b128 v[20:23], v5 offset:5120
  ds_read_b128 v[24:27], v5 offset:6144
  ds_read_b128 v[28:31], v5 offset:7168
  v_fma_mix_f32 v112, v220, v48, v56 op_sel:[0,0,0] op_sel_hi:[1,0,0]
  v_fma_mix_f32 v113, v220, v49, v57 op_sel:[1,0,0] op_sel_hi:[1,0,0]
  v_fma_mix_f32 v114, v221, v50, v58 op_sel:[0,0,0] op_sel_hi:[1,0,0]
  v_fma_mix_f32 v115, v221, v51, v59 op_sel:[1,0,0] op_sel_hi:[1,0,0]
  v_mfma_f32_32x32x16_bf16 v[80:95], v[12:15], v[120:123], v[80:95]
  ds_read_b128 v[32:35], v4 offset:3584
  ds_read_b128 v[40:43], v4 offset:1536
  v_fma_mix_f32 v116, v222, v52, v60 op_sel:[0,0,0] op_sel_hi:[1,0,0]
  v_fma_mix_f32 v117, v222, v53, v61 op_sel:[1,0,0] op_sel_hi:[1,0,0]
  v_fma_mix_f32 v118, v223, v54, v62 op_sel:[0,0,0] op_sel_hi:[1,0,0]
  v_fma_mix_f32 v119, v223, v55, v63 op_sel:[1,0,0] op_sel_hi:[1,0,0]
  ds_read_b128 v[36:39], v4 offset:3600
  ds_read_b128 v[44:47], v4 offset:1552
  v_mfma_f32_32x32x16_bf16 v[96:111], v[120:123], v[16:19], v[96:111]
  s_add_u32 s28, s28, 4096
  buffer_load_dwordx4 v[240:243], v3, s[24:27], s28 offen offset:0 sc1
  v_cvt_pk_bf16_f32 v124, v112, v113
  v_cvt_pk_bf16_f32 v125, v114, v115
  v_cvt_pk_bf16_f32 v126, v116, v117
  v_cvt_pk_bf16_f32 v127, v118, v119
  s_barrier
  s_waitcnt lgkmcnt(0)
  s_waitcnt vmcnt(4)
  v_mfma_f32_32x32x16_bf16 v[64:79], v[20:23], v[124:127], v[64:79]
  ds_read_b128 v[8:11], v5 offset:8192
  ds_read_b128 v[12:15], v5 offset:9216
  ds_read_b128 v[16:19], v5 offset:10240
  v_fma_mix_f32 v112, v224, v32, v40 op_sel:[0,0,0] op_sel_hi:[1,0,0]
  v_fma_mix_f32 v113, v224, v33, v41 op_sel:[1,0,0] op_sel_hi:[1,0,0]
  v_fma_mix_f32 v114, v225, v34, v42 op_sel:[0,0,0] op_sel_hi:[1,0,0]
  v_fma_mix_f32 v115, v225, v35, v43 op_sel:[1,0,0] op_sel_hi:[1,0,0]
  v_mfma_f32_32x32x16_bf16 v[80:95], v[24:27], v[124:127], v[80:95]
  ds_read_b128 v[48:51], v4 offset:3648
  ds_read_b128 v[56:59], v4 offset:1600
  v_fma_mix_f32 v116, v226, v36, v44 op_sel:[0,0,0] op_sel_hi:[1,0,0]
  v_fma_mix_f32 v117, v226, v37, v45 op_sel:[1,0,0] op_sel_hi:[1,0,0]
  v_fma_mix_f32 v118, v227, v38, v46 op_sel:[0,0,0] op_sel_hi:[1,0,0]
  v_fma_mix_f32 v119, v227, v39, v47 op_sel:[1,0,0] op_sel_hi:[1,0,0]
  ds_read_b128 v[52:55], v4 offset:3664
  ds_read_b128 v[60:63], v4 offset:1616
  v_mfma_f32_32x32x16_bf16 v[96:111], v[124:127], v[28:31], v[96:111]
  buffer_load_dwordx4 v[244:247], v3, s[24:27], s28 offen offset:1024 sc1
  v_cvt_pk_bf16_f32 v120, v112, v113
  v_cvt_pk_bf16_f32 v121, v114, v115
  v_cvt_pk_bf16_f32 v122, v116, v117
  v_cvt_pk_bf16_f32 v123, v118, v119
  s_waitcnt lgkmcnt(0)
  s_waitcnt vmcnt(4)
  v_mfma_f32_32x32x16_bf16 v[64:79], v[8:11], v[120:123], v[64:79]
  ds_read_b128 v[20:23], v5 offset:11264
  ds_read_b128 v[24:27], v5 offset:12288
  ds_read_b128 v[28:31], v5 offset:13312
  v_fma_mix_f32 v112, v228, v48, v56 op_sel:[0,0,0] op_sel_hi:[1,0,0]
  v_fma_mix_f32 v113, v228, v49, v57 op_sel:[1,0,0] op_sel_hi:[1,0,0]
  v_fma_mix_f32 v114, v229, v50, v58 op_sel:[0,0,0] op_sel_hi:[1,0,0]
  v_fma_mix_f32 v115, v229, v51, v59 op_sel:[1,0,0] op_sel_hi:[1,0,0]
  v_mfma_f32_32x32x16_bf16 v[80:95], v[12:15], v[120:123], v[80:95]
  ds_read_b128 v[32:35], v4 offset:3712
  ds_read_b128 v[40:43], v4 offset:1664
  v_fma_mix_f32 v116, v230, v52, v60 op_sel:[0,0,0] op_sel_hi:[1,0,0]
  v_fma_mix_f32 v117, v230, v53, v61 op_sel:[1,0,0] op_sel_hi:[1,0,0]
  v_fma_mix_f32 v118, v231, v54, v62 op_sel:[0,0,0] op_sel_hi:[1,0,0]
  v_fma_mix_f32 v119, v231, v55, v63 op_sel:[1,0,0] op_sel_hi:[1,0,0]
  ds_read_b128 v[36:39], v4 offset:3728
  ds_read_b128 v[44:47], v4 offset:1680
  v_mfma_f32_32x32x16_bf16 v[96:111], v[120:123], v[16:19], v[96:111]
  buffer_load_dwordx4 v[248:251], v3, s[24:27], s28 offen offset:2048 sc1
  v_cvt_pk_bf16_f32 v124, v112, v113
  v_cvt_pk_bf16_f32 v125, v114, v115
  v_cvt_pk_bf16_f32 v126, v116, v117
  v_cvt_pk_bf16_f32 v127, v118, v119
  s_waitcnt lgkmcnt(0)
  s_waitcnt vmcnt(4)
  v_mfma_f32_32x32x16_bf16 v[64:79], v[20:23], v[124:127], v[64:79]
  ds_read_b128 v[8:11], v5 offset:14336
  ds_read_b128 v[12:15], v5 offset:15360
  ds_read_b128 v[16:19], v5 offset:16384
  v_fma_mix_f32 v112, v232, v32, v40 op_sel:[0,0,0] op_sel_hi:[1,0,0]
  v_fma_mix_f32 v113, v232, v33, v41 op_sel:[1,0,0] op_sel_hi:[1,0,0]
  v_fma_mix_f32 v114, v233, v34, v42 op_sel:[0,0,0] op_sel_hi:[1,0,0]
  v_fma_mix_f32 v115, v233, v35, v43 op_sel:[1,0,0] op_sel_hi:[1,0,0]
  v_mfma_f32_32x32x16_bf16 v[80:95], v[24:27], v[124:127], v[80:95]
  ds_read_b128 v[48:51], v4 offset:3776
  ds_read_b128 v[56:59], v4 offset:1728
  v_fma_mix_f32 v116, v234, v36, v44 op_sel:[0,0,0] op_sel_hi:[1,0,0]
  v_fma_mix_f32 v117, v234, v37, v45 op_sel:[1,0,0] op_sel_hi:[1,0,0]
  v_fma_mix_f32 v118, v235, v38, v46 op_sel:[0,0,0] op_sel_hi:[1,0,0]
  v_fma_mix_f32 v119, v235, v39, v47 op_sel:[1,0,0] op_sel_hi:[1,0,0]
  ds_read_b128 v[52:55], v4 offset:3792
  ds_read_b128 v[60:63], v4 offset:1744
  v_mfma_f32_32x32x16_bf16 v[96:111], v[124:127], v[28:31], v[96:111]
  buffer_load_dwordx4 v[252:255], v3, s[24:27], s28 offen offset:3072 sc1
  v_cvt_pk_bf16_f32 v120, v112, v113
  v_cvt_pk_bf16_f32 v121, v114, v115
  v_cvt_pk_bf16_f32 v122, v116, v117
  v_cvt_pk_bf16_f32 v123, v118, v119
  s_waitcnt lgkmcnt(0)
  s_waitcnt vmcnt(4)
  v_mfma_f32_32x32x16_bf16 v[64:79], v[8:11], v[120:123], v[64:79]
  ds_read_b128 v[20:23], v5 offset:17408
  ds_read_b128 v[24:27], v5 offset:18432
  ds_read_b128 v[28:31], v5 offset:19456
  v_fma_mix_f32 v112, v236, v48, v56 op_sel:[0,0,0] op_sel_hi:[1,0,0]
  v_fma_mix_f32 v113, v236, v49, v57 op_sel:[1,0,0] op_sel_hi:[1,0,0]
  v_fma_mix_f32 v114, v237, v50, v58 op_sel:[0,0,0] op_sel_hi:[1,0,0]
  v_fma_mix_f32 v115, v237, v51, v59 op_sel:[1,0,0] op_sel_hi:[1,0,0]
  v_mfma_f32_32x32x16_bf16 v[80:95], v[12:15], v[120:123], v[80:95]
  ds_read_b128 v[32:35], v4 offset:3840
  ds_read_b128 v[40:43], v4 offset:1792
  v_fma_mix_f32 v116, v238, v52, v60 op_sel:[0,0,0] op_sel_hi:[1,0,0]
  v_fma_mix_f32 v117, v238, v53, v61 op_sel:[1,0,0] op_sel_hi:[1,0,0]
  v_fma_mix_f32 v118, v239, v54, v62 op_sel:[0,0,0] op_sel_hi:[1,0,0]
  v_fma_mix_f32 v119, v239, v55, v63 op_sel:[1,0,0] op_sel_hi:[1,0,0]
  ds_read_b128 v[36:39], v4 offset:3856
  ds_read_b128 v[44:47], v4 offset:1808
  v_mfma_f32_32x32x16_bf16 v[96:111], v[120:123], v[16:19], v[96:111]
  v_cvt_pk_bf16_f32 v124, v112, v113
  v_cvt_pk_bf16_f32 v125, v114, v115
  v_cvt_pk_bf16_f32 v126, v116, v117
  v_cvt_pk_bf16_f32 v127, v118, v119
  s_barrier
  s_waitcnt lgkmcnt(0)
  s_waitcnt vmcnt(3)
  v_mfma_f32_32x32x16_bf16 v[64:79], v[20:23], v[124:127], v[64:79]
  ds_read_b128 v[8:11], v5 offset:20480
  ds_read_b128 v[12:15], v5 offset:21504
  ds_read_b128 v[16:19], v5 offset:22528
  v_fma_mix_f32 v112, v240, v32, v40 op_sel:[0,0,0] op_sel_hi:[1,0,0]
  v_fma_mix_f32 v113, v240, v33, v41 op_sel:[1,0,0] op_sel_hi:[1,0,0]
  v_fma_mix_f32 v114, v241, v34, v42 op_sel:[0,0,0] op_sel_hi:[1,0,0]
  v_fma_mix_f32 v115, v241, v35, v43 op_sel:[1,0,0] op_sel_hi:[1,0,0]
  v_mfma_f32_32x32x16_bf16 v[80:95], v[24:27], v[124:127], v[80:95]
  ds_read_b128 v[48:51], v4 offset:3904
  ds_read_b128 v[56:59], v4 offset:1856
  v_fma_mix_f32 v116, v242, v36, v44 op_sel:[0,0,0] op_sel_hi:[1,0,0]
  v_fma_mix_f32 v117, v242, v37, v45 op_sel:[1,0,0] op_sel_hi:[1,0,0]
  v_fma_mix_f32 v118, v243, v38, v46 op_sel:[0,0,0] op_sel_hi:[1,0,0]
  v_fma_mix_f32 v119, v243, v39, v47 op_sel:[1,0,0] op_sel_hi:[1,0,0]
  ds_read_b128 v[52:55], v4 offset:3920
  ds_read_b128 v[60:63], v4 offset:1872
  v_mfma_f32_32x32x16_bf16 v[96:111], v[124:127], v[28:31], v[96:111]
  v_cvt_pk_bf16_f32 v120, v112, v113
  v_cvt_pk_bf16_f32 v121, v114, v115
  v_cvt_pk_bf16_f32 v122, v116, v117
  v_cvt_pk_bf16_f32 v123, v118, v119
  s_waitcnt lgkmcnt(0)
  s_waitcnt vmcnt(2)
  v_mfma_f32_32x32x16_bf16 v[64:79], v[8:11], v[120:123], v[64:79]
  ds_read_b128 v[20:23], v5 offset:23552
  ds_read_b128 v[24:27], v5 offset:24576
  ds_read_b128 v[28:31], v5 offset:25600
  v_fma_mix_f32 v112, v244, v48, v56 op_sel:[0,0,0] op_sel_hi:[1,0,0]
  v_fma_mix_f32 v113, v244, v49, v57 op_sel:[1,0,0] op_sel_hi:[1,0,0]
  v_fma_mix_f32 v114, v245, v50, v58 op_sel:[0,0,0] op_sel_hi:[1,0,0]
  v_fma_mix_f32 v115, v245, v51, v59 op_sel:[1,0,0] op_sel_hi:[1,0,0]
  v_mfma_f32_32x32x16_bf16 v[80:95], v[12:15], v[120:123], v[80:95]
  ds_read_b128 v[32:35], v4 offset:3968
  ds_read_b128 v[40:43], v4 offset:1920
  v_fma_mix_f32 v116, v246, v52, v60 op_sel:[0,0,0] op_sel_hi:[1,0,0]
  v_fma_mix_f32 v117, v246, v53, v61 op_sel:[1,0,0] op_sel_hi:[1,0,0]
  v_fma_mix_f32 v118, v247, v54, v62 op_sel:[0,0,0] op_sel_hi:[1,0,0]
  v_fma_mix_f32 v119, v247, v55, v63 op_sel:[1,0,0] op_sel_hi:[1,0,0]
  ds_read_b128 v[36:39], v4 offset:3984
  ds_read_b128 v[44:47], v4 offset:1936
  v_mfma_f32_32x32x16_bf16 v[96:111], v[120:123], v[16:19], v[96:111]
  v_cvt_pk_bf16_f32 v124, v112, v113
  v_cvt_pk_bf16_f32 v125, v114, v115
  v_cvt_pk_bf16_f32 v126, v116, v117
  v_cvt_pk_bf16_f32 v127, v118, v119
  s_waitcnt lgkmcnt(0)
  s_waitcnt vmcnt(1)
  v_mfma_f32_32x32x16_bf16 v[64:79], v[20:23], v[124:127], v[64:79]
  ds_read_b128 v[8:11], v5 offset:26624
  ds_read_b128 v[12:15], v5 offset:27648
  ds_read_b128 v[16:19], v5 offset:28672
  v_fma_mix_f32 v112, v248, v32, v40 op_sel:[0,0,0] op_sel_hi:[1,0,0]
  v_fma_mix_f32 v113, v248, v33, v41 op_sel:[1,0,0] op_sel_hi:[1,0,0]
  v_fma_mix_f32 v114, v249, v34, v42 op_sel:[0,0,0] op_sel_hi:[1,0,0]
  v_fma_mix_f32 v115, v249, v35, v43 op_sel:[1,0,0] op_sel_hi:[1,0,0]
  v_mfma_f32_32x32x16_bf16 v[80:95], v[24:27], v[124:127], v[80:95]
  ds_read_b128 v[48:51], v4 offset:4032
  ds_read_b128 v[56:59], v4 offset:1984
  v_fma_mix_f32 v116, v250, v36, v44 op_sel:[0,0,0] op_sel_hi:[1,0,0]
  v_fma_mix_f32 v117, v250, v37, v45 op_sel:[1,0,0] op_sel_hi:[1,0,0]
  v_fma_mix_f32 v118, v251, v38, v46 op_sel:[0,0,0] op_sel_hi:[1,0,0]
  v_fma_mix_f32 v119, v251, v39, v47 op_sel:[1,0,0] op_sel_hi:[1,0,0]
  ds_read_b128 v[52:55], v4 offset:4048
  ds_read_b128 v[60:63], v4 offset:2000
  v_mfma_f32_32x32x16_bf16 v[96:111], v[124:127], v[28:31], v[96:111]
  v_cvt_pk_bf16_f32 v120, v112, v113
  v_cvt_pk_bf16_f32 v121, v114, v115
  v_cvt_pk_bf16_f32 v122, v116, v117
  v_cvt_pk_bf16_f32 v123, v118, v119
  s_waitcnt lgkmcnt(0)
  s_waitcnt vmcnt(0)
  v_mfma_f32_32x32x16_bf16 v[64:79], v[8:11], v[120:123], v[64:79]
  ds_read_b128 v[20:23], v5 offset:29696
  ds_read_b128 v[24:27], v5 offset:30720
  ds_read_b128 v[28:31], v5 offset:31744
  v_fma_mix_f32 v112, v252, v48, v56 op_sel:[0,0,0] op_sel_hi:[1,0,0]
  v_fma_mix_f32 v113, v252, v49, v57 op_sel:[1,0,0] op_sel_hi:[1,0,0]
  v_fma_mix_f32 v114, v253, v50, v58 op_sel:[0,0,0] op_sel_hi:[1,0,0]
  v_fma_mix_f32 v115, v253, v51, v59 op_sel:[1,0,0] op_sel_hi:[1,0,0]
  v_mfma_f32_32x32x16_bf16 v[80:95], v[12:15], v[120:123], v[80:95]
  v_fma_mix_f32 v116, v254, v52, v60 op_sel:[0,0,0] op_sel_hi:[1,0,0]
  v_fma_mix_f32 v117, v254, v53, v61 op_sel:[1,0,0] op_sel_hi:[1,0,0]
  v_fma_mix_f32 v118, v255, v54, v62 op_sel:[0,0,0] op_sel_hi:[1,0,0]
  v_fma_mix_f32 v119, v255, v55, v63 op_sel:[1,0,0] op_sel_hi:[1,0,0]
  v_mfma_f32_32x32x16_bf16 v[96:111], v[120:123], v[16:19], v[96:111]
  v_cvt_pk_bf16_f32 v124, v112, v113
  v_cvt_pk_bf16_f32 v125, v114, v115
  v_cvt_pk_bf16_f32 v126, v116, v117
  v_cvt_pk_bf16_f32 v127, v118, v119
  s_waitcnt lgkmcnt(0)
  s_nop 0
  v_mfma_f32_32x32x16_bf16 v[64:79], v[20:23], v[124:127], v[64:79]
  v_mfma_f32_32x32x16_bf16 v[80:95], v[24:27], v[124:127], v[80:95]
  v_mfma_f32_32x32x16_bf16 v[96:111], v[124:127], v[28:31], v[96:111]
  s_lshl_b32 s28, s20, 2
  s_add_u32 s28, s28, s22
  s_lshl_b32 s29, s21, 17
  s_lshl_b32 s30, s28, 10
  s_add_u32 s29, s29, s30
  s_mov_b32 s31, 0x3eb8aa3b
  v_and_b32 v6, 15, v2
  v_lshlrev_b32 v6, 4, v6
  v_lshrrev_b32 v7, 5, v2
  v_lshl_add_u32 v6, v7, 8, v6
  v_bfe_u32 v7, v2, 4, 1
  v_lshl_add_u32 v6, v7, 16, v6
  v_mov_b32 v7, s31
  v_mul_f32 v64, v7, v64
  v_mul_f32 v65, v7, v65
  v_mul_f32 v66, v7, v66
  v_mul_f32 v67, v7, v67
  v_mul_f32 v68, v7, v68
  v_mul_f32 v69, v7, v69
  v_mul_f32 v70, v7, v70
  v_mul_f32 v71, v7, v71
  v_mul_f32 v72, v7, v72
  v_mul_f32 v73, v7, v73
  v_mul_f32 v74, v7, v74
  v_mul_f32 v75, v7, v75
  v_mul_f32 v76, v7, v76
  v_mul_f32 v77, v7, v77
  v_mul_f32 v78, v7, v78
  v_mul_f32 v79, v7, v79
  v_cvt_pk_bf16_f32 v8, v64, v65
  v_cvt_pk_bf16_f32 v9, v66, v67
  v_cvt_pk_bf16_f32 v10, v68, v69
  v_cvt_pk_bf16_f32 v11, v70, v71
  v_cvt_pk_bf16_f32 v12, v72, v73
  v_cvt_pk_bf16_f32 v13, v74, v75
  v_cvt_pk_bf16_f32 v14, v76, v77
  v_cvt_pk_bf16_f32 v15, v78, v79
  s_add_u32 s18, s29, 5242880
  buffer_store_dwordx4 v[8:11], v3, s[24:27], s18 offen sc1
  s_add_u32 s18, s29, 5308416
  buffer_store_dwordx4 v[12:15], v3, s[24:27], s18 offen sc1
  v_cvt_pk_bf16_f32 v16, v80, v81
  v_cvt_pk_bf16_f32 v17, v82, v83
  v_cvt_pk_bf16_f32 v18, v84, v85
  v_cvt_pk_bf16_f32 v19, v86, v87
  v_cvt_pk_bf16_f32 v20, v88, v89
  v_cvt_pk_bf16_f32 v21, v90, v91
  v_cvt_pk_bf16_f32 v22, v92, v93
  v_cvt_pk_bf16_f32 v23, v94, v95
  s_add_u32 s18, s29, 7340032
  buffer_store_dwordx4 v[16:19], v3, s[24:27], s18 offen sc1
  s_add_u32 s18, s29, 7405568
  buffer_store_dwordx4 v[20:23], v3, s[24:27], s18 offen sc1
  v_cvt_pk_bf16_f32 v24, v96, v97
  v_cvt_pk_bf16_f32 v25, v98, v99
  v_cvt_pk_bf16_f32 v26, v100, v101
  v_cvt_pk_bf16_f32 v27, v102, v103
  v_cvt_pk_bf16_f32 v28, v104, v105
  v_cvt_pk_bf16_f32 v29, v106, v107
  v_cvt_pk_bf16_f32 v30, v108, v109
  v_cvt_pk_bf16_f32 v31, v110, v111
  s_add_u32 s18, s29, 9437184
  buffer_store_dwordx4 v[24:27], v6, s[24:27], s18 offen sc1
  buffer_store_dwordx4 v[28:31], v6, s[24:27], s18 offen offset:512 sc1
  s_branch L_p1_fin
L_p1_loader:
  s_cmp_ge_u32 s22, 6
  s_cbranch_scc1 L_p1_gs
  s_sub_u32 s32, s22, 4
  s_lshl_b32 s18, s32, 11
  s_mul_i32 s29, s21, 98304
  s_add_u32 s29, s29, s18
  s_add_u32 s29, s29, 3145728
  s_mul_i32 s30, s32, 6144
  s_lshl_b32 s19, s22, 9
  s_add_u32 s19, s19, 720896
  v_lshlrev_b32 v60, 3, v2
  s_barrier
  s_add_u32 m0, s30, 0
  s_add_u32 s31, s29, 0
  buffer_load_dwordx4 v3, s[24:27], s31 offen sc1 lds
  s_add_u32 m0, s30, 1024
  s_add_u32 s31, s29, 32768
  buffer_load_dwordx4 v3, s[24:27], s31 offen sc1 lds
  s_add_u32 m0, s30, 2048
  s_add_u32 s31, s29, 65536
  buffer_load_dwordx4 v3, s[24:27], s31 offen sc1 lds
  s_add_u32 m0, s30, 3072
  s_add_u32 s31, s29, 1024
  buffer_load_dwordx4 v3, s[24:27], s31 offen sc1 lds
  s_add_u32 m0, s30, 4096
  s_add_u32 s31, s29, 33792
  buffer_load_dwordx4 v3, s[24:27], s31 offen sc1 lds
  s_add_u32 m0, s30, 5120
  s_add_u32 s31, s29, 66560
  buffer_load_dwordx4 v3, s[24:27], s31 offen sc1 lds
  s_add_u32 s31, s19, 0
  buffer_load_dwordx2 v[44:45], v60, s[24:27], s31 offen sc1
  s_add_u32 s31, s19, 4096
  buffer_load_dwordx2 v[46:47], v60, s[24:27], s31 offen sc1
  s_add_u32 s31, s19, 8192
  buffer_load_dwordx2 v[48:49], v60, s[24:27], s31 offen sc1
  s_add_u32 s31, s19, 12288
  buffer_load_dwordx2 v[50:51], v60, s[24:27], s31 offen sc1
  s_add_u32 s31, s19, 16384
  buffer_load_dwordx2 v[52:53], v60, s[24:27], s31 offen sc1
  s_add_u32 s31, s19, 20480
  buffer_load_dwordx2 v[54:55], v60, s[24:27], s31 offen sc1
  s_add_u32 s31, s19, 24576
  buffer_load_dwordx2 v[56:57], v60, s[24:27], s31 offen sc1
  s_add_u32 s31, s19, 28672
  buffer_load_dwordx2 v[58:59], v60, s[24:27], s31 offen sc1
  s_add_u32 m0, s30, 12288
  s_add_u32 s31, s29, 4096
  buffer_load_dwordx4 v3, s[24:27], s31 offen sc1 lds
  s_add_u32 m0, s30, 13312
  s_add_u32 s31, s29, 36864
  buffer_load_dwordx4 v3, s[24:27], s31 offen sc1 lds
  s_add_u32 m0, s30, 14336
  s_add_u32 s31, s29, 69632
  buffer_load_dwordx4 v3, s[24:27], s31 offen sc1 lds
  s_add_u32 m0, s30, 15360
  s_add_u32 s31, s29, 5120
  buffer_load_dwordx4 v3, s[24:27], s31 offen sc1 lds
  s_add_u32 m0, s30, 16384
  s_add_u32 s31, s29, 37888
  buffer_load_dwordx4 v3, s[24:27], s31 offen sc1 lds
  s_add_u32 m0, s30, 17408
  s_add_u32 s31, s29, 70656
  buffer_load_dwordx4 v3, s[24:27], s31 offen sc1 lds
  s_waitcnt vmcnt(6)
  v_add_f32 v44, v44, v46
  v_add_f32 v45, v45, v47
  v_add_f32 v48, v48, v50
  v_add_f32 v49, v49, v51
  v_add_f32 v52, v52, v54
  v_add_f32 v53, v53, v55
  v_add_f32 v56, v56, v58
  v_add_f32 v57, v57, v59
  v_add_f32 v44, v44, v48
  v_add_f32 v45, v45, v49
  v_add_f32 v52, v52, v56
  v_add_f32 v53, v53, v57
  v_add_f32 v44, v44, v52
  v_add_f32 v45, v45, v53
  v_cvt_pk_bf16_f32 v44, v44, v44
  v_lshlrev_b32 v44, 16, v44
  v_cvt_pk_bf16_f32 v45, v45, v45
  v_lshlrev_b32 v45, 16, v45
  s_cmp_lt_u32 s22, 4
  s_cbranch_scc1 L_mega_kernel_7
  v_add_f32 v44, 1.0, v44
  v_add_f32 v45, 1.0, v45
  v_cvt_pk_bf16_f32 v44, v44, v44
  v_lshlrev_b32 v44, 16, v44
  v_cvt_pk_bf16_f32 v45, v45, v45
  v_lshlrev_b32 v45, 16, v45
L_mega_kernel_7:
  s_lshl_b32 s31, s22, 9
  s_add_u32 s31, s31, 98304
  v_add_u32 v60, s31, v60
  ds_write_b64 v60, v[44:45]
  s_waitcnt lgkmcnt(0)
  s_barrier
  s_add_u32 m0, s30, 24576
  s_add_u32 s31, s29, 8192
  buffer_load_dwordx4 v3, s[24:27], s31 offen sc1 lds
  s_add_u32 m0, s30, 25600
  s_add_u32 s31, s29, 40960
  buffer_load_dwordx4 v3, s[24:27], s31 offen sc1 lds
  s_add_u32 m0, s30, 26624
  s_add_u32 s31, s29, 73728
  buffer_load_dwordx4 v3, s[24:27], s31 offen sc1 lds
  s_add_u32 m0, s30, 27648
  s_add_u32 s31, s29, 9216
  buffer_load_dwordx4 v3, s[24:27], s31 offen sc1 lds
  s_add_u32 m0, s30, 28672
  s_add_u32 s31, s29, 41984
  buffer_load_dwordx4 v3, s[24:27], s31 offen sc1 lds
  s_add_u32 m0, s30, 29696
  s_add_u32 s31, s29, 74752
  buffer_load_dwordx4 v3, s[24:27], s31 offen sc1 lds
  s_waitcnt vmcnt(6)
  s_barrier
  s_add_u32 m0, s30, 36864
  s_add_u32 s31, s29, 12288
  buffer_load_dwordx4 v3, s[24:27], s31 offen sc1 lds
  s_add_u32 m0, s30, 37888
  s_add_u32 s31, s29, 45056
  buffer_load_dwordx4 v3, s[24:27], s31 offen sc1 lds
  s_add_u32 m0, s30, 38912
  s_add_u32 s31, s29, 77824
  buffer_load_dwordx4 v3, s[24:27], s31 offen sc1 lds
  s_add_u32 m0, s30, 39936
  s_add_u32 s31, s29, 13312
  buffer_load_dwordx4 v3, s[24:27], s31 offen sc1 lds
  s_add_u32 m0, s30, 40960
  s_add_u32 s31, s29, 46080
  buffer_load_dwordx4 v3, s[24:27], s31 offen sc1 lds
  s_add_u32 m0, s30, 41984
  s_add_u32 s31, s29, 78848
  buffer_load_dwordx4 v3, s[24:27], s31 offen sc1 lds
  s_waitcnt vmcnt(6)
  s_barrier
  s_add_u32 m0, s30, 49152
  s_add_u32 s31, s29, 16384
  buffer_load_dwordx4 v3, s[24:27], s31 offen sc1 lds
  s_add_u32 m0, s30, 50176
  s_add_u32 s31, s29, 49152
  buffer_load_dwordx4 v3, s[24:27], s31 offen sc1 lds
  s_add_u32 m0, s30, 51200
  s_add_u32 s31, s29, 81920
  buffer_load_dwordx4 v3, s[24:27], s31 offen sc1 lds
  s_add_u32 m0, s30, 52224
  s_add_u32 s31, s29, 17408
  buffer_load_dwordx4 v3, s[24:27], s31 offen sc1 lds
  s_add_u32 m0, s30, 53248
  s_add_u32 s31, s29, 50176
  buffer_load_dwordx4 v3, s[24:27], s31 offen sc1 lds
  s_add_u32 m0, s30, 54272
  s_add_u32 s31, s29, 82944
  buffer_load_dwordx4 v3, s[24:27], s31 offen sc1 lds
  s_waitcnt vmcnt(6)
  s_barrier
  s_add_u32 m0, s30, 61440
  s_add_u32 s31, s29, 20480
  buffer_load_dwordx4 v3, s[24:27], s31 offen sc1 lds
  s_add_u32 m0, s30, 62464
  s_add_u32 s31, s29, 53248
  buffer_load_dwordx4 v3, s[24:27], s31 offen sc1 lds
  s_add_u32 m0, s30, 63488
  s_add_u32 s31, s29, 86016
  buffer_load_dwordx4 v3, s[24:27], s31 offen sc1 lds
  s_add_u32 m0, s30, 64512
  s_add_u32 s31, s29, 21504
  buffer_load_dwordx4 v3, s[24:27], s31 offen sc1 lds
  s_add_u32 m0, s30, 65536
  s_add_u32 s31, s29, 54272
  buffer_load_dwordx4 v3, s[24:27], s31 offen sc1 lds
  s_add_u32 m0, s30, 66560
  s_add_u32 s31, s29, 87040
  buffer_load_dwordx4 v3, s[24:27], s31 offen sc1 lds
  s_waitcnt vmcnt(6)
  s_barrier
  s_add_u32 m0, s30, 73728
  s_add_u32 s31, s29, 24576
  buffer_load_dwordx4 v3, s[24:27], s31 offen sc1 lds
  s_add_u32 m0, s30, 74752
  s_add_u32 s31, s29, 57344
  buffer_load_dwordx4 v3, s[24:27], s31 offen sc1 lds
  s_add_u32 m0, s30, 75776
  s_add_u32 s31, s29, 90112
  buffer_load_dwordx4 v3, s[24:27], s31 offen sc1 lds
  s_add_u32 m0, s30, 76800
  s_add_u32 s31, s29, 25600
  buffer_load_dwordx4 v3, s[24:27], s31 offen sc1 lds
  s_add_u32 m0, s30, 77824
  s_add_u32 s31, s29, 58368
  buffer_load_dwordx4 v3, s[24:27], s31 offen sc1 lds
  s_add_u32 m0, s30, 78848
  s_add_u32 s31, s29, 91136
  buffer_load_dwordx4 v3, s[24:27], s31 offen sc1 lds
  s_waitcnt vmcnt(6)
  s_barrier
  s_add_u32 m0, s30, 86016
  s_add_u32 s31, s29, 28672
  buffer_load_dwordx4 v3, s[24:27], s31 offen sc1 lds
  s_add_u32 m0, s30, 87040
  s_add_u32 s31, s29, 61440
  buffer_load_dwordx4 v3, s[24:27], s31 offen sc1 lds
  s_add_u32 m0, s30, 88064
  s_add_u32 s31, s29, 94208
  buffer_load_dwordx4 v3, s[24:27], s31 offen sc1 lds
  s_add_u32 m0, s30, 89088
  s_add_u32 s31, s29, 29696
  buffer_load_dwordx4 v3, s[24:27], s31 offen sc1 lds
  s_add_u32 m0, s30, 90112
  s_add_u32 s31, s29, 62464
  buffer_load_dwordx4 v3, s[24:27], s31 offen sc1 lds
  s_add_u32 m0, s30, 91136
  s_add_u32 s31, s29, 95232
  buffer_load_dwordx4 v3, s[24:27], s31 offen sc1 lds
  s_waitcnt vmcnt(6)
  s_barrier
  s_waitcnt vmcnt(0)
  s_barrier
  s_branch L_p1_fin
L_p1_gs:
  s_lshl_b32 s19, s22, 9
  s_add_u32 s19, s19, 720896
  v_lshlrev_b32 v60, 3, v2
  s_barrier
  s_add_u32 s31, s19, 0
  buffer_load_dwordx2 v[44:45], v60, s[24:27], s31 offen sc1
  s_add_u32 s31, s19, 4096
  buffer_load_dwordx2 v[46:47], v60, s[24:27], s31 offen sc1
  s_add_u32 s31, s19, 8192
  buffer_load_dwordx2 v[48:49], v60, s[24:27], s31 offen sc1
  s_add_u32 s31, s19, 12288
  buffer_load_dwordx2 v[50:51], v60, s[24:27], s31 offen sc1
  s_add_u32 s31, s19, 16384
  buffer_load_dwordx2 v[52:53], v60, s[24:27], s31 offen sc1
  s_add_u32 s31, s19, 20480
  buffer_load_dwordx2 v[54:55], v60, s[24:27], s31 offen sc1
  s_add_u32 s31, s19, 24576
  buffer_load_dwordx2 v[56:57], v60, s[24:27], s31 offen sc1
  s_add_u32 s31, s19, 28672
  buffer_load_dwordx2 v[58:59], v60, s[24:27], s31 offen sc1
  s_waitcnt vmcnt(0)
  v_add_f32 v44, v44, v46
  v_add_f32 v45, v45, v47
  v_add_f32 v48, v48, v50
  v_add_f32 v49, v49, v51
  v_add_f32 v52, v52, v54
  v_add_f32 v53, v53, v55
  v_add_f32 v56, v56, v58
  v_add_f32 v57, v57, v59
  v_add_f32 v44, v44, v48
  v_add_f32 v45, v45, v49
  v_add_f32 v52, v52, v56
  v_add_f32 v53, v53, v57
  v_add_f32 v44, v44, v52
  v_add_f32 v45, v45, v53
  v_cvt_pk_bf16_f32 v44, v44, v44
  v_lshlrev_b32 v44, 16, v44
  v_cvt_pk_bf16_f32 v45, v45, v45
  v_lshlrev_b32 v45, 16, v45
  s_cmp_lt_u32 s22, 4
  s_cbranch_scc1 L_mega_kernel_8
  v_add_f32 v44, 1.0, v44
  v_add_f32 v45, 1.0, v45
  v_cvt_pk_bf16_f32 v44, v44, v44
  v_lshlrev_b32 v44, 16, v44
  v_cvt_pk_bf16_f32 v45, v45, v45
  v_lshlrev_b32 v45, 16, v45
L_mega_kernel_8:
  s_lshl_b32 s31, s22, 9
  s_add_u32 s31, s31, 98304
  v_add_u32 v60, s31, v60
  ds_write_b64 v60, v[44:45]
  s_waitcnt lgkmcnt(0)
  s_barrier
  s_barrier
  s_barrier
  s_barrier
  s_barrier
  v_lshlrev_b32 v10, 2, v2
  s_cmp_lg_u32 s22, 7
  s_cbranch_scc1 L_mega_kernel_9
  s_cmp_ge_u32 s2, 32
  s_cbranch_scc1 L_mega_kernel_9
  s_lshl_b32 s38, s2, 6
  s_add_u32 s38, s38, 755712
  s_add_u32 s31, s38, 0
  buffer_load_dword v48, v10, s[24:27], s31 offen sc1
  s_add_u32 s31, s38, 4096
  buffer_load_dword v49, v10, s[24:27], s31 offen sc1
  s_add_u32 s31, s38, 8192
  buffer_load_dword v50, v10, s[24:27], s31 offen sc1
  s_add_u32 s31, s38, 12288
  buffer_load_dword v51, v10, s[24:27], s31 offen sc1
  s_add_u32 s31, s38, 16384
  buffer_load_dword v52, v10, s[24:27], s31 offen sc1
  s_add_u32 s31, s38, 20480
  buffer_load_dword v53, v10, s[24:27], s31 offen sc1
  s_add_u32 s31, s38, 24576
  buffer_load_dword v54, v10, s[24:27], s31 offen sc1
  s_add_u32 s31, s38, 28672
  buffer_load_dword v55, v10, s[24:27], s31 offen sc1
L_mega_kernel_9:
  s_barrier
  s_barrier
  s_barrier
  s_cmp_lg_u32 s22, 7
  s_cbranch_scc1 L_mega_kernel_10
  s_cmp_ge_u32 s2, 32
  s_cbranch_scc1 L_mega_kernel_10
  s_waitcnt vmcnt(0)
  v_add_f32 v48, v48, v49
  v_add_f32 v50, v50, v51
  v_add_f32 v52, v52, v53
  v_add_f32 v54, v54, v55
  v_add_f32 v48, v48, v50
  v_add_f32 v52, v52, v54
  v_add_f32 v48, v48, v52
  v_cvt_pk_bf16_f32 v48, v48, v48
  v_lshlrev_b32 v48, 16, v48
  v_add_f32 v48, 1.0, v48
  v_cvt_pk_bf16_f32 v48, v48, v48
  v_lshlrev_b32 v48, 16, v48
  s_lshl_b32 s38, s2, 6
  s_add_u32 s38, s38, 8192
  s_mov_b64 exec, 0xffff
  buffer_store_dword v48, v10, s[24:27], s38 offen sc1
  s_mov_b64 exec, -1
L_mega_kernel_10:
  s_sub_u32 s32, s22, 6
  s_lshl_b32 s36, s2, 3
  s_mul_i32 s37, s32, 7
  s_add_u32 s36, s36, s37
  s_min_u32 s36, s36, 1375
  s_mul_i32 s36, s36, 24386
  s_lshr_b32 s36, s36, 20
  v_and_b32 v8, 1, v2
  v_xor_b32 v8, 1, v8
  v_lshlrev_b32 v8, 11, v8
  v_lshrrev_b32 v9, 5, v2
  v_lshl_add_u32 v8, v9, 4, v8
  s_lshl_b32 s37, s36, 6
  s_add_u32 s37, s37, 753664
  s_add_u32 s31, s37, 0
  buffer_load_dwordx4 v[64:67], v8, s[24:27], s31 offen sc1
  buffer_load_dwordx4 v[68:71], v8, s[24:27], s31 offen offset:32 sc1
  s_add_u32 s31, s37, 4096
  buffer_load_dwordx4 v[72:75], v8, s[24:27], s31 offen sc1
  buffer_load_dwordx4 v[76:79], v8, s[24:27], s31 offen offset:32 sc1
  s_add_u32 s31, s37, 8192
  buffer_load_dwordx4 v[80:83], v8, s[24:27], s31 offen sc1
  buffer_load_dwordx4 v[84:87], v8, s[24:27], s31 offen offset:32 sc1
  s_add_u32 s31, s37, 12288
  buffer_load_dwordx4 v[88:91], v8, s[24:27], s31 offen sc1
  buffer_load_dwordx4 v[92:95], v8, s[24:27], s31 offen offset:32 sc1
  s_add_u32 s31, s37, 16384
  buffer_load_dwordx4 v[96:99], v8, s[24:27], s31 offen sc1
  buffer_load_dwordx4 v[100:103], v8, s[24:27], s31 offen offset:32 sc1
  s_add_u32 s31, s37, 20480
  buffer_load_dwordx4 v[104:107], v8, s[24:27], s31 offen sc1
  buffer_load_dwordx4 v[108:111], v8, s[24:27], s31 offen offset:32 sc1
  s_add_u32 s31, s37, 24576
  buffer_load_dwordx4 v[112:115], v8, s[24:27], s31 offen sc1
  buffer_load_dwordx4 v[116:119], v8, s[24:27], s31 offen offset:32 sc1
  s_add_u32 s31, s37, 28672
  buffer_load_dwordx4 v[120:123], v8, s[24:27], s31 offen sc1
  buffer_load_dwordx4 v[124:127], v8, s[24:27], s31 offen offset:32 sc1
  v_and_b32 v9, 1, v2
  v_cvt_f32_u32 v9, v9
  v_sub_f32 v9, 1.0, v9
  v_and_b32 v8, 31, v2
  v_cmp_gt_u32 vcc, 2, v8
  v_lshlrev_b32 v8, 4, v8
  v_lshrrev_b32 v10, 5, v2
  v_lshl_add_u32 v8, v10, 5, v8
  s_lshl_b32 s37, s32, 6
  s_add_u32 s37, s37, 155648
  v_add_u32 v8, s37, v8
  s_waitcnt vmcnt(0)
  v_add_f32 v16, v64, v72
  v_add_f32 v24, v80, v88
  v_add_f32 v32, v96, v104
  v_add_f32 v40, v112, v120
  v_add_f32 v17, v65, v73
  v_add_f32 v25, v81, v89
  v_add_f32 v33, v97, v105
  v_add_f32 v41, v113, v121
  v_add_f32 v18, v66, v74
  v_add_f32 v26, v82, v90
  v_add_f32 v34, v98, v106
  v_add_f32 v42, v114, v122
  v_add_f32 v19, v67, v75
  v_add_f32 v27, v83, v91
  v_add_f32 v35, v99, v107
  v_add_f32 v43, v115, v123
  v_add_f32 v20, v68, v76
  v_add_f32 v28, v84, v92
  v_add_f32 v36, v100, v108
  v_add_f32 v44, v116, v124
  v_add_f32 v21, v69, v77
  v_add_f32 v29, v85, v93
  v_add_f32 v37, v101, v109
  v_add_f32 v45, v117, v125
  v_add_f32 v22, v70, v78
  v_add_f32 v30, v86, v94
  v_add_f32 v38, v102, v110
  v_add_f32 v46, v118, v126
  v_add_f32 v23, v71, v79
  v_add_f32 v31, v87, v95
  v_add_f32 v39, v103, v111
  v_add_f32 v47, v119, v127
  v_add_f32 v16, v16, v24
  v_add_f32 v32, v32, v40
  v_add_f32 v17, v17, v25
  v_add_f32 v33, v33, v41
  v_add_f32 v18, v18, v26
  v_add_f32 v34, v34, v42
  v_add_f32 v19, v19, v27
  v_add_f32 v35, v35, v43
  v_add_f32 v20, v20, v28
  v_add_f32 v36, v36, v44
  v_add_f32 v21, v21, v29
  v_add_f32 v37, v37, v45
  v_add_f32 v22, v22, v30
  v_add_f32 v38, v38, v46
  v_add_f32 v23, v23, v31
  v_add_f32 v39, v39, v47
  v_add_f32 v16, v16, v32
  v_add_f32 v17, v17, v33
  v_add_f32 v18, v18, v34
  v_add_f32 v19, v19, v35
  v_add_f32 v20, v20, v36
  v_add_f32 v21, v21, v37
  v_add_f32 v22, v22, v38
  v_add_f32 v23, v23, v39
  v_cvt_pk_bf16_f32 v16, v16, v16
  v_cvt_pk_bf16_f32 v17, v17, v17
  v_cvt_pk_bf16_f32 v18, v18, v18
  v_cvt_pk_bf16_f32 v19, v19, v19
  v_cvt_pk_bf16_f32 v20, v20, v20
  v_cvt_pk_bf16_f32 v21, v21, v21
  v_cvt_pk_bf16_f32 v22, v22, v22
  v_cvt_pk_bf16_f32 v23, v23, v23
  v_lshlrev_b32 v16, 16, v16
  v_lshlrev_b32 v17, 16, v17
  v_lshlrev_b32 v18, 16, v18
  v_lshlrev_b32 v19, 16, v19
  v_lshlrev_b32 v20, 16, v20
  v_lshlrev_b32 v21, 16, v21
  v_lshlrev_b32 v22, 16, v22
  v_lshlrev_b32 v23, 16, v23
  v_add_f32 v16, v9, v16
  v_add_f32 v17, v9, v17
  v_add_f32 v18, v9, v18
  v_add_f32 v19, v9, v19
  v_add_f32 v20, v9, v20
  v_add_f32 v21, v9, v21
  v_add_f32 v22, v9, v22
  v_add_f32 v23, v9, v23
  v_cvt_pk_bf16_f32 v16, v16, v17
  v_cvt_pk_bf16_f32 v17, v18, v19
  v_cvt_pk_bf16_f32 v18, v20, v21
  v_cvt_pk_bf16_f32 v19, v22, v23
  s_and_saveexec_b64 s[40:41], vcc
  ds_write_b128 v8, v[16:19]
  s_mov_b64 exec, s[40:41]
  s_waitcnt lgkmcnt(0)
L_p1_fin:
  s_lshl_b32 s30, s21, 4
  s_add_u32 s30, s30, s20
  s_waitcnt vmcnt(0)
  s_barrier
  s_cmp_lg_u32 s22, 0
  s_cbranch_scc1 Lpub_mega_kernel_11
  s_lshl_b32 s73, s30, 7
  s_add_u32 s73, s73, 35684352
  v_mov_b32 v4, s73
  v_mov_b32 v5, s72
  s_mov_b64 exec, 1
  global_store_dword v4, v5, s[8:9] sc1
  s_mov_b64 exec, -1
Lpub_mega_kernel_11:
  s_or_b32 s73, s2, s22
  s_cmp_lg_u32 s73, 0
  s_cbranch_scc1 L_mega_kernel_12
  v_mov_b32 v4, 35651456
  v_mov_b32 v5, s72
  s_mov_b64 exec, 1
  global_store_dword v4, v5, s[8:9] sc1
  s_mov_b64 exec, -1
L_mega_kernel_12:
  s_and_b32 s30, s2, 7
  s_lshl_b32 s30, s30, 2
  s_lshr_b32 s31, s2, 6
  s_add_u32 s30, s30, s31
  s_lshr_b32 s30, s30, 1
  s_lshl_b32 s30, s30, 4
  s_mov_b32 s68, s30
  s_lshl_b32 s39, s2, 3
  s_add_u32 s39, s39, s22
  s_min_u32 s39, s39, 1375
  s_add_u32 s39, s39, 944
  s_lshl_b32 s54, s22, 11
  s_add_u32 s54, s54, 131072
  s_cmp_ge_u32 s39, 944
  s_cbranch_scc1 L13_mega_kernel_13
  s_cmp_ge_u32 s39, 256
  s_cbranch_scc1 Lw2_mega_kernel_15
  s_mov_b32 s40, s39
  s_mov_b32 s44, s10
  s_mov_b32 s45, s11
  s_mov_b32 s41, 32768
  s_mov_b32 s42, 14155776
  s_branch Lj_mega_kernel_16
Lw2_mega_kernel_15:
  s_sub_u32 s40, s39, 256
  s_mov_b32 s44, s12
  s_mov_b32 s45, s13
  s_mov_b32 s41, 88064
  s_mov_b32 s42, 17825792
Lj_mega_kernel_16:
  s_mov_b32 s46, s44
  s_mov_b32 s47, s45
  s_and_b32 s43, s40, 7
  s_lshr_b32 s40, s40, 3
  v_lshrrev_b32 v232, 3, v2
  v_lshlrev_b32 v232, 10, v232
  v_and_b32 v235, 7, v2
  v_lshl_add_u32 v232, v235, 4, v232
  s_lshl_b32 s50, s40, 14
  s_lshl_b32 s51, s43, 7
  s_add_u32 s50, s50, s51
  v_add_u32 v232, s50, v232
  v_add_u32 v236, 8192, v232
  s_lshl_b32 s51, s43, 1
  s_mul_i32 s51, s51, s41
  s_add_u32 s48, s42, s51
  s_lshl_b32 s51, s40, 10
  s_add_u32 s48, s48, s51
  s_add_u32 s49, s48, s41
  v_bfe_u32 v235, v2, 2, 2
  v_lshrrev_b32 v237, 5, v2
  v_lshl_add_u32 v235, v237, 2, v235
  v_lshlrev_b32 v233, 7, v235
  v_bfe_u32 v235, v2, 4, 1
  v_lshl_add_u32 v233, v235, 5, v233
  v_and_b32 v235, 3, v2
  v_lshl_add_u32 v233, v235, 3, v233
  s_mov_b32 s52, 64
  s_mov_b32 s53, 1024
  s_branch Ld_mega_kernel_14
L13_mega_kernel_13:
  s_sub_u32 s40, s39, 944
  s_mul_i32 s43, s40, 24386
  s_lshr_b32 s43, s43, 20
  s_mul_i32 s50, s43, 43
  s_sub_u32 s40, s40, s50
  s_mov_b32 s44, s14
  s_mov_b32 s45, s15
  s_mov_b32 s46, s16
  s_mov_b32 s47, s17
  v_lshrrev_b32 v232, 2, v2
  v_mul_u32_u24 v232, 2752, v232
  v_and_b32 v235, 3, v2
  v_lshl_add_u32 v232, v235, 4, v232
  s_mul_i32 s50, s43, 44032
  s_lshl_b32 s51, s40, 6
  s_add_u32 s50, s50, s51
  v_add_u32 v232, s50, v232
  v_mov_b32 v236, v232
  s_lshl_b32 s51, s40, 16
  s_add_u32 s48, s51, 14680064
  s_lshl_b32 s51, s43, 10
  s_add_u32 s48, s48, s51
  s_add_u32 s49, s48, 32768
  v_bfe_u32 v235, v2, 2, 2
  v_lshrrev_b32 v237, 5, v2
  v_lshl_add_u32 v235, v237, 2, v235
  v_lshlrev_b32 v233, 6, v235
  v_bfe_u32 v235, v2, 4, 1
  v_lshl_add_u32 v233, v235, 10, v233
  v_and_b32 v235, 3, v2
  v_lshl_add_u32 v233, v235, 3, v233
  s_mov_b32 s52, 32
  s_mov_b32 s53, 512
Ld_mega_kernel_14:
  v_add_u32 v233, s54, v233
  s_mov_b32 s30, s68
  s_cmp_ge_u32 s22, 1
  s_cbranch_scc1 Lw_mega_kernel_17
  s_lshl_b32 s73, s30, 7
  s_add_u32 s73, s73, 35684352
  v_lshlrev_b32 v4, 7, v2
  v_add_u32 v4, s73, v4
  s_mov_b64 exec, 0xffff
  s_mov_b32 s73, 0
  global_load_dword v5, v4, s[8:9] sc1
Lp_mega_kernel_18:
  s_waitcnt vmcnt(0)
  v_cmp_ne_u32 vcc, s72, v5
  s_nop 1
  s_cbranch_vccz Lx_mega_kernel_19
  s_sleep 4
  global_load_dword v5, v4, s[8:9] sc1
  s_add_u32 s73, s73, 1
  s_cmp_lt_u32 s73, 100000
  s_cbranch_scc1 Lp_mega_kernel_18
Lx_mega_kernel_19:
  s_waitcnt vmcnt(0)
  s_mov_b64 exec, -1
Lw_mega_kernel_17:
  s_and_b32 s10, s2, 7
  s_lshr_b32 s11, s2, 3
  s_lshl_b32 s20, s10, 2
  s_lshr_b32 s18, s11, 3
  s_add_u32 s20, s20, s18
  s_and_b32 s21, s11, 7
  s_and_b32 s32, s22, 3
  s_lshr_b32 s33, s22, 2
  s_lshl_b32 s28, s20, 16
  s_lshl_b32 s29, s21, 3
  s_lshl_b32 s30, s32, 1
  s_add_u32 s29, s29, s30
  s_lshl_b32 s30, s29, 10
  s_add_u32 s30, s30, s28
  s_add_u32 s31, s30, 5242880
  s_lshl_b32 s18, s33, 5
  s_add_u32 s18, s18, s32
  s_lshl_b32 s18, s18, 10
  s_add_u32 s19, s28, s18
  s_add_u32 s19, s19, 7340032
  s_load_dwordx2 s[4:5], s[0:1], 56
  s_load_dwordx2 s[6:7], s[0:1], 64
  s_lshl_b32 s38, s33, 15
  v_and_b32 v6, 15, v2
  v_lshlrev_b32 v6, 4, v6
  v_lshrrev_b32 v7, 5, v2
  v_lshl_add_u32 v6, v7, 8, v6
  v_add_u32 v6, 65536, v6
  v_add_u32 v6, s38, v6
  v_add_u32 v7, s38, v3
  s_mov_b32 s34, 0x0000ffff
  s_mov_b32 s35, 0x0000ffff
  v_and_b32 v1, 27, v2
  v_cmp_eq_u32 vcc, 16, v1
  v_mov_b32 v1, 0x3f803f80
  s_nop 0
  v_cndmask_b32 v104, 0, v1, vcc
  v_mov_b32 v105, v104
  v_mov_b32 v106, v104
  v_mov_b32 v107, v104
  v_mov_b32 v108, v104
  v_mov_b32 v109, v104
  v_mov_b32 v110, v104
  v_mov_b32 v111, v104
  v_mov_b32 v112, v104
  v_mov_b32 v113, v104
  v_mov_b32 v114, v104
  v_mov_b32 v115, v104
  v_mov_b32 v116, v104
  v_mov_b32 v117, v104
  v_mov_b32 v118, v104
  v_mov_b32 v119, v104
  v_mov_b32 v235, 0
  v_mov_b32 v237, 0
  v_mov_b32 v238, 0
  v_mov_b32 v239, 0
  s_cmp_ge_u32 s22, 4
  s_cbranch_scc0 Lnp_mega_kernel_20
  s_setprio 1
Lnp_mega_kernel_20:
  s_barrier
  buffer_load_dwordx4 v[8:11], v3, s[24:27], s31 offen sc1
  buffer_load_dwordx4 v[12:15], v3, s[24:27], s31 offen offset:1024 sc1
  s_mov_b32 m0, s18
  s_add_u32 s23, s19, 2097152
  buffer_load_dwordx4 v3, s[24:27], s19 offen sc1 lds
  s_add_u32 m0, s18, 65536
  s_add_u32 s18, s18, 4096
  buffer_load_dwordx4 v3, s[24:27], s23 offen sc1 lds
  s_add_u32 s19, s19, 4096
  s_mov_b32 s36, 1
  s_waitcnt vmcnt(0)
  s_barrier
  ds_read_b128 v[96:99], v3
  s_waitcnt lgkmcnt(0)
  v_mfma_f32_32x32x16_bf16 v[48:63], v[96:99], v[8:11], 0
  v_mfma_f32_32x32x16_bf16 v[64:79], v[96:99], v[12:15], 0
  s_nop 7
  s_nop 3
  v_max3_f32 v80, v48, v49, v50
  v_max3_f32 v88, v64, v65, v66
  v_max3_f32 v80, v80, v51, v52
  v_max3_f32 v88, v88, v67, v68
  v_max3_f32 v80, v80, v53, v54
  v_max3_f32 v88, v88, v69, v70
  v_max3_f32 v80, v80, v55, v56
  v_max3_f32 v88, v88, v71, v72
  v_max3_f32 v80, v80, v57, v58
  v_max3_f32 v88, v88, v73, v74
  v_max3_f32 v80, v80, v59, v60
  v_max3_f32 v88, v88, v75, v76
  v_max3_f32 v80, v80, v61, v62
  v_max3_f32 v88, v88, v77, v78
  v_max_f32 v80, v80, v63
  v_max_f32 v88, v88, v79
L_p2_setm:
  v_mov_b32 v81, v80
  v_mov_b32 v89, v88
  s_nop 1
  v_permlane32_swap_b32 v80, v81
  v_permlane32_swap_b32 v88, v89
  v_max_f32 v80, v80, v81
  v_max_f32 v88, v88, v89
  v_sub_f32 v16, 0, v80
  v_sub_f32 v32, 0, v88
  v_sub_f32 v17, 0, v80
  v_sub_f32 v33, 0, v88
  v_mov_b64 v[18:19], v[16:17]
  v_mov_b64 v[34:35], v[32:33]
  v_mov_b64 v[20:21], v[16:17]
  v_mov_b64 v[36:37], v[32:33]
  v_mov_b64 v[22:23], v[16:17]
  v_mov_b64 v[38:39], v[32:33]
  v_mov_b64 v[24:25], v[16:17]
  v_mov_b64 v[40:41], v[32:33]
  v_mov_b64 v[26:27], v[16:17]
  v_mov_b64 v[42:43], v[32:33]
  v_mov_b64 v[28:29], v[16:17]
  v_mov_b64 v[44:45], v[32:33]
  v_mov_b64 v[30:31], v[16:17]
  v_mov_b64 v[46:47], v[32:33]
  v_mov_b64 v[120:121], 0
  v_mov_b64 v[136:137], 0
  v_mov_b64 v[122:123], 0
  v_mov_b64 v[138:139], 0
  v_mov_b64 v[124:125], 0
  v_mov_b64 v[140:141], 0
  v_mov_b64 v[126:127], 0
  v_mov_b64 v[142:143], 0
  v_mov_b64 v[128:129], 0
  v_mov_b64 v[144:145], 0
  v_mov_b64 v[130:131], 0
  v_mov_b64 v[146:147], 0
  v_mov_b64 v[132:133], 0
  v_mov_b64 v[148:149], 0
  v_mov_b64 v[134:135], 0
  v_mov_b64 v[150:151], 0
  v_mov_b64 v[92:93], 0
  v_mov_b64 v[94:95], 0
  v_mov_b32 v4, v7
  v_mov_b32 v5, v6
  ds_read_b128 v[96:99], v4
  s_mov_b64 exec, s[34:35]
  ds_read_b128 v[104:107], v5
  ds_read_b128 v[108:111], v5 offset:512
  ds_read_b128 v[116:119], v5 offset:512
  s_mov_b64 exec, -1
  s_waitcnt lgkmcnt(0)
  v_mfma_f32_32x32x16_bf16 v[48:63], v[96:99], v[8:11], v[16:31]
  s_cmp_eq_u32 s36, 0
  s_cbranch_scc1 L_p2_retry
  s_mov_b32 m0, s18
  s_add_u32 s23, s19, 2097152
  buffer_load_dwordx4 v3, s[24:27], s19 offen sc1 lds
  s_add_u32 m0, s18, 65536
  s_add_u32 s18, s18, 4096
  buffer_load_dwordx4 v3, s[24:27], s23 offen sc1 lds
  s_add_u32 s19, s19, 4096
  s_mov_b32 m0, s18
  s_add_u32 s23, s19, 2097152
  buffer_load_dwordx4 v3, s[24:27], s19 offen sc1 lds
  s_add_u32 m0, s18, 65536
  s_add_u32 s18, s18, 4096
  buffer_load_dwordx4 v3, s[24:27], s23 offen sc1 lds
  s_add_u32 s19, s19, 4096
  v_mfma_f32_32x32x16_bf16 v[64:79], v[96:99], v[12:15], v[32:47]
  ds_read_b128 v[100:103], v4 offset:1024
  v_exp_f32 v48, v48
  v_exp_f32 v49, v49
  v_mfma_f32_32x32x16_bf16 v[136:151], v[116:119], v[92:95], v[136:151]
  v_exp_f32 v50, v50
  v_cvt_pk_bf16_f32 v80, v48, v49
  v_exp_f32 v51, v51
  v_exp_f32 v52, v52
  v_cvt_pk_bf16_f32 v81, v50, v51
  v_exp_f32 v53, v53
  v_exp_f32 v54, v54
  v_cvt_pk_bf16_f32 v82, v52, v53
  v_exp_f32 v55, v55
  v_exp_f32 v56, v56
  v_cvt_pk_bf16_f32 v83, v54, v55
  v_exp_f32 v57, v57
  v_exp_f32 v58, v58
  v_cvt_pk_bf16_f32 v84, v56, v57
  v_mfma_f32_32x32x16_bf16 v[120:135], v[104:107], v[80:83], v[120:135]
  v_exp_f32 v59, v59
  v_exp_f32 v60, v60
  v_cvt_pk_bf16_f32 v85, v58, v59
  v_exp_f32 v61, v61
  v_exp_f32 v62, v62
  v_cvt_pk_bf16_f32 v86, v60, v61
  v_exp_f32 v63, v63
  s_waitcnt lgkmcnt(0)
  v_cvt_pk_bf16_f32 v87, v62, v63
  v_mfma_f32_32x32x16_bf16 v[48:63], v[100:103], v[8:11], v[16:31]
  s_mov_b64 exec, s[34:35]
  ds_read_b128 v[112:115], v5 offset:1024
  s_mov_b64 exec, -1
  v_exp_f32 v64, v64
  v_exp_f32 v65, v65
  v_mfma_f32_32x32x16_bf16 v[120:135], v[108:111], v[84:87], v[120:135]
  v_exp_f32 v66, v66
  v_cvt_pk_bf16_f32 v88, v64, v65
  v_exp_f32 v67, v67
  s_mov_b64 exec, s[34:35]
  ds_read_b128 v[116:119], v5 offset:1536
  s_mov_b64 exec, -1
  v_exp_f32 v68, v68
  v_cvt_pk_bf16_f32 v89, v66, v67
  v_exp_f32 v69, v69
  v_exp_f32 v70, v70
  v_cvt_pk_bf16_f32 v90, v68, v69
  v_exp_f32 v71, v71
  v_exp_f32 v72, v72
  v_cvt_pk_bf16_f32 v91, v70, v71
  v_exp_f32 v73, v73
  v_exp_f32 v74, v74
  v_cvt_pk_bf16_f32 v92, v72, v73
  v_mfma_f32_32x32x16_bf16 v[136:151], v[104:107], v[88:91], v[136:151]
  v_exp_f32 v75, v75
  v_exp_f32 v76, v76
  v_cvt_pk_bf16_f32 v93, v74, v75
  v_exp_f32 v77, v77
  v_exp_f32 v78, v78
  v_cvt_pk_bf16_f32 v94, v76, v77
  v_exp_f32 v79, v79
  s_waitcnt lgkmcnt(0)
  v_cvt_pk_bf16_f32 v95, v78, v79
  s_mov_b32 m0, s18
  s_add_u32 s23, s19, 2097152
  buffer_load_dwordx4 v3, s[24:27], s19 offen sc1 lds
  s_add_u32 m0, s18, 65536
  s_add_u32 s18, s18, 4096
  buffer_load_dwordx4 v3, s[24:27], s23 offen sc1 lds
  s_add_u32 s19, s19, 4096
  s_mov_b32 m0, s18
  s_add_u32 s23, s19, 2097152
  buffer_load_dwordx4 v3, s[24:27], s19 offen sc1 lds
  s_add_u32 m0, s18, 65536
  s_add_u32 s18, s18, 4096
  buffer_load_dwordx4 v3, s[24:27], s23 offen sc1 lds
  s_add_u32 s19, s19, 4096
  v_mfma_f32_32x32x16_bf16 v[64:79], v[100:103], v[12:15], v[32:47]
  ds_read_b128 v[96:99], v4 offset:2048
  v_exp_f32 v48, v48
  v_exp_f32 v49, v49
  v_mfma_f32_32x32x16_bf16 v[136:151], v[108:111], v[92:95], v[136:151]
  v_exp_f32 v50, v50
  v_cvt_pk_bf16_f32 v80, v48, v49
  v_exp_f32 v51, v51
  v_exp_f32 v52, v52
  v_cvt_pk_bf16_f32 v81, v50, v51
  v_exp_f32 v53, v53
  v_exp_f32 v54, v54
  v_cvt_pk_bf16_f32 v82, v52, v53
  v_exp_f32 v55, v55
  v_exp_f32 v56, v56
  v_cvt_pk_bf16_f32 v83, v54, v55
  v_exp_f32 v57, v57
  v_exp_f32 v58, v58
  v_cvt_pk_bf16_f32 v84, v56, v57
  v_mfma_f32_32x32x16_bf16 v[120:135], v[112:115], v[80:83], v[120:135]
  v_exp_f32 v59, v59
  v_exp_f32 v60, v60
  v_cvt_pk_bf16_f32 v85, v58, v59
  v_exp_f32 v61, v61
  v_exp_f32 v62, v62
  v_cvt_pk_bf16_f32 v86, v60, v61
  v_exp_f32 v63, v63
  s_waitcnt lgkmcnt(0)
  v_cvt_pk_bf16_f32 v87, v62, v63
  v_mfma_f32_32x32x16_bf16 v[48:63], v[96:99], v[8:11], v[16:31]
  s_mov_b64 exec, s[34:35]
  ds_read_b128 v[104:107], v5 offset:2048
  s_mov_b64 exec, -1
  v_exp_f32 v64, v64
  v_exp_f32 v65, v65
  v_mfma_f32_32x32x16_bf16 v[120:135], v[116:119], v[84:87], v[120:135]
  v_exp_f32 v66, v66
  v_cvt_pk_bf16_f32 v88, v64, v65
  v_exp_f32 v67, v67
  s_mov_b64 exec, s[34:35]
  ds_read_b128 v[108:111], v5 offset:2560
  s_mov_b64 exec, -1
  v_exp_f32 v68, v68
  v_cvt_pk_bf16_f32 v89, v66, v67
  v_exp_f32 v69, v69
  v_exp_f32 v70, v70
  v_cvt_pk_bf16_f32 v90, v68, v69
  v_exp_f32 v71, v71
  v_exp_f32 v72, v72
  v_cvt_pk_bf16_f32 v91, v70, v71
  v_exp_f32 v73, v73
  v_exp_f32 v74, v74
  v_cvt_pk_bf16_f32 v92, v72, v73
  v_mfma_f32_32x32x16_bf16 v[136:151], v[112:115], v[88:91], v[136:151]
  v_exp_f32 v75, v75
  v_exp_f32 v76, v76
  v_cvt_pk_bf16_f32 v93, v74, v75
  v_exp_f32 v77, v77
  v_exp_f32 v78, v78
  v_cvt_pk_bf16_f32 v94, v76, v77
  v_exp_f32 v79, v79
  s_waitcnt lgkmcnt(0)
  v_cvt_pk_bf16_f32 v95, v78, v79
  s_mov_b32 m0, s18
  s_add_u32 s23, s19, 2097152
  buffer_load_dwordx4 v3, s[24:27], s19 offen sc1 lds
  s_add_u32 m0, s18, 65536
  s_add_u32 s18, s18, 4096
  buffer_load_dwordx4 v3, s[24:27], s23 offen sc1 lds
  s_add_u32 s19, s19, 4096
  s_mov_b32 m0, s18
  s_add_u32 s23, s19, 2097152
  buffer_load_dwordx4 v3, s[24:27], s19 offen sc1 lds
  s_add_u32 m0, s18, 65536
  s_add_u32 s18, s18, 4096
  buffer_load_dwordx4 v3, s[24:27], s23 offen sc1 lds
  s_add_u32 s19, s19, 4096
  s_mov_b32 m0, s18
  s_add_u32 s23, s19, 2097152
  buffer_load_dwordx4 v3, s[24:27], s19 offen sc1 lds
  s_add_u32 m0, s18, 65536
  s_add_u32 s18, s18, 4096
  buffer_load_dwordx4 v3, s[24:27], s23 offen sc1 lds
  s_add_u32 s19, s19, 4096
  v_mfma_f32_32x32x16_bf16 v[64:79], v[96:99], v[12:15], v[32:47]
  ds_read_b128 v[100:103], v4 offset:3072
  v_exp_f32 v48, v48
  v_exp_f32 v49, v49
  v_mfma_f32_32x32x16_bf16 v[136:151], v[116:119], v[92:95], v[136:151]
  v_exp_f32 v50, v50
  v_cvt_pk_bf16_f32 v80, v48, v49
  v_exp_f32 v51, v51
  v_exp_f32 v52, v52
  v_cvt_pk_bf16_f32 v81, v50, v51
  v_exp_f32 v53, v53
  v_exp_f32 v54, v54
  v_cvt_pk_bf16_f32 v82, v52, v53
  v_exp_f32 v55, v55
  v_exp_f32 v56, v56
  v_cvt_pk_bf16_f32 v83, v54, v55
  v_exp_f32 v57, v57
  v_exp_f32 v58, v58
  v_cvt_pk_bf16_f32 v84, v56, v57
  v_mfma_f32_32x32x16_bf16 v[120:135], v[104:107], v[80:83], v[120:135]
  v_exp_f32 v59, v59
  v_exp_f32 v60, v60
  v_cvt_pk_bf16_f32 v85, v58, v59
  v_exp_f32 v61, v61
  v_exp_f32 v62, v62
  v_cvt_pk_bf16_f32 v86, v60, v61
  v_exp_f32 v63, v63
  s_waitcnt lgkmcnt(0)
  v_cvt_pk_bf16_f32 v87, v62, v63
  v_mfma_f32_32x32x16_bf16 v[48:63], v[100:103], v[8:11], v[16:31]
  s_mov_b64 exec, s[34:35]
  ds_read_b128 v[112:115], v5 offset:3072
  s_mov_b64 exec, -1
  v_exp_f32 v64, v64
  v_exp_f32 v65, v65
  v_mfma_f32_32x32x16_bf16 v[120:135], v[108:111], v[84:87], v[120:135]
  v_exp_f32 v66, v66
  v_cvt_pk_bf16_f32 v88, v64, v65
  v_exp_f32 v67, v67
  s_mov_b64 exec, s[34:35]
  ds_read_b128 v[116:119], v5 offset:3584
  s_mov_b64 exec, -1
  v_exp_f32 v68, v68
  v_cvt_pk_bf16_f32 v89, v66, v67
  v_exp_f32 v69, v69
  v_exp_f32 v70, v70
  v_cvt_pk_bf16_f32 v90, v68, v69
  v_exp_f32 v71, v71
  v_exp_f32 v72, v72
  v_cvt_pk_bf16_f32 v91, v70, v71
  v_exp_f32 v73, v73
  v_exp_f32 v74, v74
  v_cvt_pk_bf16_f32 v92, v72, v73
  v_mfma_f32_32x32x16_bf16 v[136:151], v[104:107], v[88:91], v[136:151]
  v_exp_f32 v75, v75
  v_exp_f32 v76, v76
  v_cvt_pk_bf16_f32 v93, v74, v75
  v_exp_f32 v77, v77
  v_exp_f32 v78, v78
  v_cvt_pk_bf16_f32 v94, v76, v77
  v_exp_f32 v79, v79
  s_waitcnt lgkmcnt(0)
  v_cvt_pk_bf16_f32 v95, v78, v79
  s_waitcnt vmcnt(10)
  s_barrier
  s_cmp_ge_u32 s2, 172
  s_cbranch_scc1 L_p2_nou1
  s_mov_b32 m0, s54
  s_nop 0
  global_load_lds_dwordx4 v232, s[44:45]
  s_add_u32 m0, s54, 1024
  s_nop 0
  global_load_lds_dwordx4 v236, s[46:47]
L_p2_nou1:
  v_mfma_f32_32x32x16_bf16 v[64:79], v[100:103], v[12:15], v[32:47]
  ds_read_b128 v[96:99], v4 offset:4096
  v_exp_f32 v48, v48
  v_exp_f32 v49, v49
  v_mfma_f32_32x32x16_bf16 v[136:151], v[108:111], v[92:95], v[136:151]
  v_exp_f32 v50, v50
  v_cvt_pk_bf16_f32 v80, v48, v49
  v_exp_f32 v51, v51
  v_exp_f32 v52, v52
  v_cvt_pk_bf16_f32 v81, v50, v51
  v_exp_f32 v53, v53
  v_exp_f32 v54, v54
  v_cvt_pk_bf16_f32 v82, v52, v53
  v_exp_f32 v55, v55
  v_exp_f32 v56, v56
  v_cvt_pk_bf16_f32 v83, v54, v55
  v_exp_f32 v57, v57
  v_exp_f32 v58, v58
  v_cvt_pk_bf16_f32 v84, v56, v57
  v_mfma_f32_32x32x16_bf16 v[120:135], v[112:115], v[80:83], v[120:135]
  v_exp_f32 v59, v59
  v_exp_f32 v60, v60
  v_cvt_pk_bf16_f32 v85, v58, v59
  v_exp_f32 v61, v61
  v_exp_f32 v62, v62
  v_cvt_pk_bf16_f32 v86, v60, v61
  v_exp_f32 v63, v63
  s_waitcnt lgkmcnt(0)
  v_cvt_pk_bf16_f32 v87, v62, v63
  v_mfma_f32_32x32x16_bf16 v[48:63], v[96:99], v[8:11], v[16:31]
  s_mov_b64 exec, s[34:35]
  ds_read_b128 v[104:107], v5 offset:4096
  s_mov_b64 exec, -1
  v_exp_f32 v64, v64
  v_exp_f32 v65, v65
  v_mfma_f32_32x32x16_bf16 v[120:135], v[116:119], v[84:87], v[120:135]
  v_exp_f32 v66, v66
  v_cvt_pk_bf16_f32 v88, v64, v65
  v_exp_f32 v67, v67
  s_mov_b64 exec, s[34:35]
  ds_read_b128 v[108:111], v5 offset:4608
  s_mov_b64 exec, -1
  v_exp_f32 v68, v68
  v_cvt_pk_bf16_f32 v89, v66, v67
  v_exp_f32 v69, v69
  v_exp_f32 v70, v70
  v_cvt_pk_bf16_f32 v90, v68, v69
  v_exp_f32 v71, v71
  v_exp_f32 v72, v72
  v_cvt_pk_bf16_f32 v91, v70, v71
  v_exp_f32 v73, v73
  v_exp_f32 v74, v74
  v_cvt_pk_bf16_f32 v92, v72, v73
  v_mfma_f32_32x32x16_bf16 v[136:151], v[112:115], v[88:91], v[136:151]
  v_exp_f32 v75, v75
  v_exp_f32 v76, v76
  v_cvt_pk_bf16_f32 v93, v74, v75
  v_exp_f32 v77, v77
  v_exp_f32 v78, v78
  v_cvt_pk_bf16_f32 v94, v76, v77
  v_exp_f32 v79, v79
  s_waitcnt lgkmcnt(0)
  v_cvt_pk_bf16_f32 v95, v78, v79
  v_mfma_f32_32x32x16_bf16 v[64:79], v[96:99], v[12:15], v[32:47]
  ds_read_b128 v[100:103], v4 offset:5120
  v_exp_f32 v48, v48
  v_exp_f32 v49, v49
  v_mfma_f32_32x32x16_bf16 v[136:151], v[116:119], v[92:95], v[136:151]
  v_exp_f32 v50, v50
  v_cvt_pk_bf16_f32 v80, v48, v49
  v_exp_f32 v51, v51
  v_exp_f32 v52, v52
  v_cvt_pk_bf16_f32 v81, v50, v51
  v_exp_f32 v53, v53
  v_exp_f32 v54, v54
  v_cvt_pk_bf16_f32 v82, v52, v53
  v_exp_f32 v55, v55
  v_exp_f32 v56, v56
  v_cvt_pk_bf16_f32 v83, v54, v55
  v_exp_f32 v57, v57
  v_exp_f32 v58, v58
  v_cvt_pk_bf16_f32 v84, v56, v57
  v_mfma_f32_32x32x16_bf16 v[120:135], v[104:107], v[80:83], v[120:135]
  v_exp_f32 v59, v59
  v_exp_f32 v60, v60
  v_cvt_pk_bf16_f32 v85, v58, v59
  v_exp_f32 v61, v61
  v_exp_f32 v62, v62
  v_cvt_pk_bf16_f32 v86, v60, v61
  v_exp_f32 v63, v63
  s_waitcnt lgkmcnt(0)
  v_cvt_pk_bf16_f32 v87, v62, v63
  v_mfma_f32_32x32x16_bf16 v[48:63], v[100:103], v[8:11], v[16:31]
  s_mov_b64 exec, s[34:35]
  ds_read_b128 v[112:115], v5 offset:5120
  s_mov_b64 exec, -1
  v_exp_f32 v64, v64
  v_exp_f32 v65, v65
  v_mfma_f32_32x32x16_bf16 v[120:135], v[108:111], v[84:87], v[120:135]
  v_exp_f32 v66, v66
  v_cvt_pk_bf16_f32 v88, v64, v65
  v_exp_f32 v67, v67
  s_mov_b64 exec, s[34:35]
  ds_read_b128 v[116:119], v5 offset:5632
  s_mov_b64 exec, -1
  v_exp_f32 v68, v68
  v_cvt_pk_bf16_f32 v89, v66, v67
  v_exp_f32 v69, v69
  v_exp_f32 v70, v70
  v_cvt_pk_bf16_f32 v90, v68, v69
  v_exp_f32 v71, v71
  v_exp_f32 v72, v72
  v_cvt_pk_bf16_f32 v91, v70, v71
  v_exp_f32 v73, v73
  v_exp_f32 v74, v74
  v_cvt_pk_bf16_f32 v92, v72, v73
  v_mfma_f32_32x32x16_bf16 v[136:151], v[104:107], v[88:91], v[136:151]
  v_exp_f32 v75, v75
  v_exp_f32 v76, v76
  v_cvt_pk_bf16_f32 v93, v74, v75
  v_exp_f32 v77, v77
  v_exp_f32 v78, v78
  v_cvt_pk_bf16_f32 v94, v76, v77
  v_exp_f32 v79, v79
  s_waitcnt lgkmcnt(0)
  v_cvt_pk_bf16_f32 v95, v78, v79
  v_mfma_f32_32x32x16_bf16 v[64:79], v[100:103], v[12:15], v[32:47]
  ds_read_b128 v[96:99], v4 offset:6144
  v_exp_f32 v48, v48
  v_exp_f32 v49, v49
  v_mfma_f32_32x32x16_bf16 v[136:151], v[108:111], v[92:95], v[136:151]
  v_exp_f32 v50, v50
  v_cvt_pk_bf16_f32 v80, v48, v49
  v_exp_f32 v51, v51
  v_exp_f32 v52, v52
  v_cvt_pk_bf16_f32 v81, v50, v51
  v_exp_f32 v53, v53
  v_exp_f32 v54, v54
  v_cvt_pk_bf16_f32 v82, v52, v53
  v_exp_f32 v55, v55
  v_exp_f32 v56, v56
  v_cvt_pk_bf16_f32 v83, v54, v55
  v_exp_f32 v57, v57
  v_exp_f32 v58, v58
  v_cvt_pk_bf16_f32 v84, v56, v57
  v_mfma_f32_32x32x16_bf16 v[120:135], v[112:115], v[80:83], v[120:135]
  v_exp_f32 v59, v59
  v_exp_f32 v60, v60
  v_cvt_pk_bf16_f32 v85, v58, v59
  v_exp_f32 v61, v61
  v_exp_f32 v62, v62
  v_cvt_pk_bf16_f32 v86, v60, v61
  v_exp_f32 v63, v63
  s_waitcnt lgkmcnt(0)
  v_cvt_pk_bf16_f32 v87, v62, v63
  v_mfma_f32_32x32x16_bf16 v[48:63], v[96:99], v[8:11], v[16:31]
  s_mov_b64 exec, s[34:35]
  ds_read_b128 v[104:107], v5 offset:6144
  s_mov_b64 exec, -1
  v_exp_f32 v64, v64
  v_exp_f32 v65, v65
  v_mfma_f32_32x32x16_bf16 v[120:135], v[116:119], v[84:87], v[120:135]
  v_exp_f32 v66, v66
  v_cvt_pk_bf16_f32 v88, v64, v65
  v_exp_f32 v67, v67
  s_mov_b64 exec, s[34:35]
  ds_read_b128 v[108:111], v5 offset:6656
  s_mov_b64 exec, -1
  v_exp_f32 v68, v68
  v_cvt_pk_bf16_f32 v89, v66, v67
  v_exp_f32 v69, v69
  v_exp_f32 v70, v70
  v_cvt_pk_bf16_f32 v90, v68, v69
  v_exp_f32 v71, v71
  v_exp_f32 v72, v72
  v_cvt_pk_bf16_f32 v91, v70, v71
  v_exp_f32 v73, v73
  v_exp_f32 v74, v74
  v_cvt_pk_bf16_f32 v92, v72, v73
  v_mfma_f32_32x32x16_bf16 v[136:151], v[112:115], v[88:91], v[136:151]
  v_exp_f32 v75, v75
  v_exp_f32 v76, v76
  v_cvt_pk_bf16_f32 v93, v74, v75
  v_exp_f32 v77, v77
  v_exp_f32 v78, v78
  v_cvt_pk_bf16_f32 v94, v76, v77
  v_exp_f32 v79, v79
  s_waitcnt lgkmcnt(0)
  v_cvt_pk_bf16_f32 v95, v78, v79
  v_mfma_f32_32x32x16_bf16 v[64:79], v[96:99], v[12:15], v[32:47]
  ds_read_b128 v[100:103], v4 offset:7168
  v_exp_f32 v48, v48
  v_exp_f32 v49, v49
  v_mfma_f32_32x32x16_bf16 v[136:151], v[116:119], v[92:95], v[136:151]
  v_exp_f32 v50, v50
  v_cvt_pk_bf16_f32 v80, v48, v49
  v_exp_f32 v51, v51
  v_exp_f32 v52, v52
  v_cvt_pk_bf16_f32 v81, v50, v51
  v_exp_f32 v53, v53
  v_exp_f32 v54, v54
  v_cvt_pk_bf16_f32 v82, v52, v53
  v_exp_f32 v55, v55
  v_exp_f32 v56, v56
  v_cvt_pk_bf16_f32 v83, v54, v55
  v_exp_f32 v57, v57
  v_exp_f32 v58, v58
  v_cvt_pk_bf16_f32 v84, v56, v57
  v_mfma_f32_32x32x16_bf16 v[120:135], v[104:107], v[80:83], v[120:135]
  v_exp_f32 v59, v59
  v_exp_f32 v60, v60
  v_cvt_pk_bf16_f32 v85, v58, v59
  v_exp_f32 v61, v61
  v_exp_f32 v62, v62
  v_cvt_pk_bf16_f32 v86, v60, v61
  v_exp_f32 v63, v63
  s_waitcnt lgkmcnt(0)
  v_cvt_pk_bf16_f32 v87, v62, v63
  v_mfma_f32_32x32x16_bf16 v[48:63], v[100:103], v[8:11], v[16:31]
  s_mov_b64 exec, s[34:35]
  ds_read_b128 v[112:115], v5 offset:7168
  s_mov_b64 exec, -1
  v_exp_f32 v64, v64
  v_exp_f32 v65, v65
  v_mfma_f32_32x32x16_bf16 v[120:135], v[108:111], v[84:87], v[120:135]
  v_exp_f32 v66, v66
  v_cvt_pk_bf16_f32 v88, v64, v65
  v_exp_f32 v67, v67
  s_mov_b64 exec, s[34:35]
  ds_read_b128 v[116:119], v5 offset:7680
  s_mov_b64 exec, -1
  v_exp_f32 v68, v68
  v_cvt_pk_bf16_f32 v89, v66, v67
  v_exp_f32 v69, v69
  v_exp_f32 v70, v70
  v_cvt_pk_bf16_f32 v90, v68, v69
  v_exp_f32 v71, v71
  v_exp_f32 v72, v72
  v_cvt_pk_bf16_f32 v91, v70, v71
  v_exp_f32 v73, v73
  v_exp_f32 v74, v74
  v_cvt_pk_bf16_f32 v92, v72, v73
  v_mfma_f32_32x32x16_bf16 v[136:151], v[104:107], v[88:91], v[136:151]
  v_exp_f32 v75, v75
  v_exp_f32 v76, v76
  v_cvt_pk_bf16_f32 v93, v74, v75
  v_exp_f32 v77, v77
  v_exp_f32 v78, v78
  v_cvt_pk_bf16_f32 v94, v76, v77
  v_exp_f32 v79, v79
  s_waitcnt lgkmcnt(0)
  v_cvt_pk_bf16_f32 v95, v78, v79
  s_cmp_ge_u32 s2, 172
  s_cbranch_scc1 L_p2_w7a
  s_waitcnt vmcnt(2)
  s_branch L_p2_w7b
L_p2_w7a:
  s_waitcnt vmcnt(0)
L_p2_w7b:
  s_barrier
  v_mfma_f32_32x32x16_bf16 v[64:79], v[100:103], v[12:15], v[32:47]
  ds_read_b128 v[96:99], v4 offset:8192
  v_exp_f32 v48, v48
  v_exp_f32 v49, v49
  v_mfma_f32_32x32x16_bf16 v[136:151], v[108:111], v[92:95], v[136:151]
  v_exp_f32 v50, v50
  v_cvt_pk_bf16_f32 v80, v48, v49
  v_exp_f32 v51, v51
  v_exp_f32 v52, v52
  v_cvt_pk_bf16_f32 v81, v50, v51
  v_exp_f32 v53, v53
  v_exp_f32 v54, v54
  v_cvt_pk_bf16_f32 v82, v52, v53
  v_exp_f32 v55, v55
  v_exp_f32 v56, v56
  v_cvt_pk_bf16_f32 v83, v54, v55
  v_exp_f32 v57, v57
  v_exp_f32 v58, v58
  v_cvt_pk_bf16_f32 v84, v56, v57
  v_mfma_f32_32x32x16_bf16 v[120:135], v[112:115], v[80:83], v[120:135]
  v_exp_f32 v59, v59
  v_exp_f32 v60, v60
  v_cvt_pk_bf16_f32 v85, v58, v59
  v_exp_f32 v61, v61
  v_exp_f32 v62, v62
  v_cvt_pk_bf16_f32 v86, v60, v61
  v_exp_f32 v63, v63
  s_waitcnt lgkmcnt(0)
  v_cvt_pk_bf16_f32 v87, v62, v63
  v_mfma_f32_32x32x16_bf16 v[48:63], v[96:99], v[8:11], v[16:31]
  s_mov_b64 exec, s[34:35]
  ds_read_b128 v[104:107], v5 offset:8192
  s_mov_b64 exec, -1
  v_exp_f32 v64, v64
  v_exp_f32 v65, v65
  v_mfma_f32_32x32x16_bf16 v[120:135], v[116:119], v[84:87], v[120:135]
  v_exp_f32 v66, v66
  v_cvt_pk_bf16_f32 v88, v64, v65
  v_exp_f32 v67, v67
  s_mov_b64 exec, s[34:35]
  ds_read_b128 v[108:111], v5 offset:8704
  s_mov_b64 exec, -1
  v_exp_f32 v68, v68
  v_cvt_pk_bf16_f32 v89, v66, v67
  v_exp_f32 v69, v69
  v_exp_f32 v70, v70
  v_cvt_pk_bf16_f32 v90, v68, v69
  v_exp_f32 v71, v71
  v_exp_f32 v72, v72
  v_cvt_pk_bf16_f32 v91, v70, v71
  v_exp_f32 v73, v73
  v_exp_f32 v74, v74
  v_cvt_pk_bf16_f32 v92, v72, v73
  v_mfma_f32_32x32x16_bf16 v[136:151], v[112:115], v[88:91], v[136:151]
  v_exp_f32 v75, v75
  v_exp_f32 v76, v76
  v_cvt_pk_bf16_f32 v93, v74, v75
  v_exp_f32 v77, v77
  v_exp_f32 v78, v78
  v_cvt_pk_bf16_f32 v94, v76, v77
  v_exp_f32 v79, v79
  s_waitcnt lgkmcnt(0)
  v_cvt_pk_bf16_f32 v95, v78, v79
  v_mfma_f32_32x32x16_bf16 v[64:79], v[96:99], v[12:15], v[32:47]
  ds_read_b128 v[100:103], v4 offset:9216
  v_exp_f32 v48, v48
  v_exp_f32 v49, v49
  v_mfma_f32_32x32x16_bf16 v[136:151], v[116:119], v[92:95], v[136:151]
  v_exp_f32 v50, v50
  v_cvt_pk_bf16_f32 v80, v48, v49
  v_exp_f32 v51, v51
  v_exp_f32 v52, v52
  v_cvt_pk_bf16_f32 v81, v50, v51
  v_exp_f32 v53, v53
  v_exp_f32 v54, v54
  v_cvt_pk_bf16_f32 v82, v52, v53
  v_exp_f32 v55, v55
  v_exp_f32 v56, v56
  v_cvt_pk_bf16_f32 v83, v54, v55
  v_exp_f32 v57, v57
  v_exp_f32 v58, v58
  v_cvt_pk_bf16_f32 v84, v56, v57
  v_mfma_f32_32x32x16_bf16 v[120:135], v[104:107], v[80:83], v[120:135]
  v_exp_f32 v59, v59
  v_exp_f32 v60, v60
  v_cvt_pk_bf16_f32 v85, v58, v59
  v_exp_f32 v61, v61
  v_exp_f32 v62, v62
  v_cvt_pk_bf16_f32 v86, v60, v61
  v_exp_f32 v63, v63
  s_waitcnt lgkmcnt(0)
  v_cvt_pk_bf16_f32 v87, v62, v63
  v_mfma_f32_32x32x16_bf16 v[48:63], v[100:103], v[8:11], v[16:31]
  s_mov_b64 exec, s[34:35]
  ds_read_b128 v[112:115], v5 offset:9216
  s_mov_b64 exec, -1
  v_exp_f32 v64, v64
  v_exp_f32 v65, v65
  v_mfma_f32_32x32x16_bf16 v[120:135], v[108:111], v[84:87], v[120:135]
  v_exp_f32 v66, v66
  v_cvt_pk_bf16_f32 v88, v64, v65
  v_exp_f32 v67, v67
  s_mov_b64 exec, s[34:35]
  ds_read_b128 v[116:119], v5 offset:9728
  s_mov_b64 exec, -1
  v_exp_f32 v68, v68
  v_cvt_pk_bf16_f32 v89, v66, v67
  v_exp_f32 v69, v69
  v_exp_f32 v70, v70
  v_cvt_pk_bf16_f32 v90, v68, v69
  v_exp_f32 v71, v71
  v_exp_f32 v72, v72
  v_cvt_pk_bf16_f32 v91, v70, v71
  v_exp_f32 v73, v73
  v_exp_f32 v74, v74
  v_cvt_pk_bf16_f32 v92, v72, v73
  v_mfma_f32_32x32x16_bf16 v[136:151], v[104:107], v[88:91], v[136:151]
  v_exp_f32 v75, v75
  v_exp_f32 v76, v76
  v_cvt_pk_bf16_f32 v93, v74, v75
  v_exp_f32 v77, v77
  v_exp_f32 v78, v78
  v_cvt_pk_bf16_f32 v94, v76, v77
  v_exp_f32 v79, v79
  s_waitcnt lgkmcnt(0)
  v_cvt_pk_bf16_f32 v95, v78, v79
  s_cmp_ge_u32 s2, 172
  s_cbranch_scc1 Lu_mega_kernel_21
  s_waitcnt vmcnt(0)
  v_add_u32 v235, s52, v233
  v_add_u32 v236, s53, v233
  v_add_u32 v237, s53, v235
  ds_read_b64_tr_b16 v[240:241], v233
  ds_read_b64_tr_b16 v[242:243], v236
  ds_read_b64_tr_b16 v[244:245], v235
  ds_read_b64_tr_b16 v[246:247], v237
  s_lshl_b32 s40, s2, 3
  s_mul_i32 s40, s40, 24386
  s_lshr_b32 s40, s40, 20
  s_add_u32 s41, s39, -944
  s_mul_i32 s41, s41, 24386
  s_lshr_b32 s41, s41, 20
  s_cmp_eq_u32 s40, s41
  s_cselect_b32 s40, 0, 64
  s_add_u32 s40, s40, 155648
  v_and_b32 v238, 1, v2
  v_lshlrev_b32 v238, 4, v238
  v_lshrrev_b32 v239, 5, v2
  v_lshl_add_u32 v238, v239, 5, v238
  v_add_u32 v238, s40, v238
  ds_read_b128 v[196:199], v238
Lu_mega_kernel_21:
  v_mfma_f32_32x32x16_bf16 v[64:79], v[100:103], v[12:15], v[32:47]
  ds_read_b128 v[96:99], v4 offset:10240
  v_exp_f32 v48, v48
  v_exp_f32 v49, v49
  v_mfma_f32_32x32x16_bf16 v[136:151], v[108:111], v[92:95], v[136:151]
  v_exp_f32 v50, v50
  v_cvt_pk_bf16_f32 v80, v48, v49
  v_exp_f32 v51, v51
  v_exp_f32 v52, v52
  v_cvt_pk_bf16_f32 v81, v50, v51
  v_exp_f32 v53, v53
  v_exp_f32 v54, v54
  v_cvt_pk_bf16_f32 v82, v52, v53
  v_exp_f32 v55, v55
  v_exp_f32 v56, v56
  v_cvt_pk_bf16_f32 v83, v54, v55
  v_exp_f32 v57, v57
  v_exp_f32 v58, v58
  v_cvt_pk_bf16_f32 v84, v56, v57
  v_mfma_f32_32x32x16_bf16 v[120:135], v[112:115], v[80:83], v[120:135]
  v_exp_f32 v59, v59
  v_exp_f32 v60, v60
  v_cvt_pk_bf16_f32 v85, v58, v59
  v_exp_f32 v61, v61
  v_exp_f32 v62, v62
  v_cvt_pk_bf16_f32 v86, v60, v61
  v_exp_f32 v63, v63
  s_waitcnt lgkmcnt(0)
  v_cvt_pk_bf16_f32 v87, v62, v63
  v_mfma_f32_32x32x16_bf16 v[48:63], v[96:99], v[8:11], v[16:31]
  s_mov_b64 exec, s[34:35]
  ds_read_b128 v[104:107], v5 offset:10240
  s_mov_b64 exec, -1
  v_exp_f32 v64, v64
  v_exp_f32 v65, v65
  v_mfma_f32_32x32x16_bf16 v[120:135], v[116:119], v[84:87], v[120:135]
  v_exp_f32 v66, v66
  v_cvt_pk_bf16_f32 v88, v64, v65
  v_exp_f32 v67, v67
  s_mov_b64 exec, s[34:35]
  ds_read_b128 v[108:111], v5 offset:10752
  s_mov_b64 exec, -1
  v_exp_f32 v68, v68
  v_cvt_pk_bf16_f32 v89, v66, v67
  v_exp_f32 v69, v69
  v_exp_f32 v70, v70
  v_cvt_pk_bf16_f32 v90, v68, v69
  v_exp_f32 v71, v71
  v_exp_f32 v72, v72
  v_cvt_pk_bf16_f32 v91, v70, v71
  v_exp_f32 v73, v73
  v_exp_f32 v74, v74
  v_cvt_pk_bf16_f32 v92, v72, v73
  v_mfma_f32_32x32x16_bf16 v[136:151], v[112:115], v[88:91], v[136:151]
  v_exp_f32 v75, v75
  v_exp_f32 v76, v76
  v_cvt_pk_bf16_f32 v93, v74, v75
  v_exp_f32 v77, v77
  v_exp_f32 v78, v78
  v_cvt_pk_bf16_f32 v94, v76, v77
  v_exp_f32 v79, v79
  s_waitcnt lgkmcnt(0)
  v_cvt_pk_bf16_f32 v95, v78, v79
  s_cmp_ge_u32 s2, 172
  s_cbranch_scc1 Lu_mega_kernel_22
  buffer_store_dwordx4 v[240:243], v3, s[24:27], s48 offen sc1
  buffer_store_dwordx4 v[244:247], v3, s[24:27], s49 offen sc1
  v_mfma_f32_32x32x16_bf16 v[200:215], v[240:243], v[196:199], 0
  v_mfma_f32_32x32x16_bf16 v[216:231], v[244:247], v[196:199], 0
  v_and_b32 v238, 31, v2
  v_lshlrev_b32 v238, 5, v238
  v_lshl_add_u32 v238, v239, 7, v238
  v_add_u32 v238, s54, v238
  v_lshlrev_b32 v239, 2, v2
  v_add_u32 v237, s54, v239
  s_sub_u32 s40, s48, 14680064
  s_lshr_b32 s40, s40, 15
  s_lshl_b32 s40, s40, 8
  s_add_u32 s40, s40, 655360
Lu_mega_kernel_22:
  v_mfma_f32_32x32x16_bf16 v[64:79], v[96:99], v[12:15], v[32:47]
  ds_read_b128 v[100:103], v4 offset:11264
  v_exp_f32 v48, v48
  v_exp_f32 v49, v49
  v_mfma_f32_32x32x16_bf16 v[136:151], v[116:119], v[92:95], v[136:151]
  v_exp_f32 v50, v50
  v_cvt_pk_bf16_f32 v80, v48, v49
  v_exp_f32 v51, v51
  v_exp_f32 v52, v52
  v_cvt_pk_bf16_f32 v81, v50, v51
  v_exp_f32 v53, v53
  v_exp_f32 v54, v54
  v_cvt_pk_bf16_f32 v82, v52, v53
  v_exp_f32 v55, v55
  v_exp_f32 v56, v56
  v_cvt_pk_bf16_f32 v83, v54, v55
  v_exp_f32 v57, v57
  v_exp_f32 v58, v58
  v_cvt_pk_bf16_f32 v84, v56, v57
  v_mfma_f32_32x32x16_bf16 v[120:135], v[104:107], v[80:83], v[120:135]
  v_exp_f32 v59, v59
  v_exp_f32 v60, v60
  v_cvt_pk_bf16_f32 v85, v58, v59
  v_exp_f32 v61, v61
  v_exp_f32 v62, v62
  v_cvt_pk_bf16_f32 v86, v60, v61
  v_exp_f32 v63, v63
  s_waitcnt lgkmcnt(0)
  v_cvt_pk_bf16_f32 v87, v62, v63
  v_mfma_f32_32x32x16_bf16 v[48:63], v[100:103], v[8:11], v[16:31]
  s_mov_b64 exec, s[34:35]
  ds_read_b128 v[112:115], v5 offset:11264
  s_mov_b64 exec, -1
  v_exp_f32 v64, v64
  v_exp_f32 v65, v65
  v_mfma_f32_32x32x16_bf16 v[120:135], v[108:111], v[84:87], v[120:135]
  v_exp_f32 v66, v66
  v_cvt_pk_bf16_f32 v88, v64, v65
  v_exp_f32 v67, v67
  s_mov_b64 exec, s[34:35]
  ds_read_b128 v[116:119], v5 offset:11776
  s_mov_b64 exec, -1
  v_exp_f32 v68, v68
  v_cvt_pk_bf16_f32 v89, v66, v67
  v_exp_f32 v69, v69
  v_exp_f32 v70, v70
  v_cvt_pk_bf16_f32 v90, v68, v69
  v_exp_f32 v71, v71
  v_exp_f32 v72, v72
  v_cvt_pk_bf16_f32 v91, v70, v71
  v_exp_f32 v73, v73
  v_exp_f32 v74, v74
  v_cvt_pk_bf16_f32 v92, v72, v73
  v_mfma_f32_32x32x16_bf16 v[136:151], v[104:107], v[88:91], v[136:151]
  v_exp_f32 v75, v75
  v_exp_f32 v76, v76
  v_cvt_pk_bf16_f32 v93, v74, v75
  v_exp_f32 v77, v77
  v_exp_f32 v78, v78
  v_cvt_pk_bf16_f32 v94, v76, v77
  v_exp_f32 v79, v79
  s_waitcnt lgkmcnt(0)
  v_cvt_pk_bf16_f32 v95, v78, v79
  s_cmp_ge_u32 s2, 172
  s_cbranch_scc1 Lu_mega_kernel_23
  s_mov_b32 exec_lo, 3
  s_mov_b32 exec_hi, 3
  ds_write_b128 v238, v[200:203] offset:0
  ds_write_b128 v238, v[204:207] offset:16
  ds_write_b128 v238, v[208:211] offset:64
  ds_write_b128 v238, v[212:215] offset:80
  ds_write_b128 v238, v[216:219] offset:256
  ds_write_b128 v238, v[220:223] offset:272
  ds_write_b128 v238, v[224:227] offset:320
  ds_write_b128 v238, v[228:231] offset:336
  s_mov_b64 exec, -1
Lu_mega_kernel_23:
  v_mfma_f32_32x32x16_bf16 v[64:79], v[100:103], v[12:15], v[32:47]
  ds_read_b128 v[96:99], v4 offset:12288
  v_exp_f32 v48, v48
  v_exp_f32 v49, v49
  v_mfma_f32_32x32x16_bf16 v[136:151], v[108:111], v[92:95], v[136:151]
  v_exp_f32 v50, v50
  v_cvt_pk_bf16_f32 v80, v48, v49
  v_exp_f32 v51, v51
  v_exp_f32 v52, v52
  v_cvt_pk_bf16_f32 v81, v50, v51
  v_exp_f32 v53, v53
  v_exp_f32 v54, v54
  v_cvt_pk_bf16_f32 v82, v52, v53
  v_exp_f32 v55, v55
  v_exp_f32 v56, v56
  v_cvt_pk_bf16_f32 v83, v54, v55
  v_exp_f32 v57, v57
  v_exp_f32 v58, v58
  v_cvt_pk_bf16_f32 v84, v56, v57
  v_mfma_f32_32x32x16_bf16 v[120:135], v[112:115], v[80:83], v[120:135]
  v_exp_f32 v59, v59
  v_exp_f32 v60, v60
  v_cvt_pk_bf16_f32 v85, v58, v59
  v_exp_f32 v61, v61
  v_exp_f32 v62, v62
  v_cvt_pk_bf16_f32 v86, v60, v61
  v_exp_f32 v63, v63
  s_waitcnt lgkmcnt(0)
  v_cvt_pk_bf16_f32 v87, v62, v63
  v_mfma_f32_32x32x16_bf16 v[48:63], v[96:99], v[8:11], v[16:31]
  s_mov_b64 exec, s[34:35]
  ds_read_b128 v[104:107], v5 offset:12288
  s_mov_b64 exec, -1
  v_exp_f32 v64, v64
  v_exp_f32 v65, v65
  v_mfma_f32_32x32x16_bf16 v[120:135], v[116:119], v[84:87], v[120:135]
  v_exp_f32 v66, v66
  v_cvt_pk_bf16_f32 v88, v64, v65
  v_exp_f32 v67, v67
  s_mov_b64 exec, s[34:35]
  ds_read_b128 v[108:111], v5 offset:12800
  s_mov_b64 exec, -1
  v_exp_f32 v68, v68
  v_cvt_pk_bf16_f32 v89, v66, v67
  v_exp_f32 v69, v69
  v_exp_f32 v70, v70
  v_cvt_pk_bf16_f32 v90, v68, v69
  v_exp_f32 v71, v71
  v_exp_f32 v72, v72
  v_cvt_pk_bf16_f32 v91, v70, v71
  v_exp_f32 v73, v73
  v_exp_f32 v74, v74
  v_cvt_pk_bf16_f32 v92, v72, v73
  v_mfma_f32_32x32x16_bf16 v[136:151], v[112:115], v[88:91], v[136:151]
  v_exp_f32 v75, v75
  v_exp_f32 v76, v76
  v_cvt_pk_bf16_f32 v93, v74, v75
  v_exp_f32 v77, v77
  v_exp_f32 v78, v78
  v_cvt_pk_bf16_f32 v94, v76, v77
  v_exp_f32 v79, v79
  s_waitcnt lgkmcnt(0)
  v_cvt_pk_bf16_f32 v95, v78, v79
  s_cmp_ge_u32 s2, 172
  s_cbranch_scc1 Lu_mega_kernel_24
  ds_read_b32 v200, v237
  ds_read_b32 v201, v237 offset:256
Lu_mega_kernel_24:
  v_mfma_f32_32x32x16_bf16 v[64:79], v[96:99], v[12:15], v[32:47]
  ds_read_b128 v[100:103], v4 offset:13312
  v_exp_f32 v48, v48
  v_exp_f32 v49, v49
  v_mfma_f32_32x32x16_bf16 v[136:151], v[116:119], v[92:95], v[136:151]
  v_exp_f32 v50, v50
  v_cvt_pk_bf16_f32 v80, v48, v49
  v_exp_f32 v51, v51
  v_exp_f32 v52, v52
  v_cvt_pk_bf16_f32 v81, v50, v51
  v_exp_f32 v53, v53
  v_exp_f32 v54, v54
  v_cvt_pk_bf16_f32 v82, v52, v53
  v_exp_f32 v55, v55
  v_exp_f32 v56, v56
  v_cvt_pk_bf16_f32 v83, v54, v55
  v_exp_f32 v57, v57
  v_exp_f32 v58, v58
  v_cvt_pk_bf16_f32 v84, v56, v57
  v_mfma_f32_32x32x16_bf16 v[120:135], v[104:107], v[80:83], v[120:135]
  v_exp_f32 v59, v59
  v_exp_f32 v60, v60
  v_cvt_pk_bf16_f32 v85, v58, v59
  v_exp_f32 v61, v61
  v_exp_f32 v62, v62
  v_cvt_pk_bf16_f32 v86, v60, v61
  v_exp_f32 v63, v63
  s_waitcnt lgkmcnt(0)
  v_cvt_pk_bf16_f32 v87, v62, v63
  v_mfma_f32_32x32x16_bf16 v[48:63], v[100:103], v[8:11], v[16:31]
  s_mov_b64 exec, s[34:35]
  ds_read_b128 v[112:115], v5 offset:13312
  s_mov_b64 exec, -1
  v_exp_f32 v64, v64
  v_exp_f32 v65, v65
  v_mfma_f32_32x32x16_bf16 v[120:135], v[108:111], v[84:87], v[120:135]
  v_exp_f32 v66, v66
  v_cvt_pk_bf16_f32 v88, v64, v65
  v_exp_f32 v67, v67
  s_mov_b64 exec, s[34:35]
  ds_read_b128 v[116:119], v5 offset:13824
  s_mov_b64 exec, -1
  v_exp_f32 v68, v68
  v_cvt_pk_bf16_f32 v89, v66, v67
  v_exp_f32 v69, v69
  v_exp_f32 v70, v70
  v_cvt_pk_bf16_f32 v90, v68, v69
  v_exp_f32 v71, v71
  v_exp_f32 v72, v72
  v_cvt_pk_bf16_f32 v91, v70, v71
  v_exp_f32 v73, v73
  v_exp_f32 v74, v74
  v_cvt_pk_bf16_f32 v92, v72, v73
  v_mfma_f32_32x32x16_bf16 v[136:151], v[104:107], v[88:91], v[136:151]
  v_exp_f32 v75, v75
  v_exp_f32 v76, v76
  v_cvt_pk_bf16_f32 v93, v74, v75
  v_exp_f32 v77, v77
  v_exp_f32 v78, v78
  v_cvt_pk_bf16_f32 v94, v76, v77
  v_exp_f32 v79, v79
  s_waitcnt lgkmcnt(0)
  v_cvt_pk_bf16_f32 v95, v78, v79
  s_cmp_ge_u32 s2, 172
  s_cbranch_scc1 Lu_mega_kernel_25
  buffer_atomic_add_f32 v200, v239, s[24:27], s40 offen sc1
  buffer_atomic_add_f32 v201, v239, s[24:27], s40 offen offset:256 sc1
Lu_mega_kernel_25:
  v_mfma_f32_32x32x16_bf16 v[64:79], v[100:103], v[12:15], v[32:47]
  ds_read_b128 v[96:99], v4 offset:14336
  v_exp_f32 v48, v48
  v_exp_f32 v49, v49
  v_mfma_f32_32x32x16_bf16 v[136:151], v[108:111], v[92:95], v[136:151]
  v_exp_f32 v50, v50
  v_cvt_pk_bf16_f32 v80, v48, v49
  v_exp_f32 v51, v51
  v_exp_f32 v52, v52
  v_cvt_pk_bf16_f32 v81, v50, v51
  v_exp_f32 v53, v53
  v_exp_f32 v54, v54
  v_cvt_pk_bf16_f32 v82, v52, v53
  v_exp_f32 v55, v55
  v_exp_f32 v56, v56
  v_cvt_pk_bf16_f32 v83, v54, v55
  v_exp_f32 v57, v57
  v_exp_f32 v58, v58
  v_cvt_pk_bf16_f32 v84, v56, v57
  v_mfma_f32_32x32x16_bf16 v[120:135], v[112:115], v[80:83], v[120:135]
  v_exp_f32 v59, v59
  v_exp_f32 v60, v60
  v_cvt_pk_bf16_f32 v85, v58, v59
  v_exp_f32 v61, v61
  v_exp_f32 v62, v62
  v_cvt_pk_bf16_f32 v86, v60, v61
  v_exp_f32 v63, v63
  s_waitcnt lgkmcnt(0)
  v_cvt_pk_bf16_f32 v87, v62, v63
  v_mfma_f32_32x32x16_bf16 v[48:63], v[96:99], v[8:11], v[16:31]
  s_mov_b64 exec, s[34:35]
  ds_read_b128 v[104:107], v5 offset:14336
  s_mov_b64 exec, -1
  v_exp_f32 v64, v64
  v_exp_f32 v65, v65
  v_mfma_f32_32x32x16_bf16 v[120:135], v[116:119], v[84:87], v[120:135]
  v_exp_f32 v66, v66
  v_cvt_pk_bf16_f32 v88, v64, v65
  v_exp_f32 v67, v67
  s_mov_b64 exec, s[34:35]
  ds_read_b128 v[108:111], v5 offset:14848
  s_mov_b64 exec, -1
  v_exp_f32 v68, v68
  v_cvt_pk_bf16_f32 v89, v66, v67
  v_exp_f32 v69, v69
  v_exp_f32 v70, v70
  v_cvt_pk_bf16_f32 v90, v68, v69
  v_exp_f32 v71, v71
  v_exp_f32 v72, v72
  v_cvt_pk_bf16_f32 v91, v70, v71
  v_exp_f32 v73, v73
  v_exp_f32 v74, v74
  v_cvt_pk_bf16_f32 v92, v72, v73
  v_mfma_f32_32x32x16_bf16 v[136:151], v[112:115], v[88:91], v[136:151]
  v_exp_f32 v75, v75
  v_exp_f32 v76, v76
  v_cvt_pk_bf16_f32 v93, v74, v75
  v_exp_f32 v77, v77
  v_exp_f32 v78, v78
  v_cvt_pk_bf16_f32 v94, v76, v77
  v_exp_f32 v79, v79
  s_waitcnt lgkmcnt(0)
  v_cvt_pk_bf16_f32 v95, v78, v79
  v_mfma_f32_32x32x16_bf16 v[64:79], v[96:99], v[12:15], v[32:47]
  ds_read_b128 v[100:103], v4 offset:15360
  v_exp_f32 v48, v48
  v_exp_f32 v49, v49
  v_mfma_f32_32x32x16_bf16 v[136:151], v[116:119], v[92:95], v[136:151]
  v_exp_f32 v50, v50
  v_cvt_pk_bf16_f32 v80, v48, v49
  v_exp_f32 v51, v51
  v_exp_f32 v52, v52
  v_cvt_pk_bf16_f32 v81, v50, v51
  v_exp_f32 v53, v53
  v_exp_f32 v54, v54
  v_cvt_pk_bf16_f32 v82, v52, v53
  v_exp_f32 v55, v55
  v_exp_f32 v56, v56
  v_cvt_pk_bf16_f32 v83, v54, v55
  v_exp_f32 v57, v57
  v_exp_f32 v58, v58
  v_cvt_pk_bf16_f32 v84, v56, v57
  v_mfma_f32_32x32x16_bf16 v[120:135], v[104:107], v[80:83], v[120:135]
  v_exp_f32 v59, v59
  v_exp_f32 v60, v60
  v_cvt_pk_bf16_f32 v85, v58, v59
  v_exp_f32 v61, v61
  v_exp_f32 v62, v62
  v_cvt_pk_bf16_f32 v86, v60, v61
  v_exp_f32 v63, v63
  s_waitcnt lgkmcnt(0)
  v_cvt_pk_bf16_f32 v87, v62, v63
  v_mfma_f32_32x32x16_bf16 v[48:63], v[100:103], v[8:11], v[16:31]
  s_mov_b64 exec, s[34:35]
  ds_read_b128 v[112:115], v5 offset:15360
  s_mov_b64 exec, -1
  v_exp_f32 v64, v64
  v_exp_f32 v65, v65
  v_mfma_f32_32x32x16_bf16 v[120:135], v[108:111], v[84:87], v[120:135]
  v_exp_f32 v66, v66
  v_cvt_pk_bf16_f32 v88, v64, v65
  v_exp_f32 v67, v67
  s_mov_b64 exec, s[34:35]
  ds_read_b128 v[116:119], v5 offset:15872
  s_mov_b64 exec, -1
  v_exp_f32 v68, v68
  v_cvt_pk_bf16_f32 v89, v66, v67
  v_exp_f32 v69, v69
  v_exp_f32 v70, v70
  v_cvt_pk_bf16_f32 v90, v68, v69
  v_exp_f32 v71, v71
  v_exp_f32 v72, v72
  v_cvt_pk_bf16_f32 v91, v70, v71
  v_exp_f32 v73, v73
  v_exp_f32 v74, v74
  v_cvt_pk_bf16_f32 v92, v72, v73
  v_mfma_f32_32x32x16_bf16 v[136:151], v[104:107], v[88:91], v[136:151]
  v_exp_f32 v75, v75
  v_exp_f32 v76, v76
  v_cvt_pk_bf16_f32 v93, v74, v75
  v_exp_f32 v77, v77
  v_exp_f32 v78, v78
  v_cvt_pk_bf16_f32 v94, v76, v77
  v_exp_f32 v79, v79
  s_waitcnt lgkmcnt(0)
  v_cvt_pk_bf16_f32 v95, v78, v79
  v_mfma_f32_32x32x16_bf16 v[64:79], v[100:103], v[12:15], v[32:47]
  ds_read_b128 v[96:99], v4 offset:16384
  v_exp_f32 v48, v48
  v_exp_f32 v49, v49
  v_mfma_f32_32x32x16_bf16 v[136:151], v[108:111], v[92:95], v[136:151]
  v_exp_f32 v50, v50
  v_cvt_pk_bf16_f32 v80, v48, v49
  v_exp_f32 v51, v51
  v_exp_f32 v52, v52
  v_cvt_pk_bf16_f32 v81, v50, v51
  v_exp_f32 v53, v53
  v_exp_f32 v54, v54
  v_cvt_pk_bf16_f32 v82, v52, v53
  v_exp_f32 v55, v55
  v_exp_f32 v56, v56
  v_cvt_pk_bf16_f32 v83, v54, v55
  v_exp_f32 v57, v57
  v_exp_f32 v58, v58
  v_cvt_pk_bf16_f32 v84, v56, v57
  v_mfma_f32_32x32x16_bf16 v[120:135], v[112:115], v[80:83], v[120:135]
  v_exp_f32 v59, v59
  v_exp_f32 v60, v60
  v_cvt_pk_bf16_f32 v85, v58, v59
  v_exp_f32 v61, v61
  v_exp_f32 v62, v62
  v_cvt_pk_bf16_f32 v86, v60, v61
  v_exp_f32 v63, v63
  s_waitcnt lgkmcnt(0)
  v_cvt_pk_bf16_f32 v87, v62, v63
  v_mfma_f32_32x32x16_bf16 v[48:63], v[96:99], v[8:11], v[16:31]
  s_mov_b64 exec, s[34:35]
  ds_read_b128 v[104:107], v5 offset:16384
  s_mov_b64 exec, -1
  v_exp_f32 v64, v64
  v_exp_f32 v65, v65
  v_mfma_f32_32x32x16_bf16 v[120:135], v[116:119], v[84:87], v[120:135]
  v_exp_f32 v66, v66
  v_cvt_pk_bf16_f32 v88, v64, v65
  v_exp_f32 v67, v67
  s_mov_b64 exec, s[34:35]
  ds_read_b128 v[108:111], v5 offset:16896
  s_mov_b64 exec, -1
  v_exp_f32 v68, v68
  v_cvt_pk_bf16_f32 v89, v66, v67
  v_exp_f32 v69, v69
  v_exp_f32 v70, v70
  v_cvt_pk_bf16_f32 v90, v68, v69
  v_exp_f32 v71, v71
  v_exp_f32 v72, v72
  v_cvt_pk_bf16_f32 v91, v70, v71
  v_exp_f32 v73, v73
  v_exp_f32 v74, v74
  v_cvt_pk_bf16_f32 v92, v72, v73
  v_mfma_f32_32x32x16_bf16 v[136:151], v[112:115], v[88:91], v[136:151]
  v_exp_f32 v75, v75
  v_exp_f32 v76, v76
  v_cvt_pk_bf16_f32 v93, v74, v75
  v_exp_f32 v77, v77
  v_exp_f32 v78, v78
  v_cvt_pk_bf16_f32 v94, v76, v77
  v_exp_f32 v79, v79
  s_waitcnt lgkmcnt(0)
  v_cvt_pk_bf16_f32 v95, v78, v79
  v_mfma_f32_32x32x16_bf16 v[64:79], v[96:99], v[12:15], v[32:47]
  ds_read_b128 v[100:103], v4 offset:17408
  v_exp_f32 v48, v48
  v_exp_f32 v49, v49
  v_mfma_f32_32x32x16_bf16 v[136:151], v[116:119], v[92:95], v[136:151]
  v_exp_f32 v50, v50
  v_cvt_pk_bf16_f32 v80, v48, v49
  v_exp_f32 v51, v51
  v_exp_f32 v52, v52
  v_cvt_pk_bf16_f32 v81, v50, v51
  v_exp_f32 v53, v53
  v_exp_f32 v54, v54
  v_cvt_pk_bf16_f32 v82, v52, v53
  v_exp_f32 v55, v55
  v_exp_f32 v56, v56
  v_cvt_pk_bf16_f32 v83, v54, v55
  v_exp_f32 v57, v57
  v_exp_f32 v58, v58
  v_cvt_pk_bf16_f32 v84, v56, v57
  v_mfma_f32_32x32x16_bf16 v[120:135], v[104:107], v[80:83], v[120:135]
  v_exp_f32 v59, v59
  v_exp_f32 v60, v60
  v_cvt_pk_bf16_f32 v85, v58, v59
  v_exp_f32 v61, v61
  v_exp_f32 v62, v62
  v_cvt_pk_bf16_f32 v86, v60, v61
  v_exp_f32 v63, v63
  s_waitcnt lgkmcnt(0)
  v_cvt_pk_bf16_f32 v87, v62, v63
  v_mfma_f32_32x32x16_bf16 v[48:63], v[100:103], v[8:11], v[16:31]
  s_mov_b64 exec, s[34:35]
  ds_read_b128 v[112:115], v5 offset:17408
  s_mov_b64 exec, -1
  v_exp_f32 v64, v64
  v_exp_f32 v65, v65
  v_mfma_f32_32x32x16_bf16 v[120:135], v[108:111], v[84:87], v[120:135]
  v_exp_f32 v66, v66
  v_cvt_pk_bf16_f32 v88, v64, v65
  v_exp_f32 v67, v67
  s_mov_b64 exec, s[34:35]
  ds_read_b128 v[116:119], v5 offset:17920
  s_mov_b64 exec, -1
  v_exp_f32 v68, v68
  v_cvt_pk_bf16_f32 v89, v66, v67
  v_exp_f32 v69, v69
  v_exp_f32 v70, v70
  v_cvt_pk_bf16_f32 v90, v68, v69
  v_exp_f32 v71, v71
  v_exp_f32 v72, v72
  v_cvt_pk_bf16_f32 v91, v70, v71
  v_exp_f32 v73, v73
  v_exp_f32 v74, v74
  v_cvt_pk_bf16_f32 v92, v72, v73
  v_mfma_f32_32x32x16_bf16 v[136:151], v[104:107], v[88:91], v[136:151]
  v_exp_f32 v75, v75
  v_exp_f32 v76, v76
  v_cvt_pk_bf16_f32 v93, v74, v75
  v_exp_f32 v77, v77
  v_exp_f32 v78, v78
  v_cvt_pk_bf16_f32 v94, v76, v77
  v_exp_f32 v79, v79
  s_waitcnt lgkmcnt(0)
  v_cvt_pk_bf16_f32 v95, v78, v79
  s_cmp_ge_u32 s2, 172
  s_cbranch_scc1 L_p2_nou3
  s_waitcnt vmcnt(0)
  s_sub_u32 s40, s39, 944
  s_lshl_b32 s40, s40, 7
  s_add_u32 s40, s40, 36044800
  v_mov_b32 v152, s40
  v_mov_b32 v153, s72
  s_mov_b64 exec, 1
  global_store_dword v152, v153, s[8:9] sc1
  s_mov_b64 exec, -1
L_p2_nou3:
  v_mfma_f32_32x32x16_bf16 v[64:79], v[100:103], v[12:15], v[32:47]
  ds_read_b128 v[96:99], v4 offset:18432
  v_exp_f32 v48, v48
  v_exp_f32 v49, v49
  v_mfma_f32_32x32x16_bf16 v[136:151], v[108:111], v[92:95], v[136:151]
  v_exp_f32 v50, v50
  v_cvt_pk_bf16_f32 v80, v48, v49
  v_exp_f32 v51, v51
  v_exp_f32 v52, v52
  v_cvt_pk_bf16_f32 v81, v50, v51
  v_exp_f32 v53, v53
  v_exp_f32 v54, v54
  v_cvt_pk_bf16_f32 v82, v52, v53
  v_exp_f32 v55, v55
  v_exp_f32 v56, v56
  v_cvt_pk_bf16_f32 v83, v54, v55
  v_exp_f32 v57, v57
  v_exp_f32 v58, v58
  v_cvt_pk_bf16_f32 v84, v56, v57
  v_mfma_f32_32x32x16_bf16 v[120:135], v[112:115], v[80:83], v[120:135]
  v_exp_f32 v59, v59
  v_exp_f32 v60, v60
  v_cvt_pk_bf16_f32 v85, v58, v59
  v_exp_f32 v61, v61
  v_exp_f32 v62, v62
  v_cvt_pk_bf16_f32 v86, v60, v61
  v_exp_f32 v63, v63
  s_waitcnt lgkmcnt(0)
  v_cvt_pk_bf16_f32 v87, v62, v63
  v_mfma_f32_32x32x16_bf16 v[48:63], v[96:99], v[8:11], v[16:31]
  s_mov_b64 exec, s[34:35]
  ds_read_b128 v[104:107], v5 offset:18432
  s_mov_b64 exec, -1
  v_exp_f32 v64, v64
  v_exp_f32 v65, v65
  v_mfma_f32_32x32x16_bf16 v[120:135], v[116:119], v[84:87], v[120:135]
  v_exp_f32 v66, v66
  v_cvt_pk_bf16_f32 v88, v64, v65
  v_exp_f32 v67, v67
  s_mov_b64 exec, s[34:35]
  ds_read_b128 v[108:111], v5 offset:18944
  s_mov_b64 exec, -1
  v_exp_f32 v68, v68
  v_cvt_pk_bf16_f32 v89, v66, v67
  v_exp_f32 v69, v69
  v_exp_f32 v70, v70
  v_cvt_pk_bf16_f32 v90, v68, v69
  v_exp_f32 v71, v71
  v_exp_f32 v72, v72
  v_cvt_pk_bf16_f32 v91, v70, v71
  v_exp_f32 v73, v73
  v_exp_f32 v74, v74
  v_cvt_pk_bf16_f32 v92, v72, v73
  v_mfma_f32_32x32x16_bf16 v[136:151], v[112:115], v[88:91], v[136:151]
  v_exp_f32 v75, v75
  v_exp_f32 v76, v76
  v_cvt_pk_bf16_f32 v93, v74, v75
  v_exp_f32 v77, v77
  v_exp_f32 v78, v78
  v_cvt_pk_bf16_f32 v94, v76, v77
  v_exp_f32 v79, v79
  s_waitcnt lgkmcnt(0)
  v_cvt_pk_bf16_f32 v95, v78, v79
  s_cmp_lt_u32 s2, 192
  s_cbranch_scc1 L_p2_nosm1
  s_sub_u32 s37, s2, 192
  s_and_b32 s58, s37, 7
  s_lshl_b32 s58, s58, 2
  s_bfe_u32 s47, s37, 0x20003
  s_add_u32 s58, s58, s47
  s_lshr_b32 s37, s37, 5
  s_mul_i32 s37, s37, 96
  s_add_u32 s58, s58, s37
  s_add_u32 s58, s58, 64
  s_lshl_b32 s47, s22, 6
  v_lshrrev_b32 v210, 1, v2
  v_add_u32 v210, s47, v210
  v_lshlrev_b32 v211, 1, v210
  global_load_ushort v208, v211, s[4:5] offset:0
  global_load_ushort v209, v211, s[4:5] offset:64
  v_mul_u32_u24 v211, 6144, v210
  v_and_b32 v212, 1, v2
  v_lshl_add_u32 v211, v212, 4, v211
  s_lshl_b32 s47, s58, 5
  v_add_u32 v211, s47, v211
  global_load_dwordx4 v[200:203], v211, s[6:7]
  v_add_u32 v211, 196608, v211
  global_load_dwordx4 v[204:207], v211, s[6:7]
L_p2_nosm1:
  s_load_dwordx2 s[12:13], s[0:1], 16
  s_load_dwordx2 s[14:15], s[0:1], 48
  s_lshr_b32 s44, s2, 3
  s_lshl_b32 s44, s44, 3
  s_add_u32 s44, s44, s22
  v_mfma_f32_32x32x16_bf16 v[64:79], v[96:99], v[12:15], v[32:47]
  ds_read_b128 v[100:103], v4 offset:19456
  v_exp_f32 v48, v48
  v_exp_f32 v49, v49
  v_mfma_f32_32x32x16_bf16 v[136:151], v[116:119], v[92:95], v[136:151]
  v_exp_f32 v50, v50
  v_cvt_pk_bf16_f32 v80, v48, v49
  v_exp_f32 v51, v51
  v_exp_f32 v52, v52
  v_cvt_pk_bf16_f32 v81, v50, v51
  v_exp_f32 v53, v53
  v_exp_f32 v54, v54
  v_cvt_pk_bf16_f32 v82, v52, v53
  v_exp_f32 v55, v55
  v_exp_f32 v56, v56
  v_cvt_pk_bf16_f32 v83, v54, v55
  v_exp_f32 v57, v57
  v_exp_f32 v58, v58
  v_cvt_pk_bf16_f32 v84, v56, v57
  v_mfma_f32_32x32x16_bf16 v[120:135], v[104:107], v[80:83], v[120:135]
  v_exp_f32 v59, v59
  v_exp_f32 v60, v60
  v_cvt_pk_bf16_f32 v85, v58, v59
  v_exp_f32 v61, v61
  v_exp_f32 v62, v62
  v_cvt_pk_bf16_f32 v86, v60, v61
  v_exp_f32 v63, v63
  s_waitcnt lgkmcnt(0)
  v_cvt_pk_bf16_f32 v87, v62, v63
  v_mfma_f32_32x32x16_bf16 v[48:63], v[100:103], v[8:11], v[16:31]
  s_mov_b64 exec, s[34:35]
  ds_read_b128 v[112:115], v5 offset:19456
  s_mov_b64 exec, -1
  v_exp_f32 v64, v64
  v_exp_f32 v65, v65
  v_mfma_f32_32x32x16_bf16 v[120:135], v[108:111], v[84:87], v[120:135]
  v_exp_f32 v66, v66
  v_cvt_pk_bf16_f32 v88, v64, v65
  v_exp_f32 v67, v67
  s_mov_b64 exec, s[34:35]
  ds_read_b128 v[116:119], v5 offset:19968
  s_mov_b64 exec, -1
  v_exp_f32 v68, v68
  v_cvt_pk_bf16_f32 v89, v66, v67
  v_exp_f32 v69, v69
  v_exp_f32 v70, v70
  v_cvt_pk_bf16_f32 v90, v68, v69
  v_exp_f32 v71, v71
  v_exp_f32 v72, v72
  v_cvt_pk_bf16_f32 v91, v70, v71
  v_exp_f32 v73, v73
  v_exp_f32 v74, v74
  v_cvt_pk_bf16_f32 v92, v72, v73
  v_mfma_f32_32x32x16_bf16 v[136:151], v[104:107], v[88:91], v[136:151]
  v_exp_f32 v75, v75
  v_exp_f32 v76, v76
  v_cvt_pk_bf16_f32 v93, v74, v75
  v_exp_f32 v77, v77
  v_exp_f32 v78, v78
  v_cvt_pk_bf16_f32 v94, v76, v77
  v_exp_f32 v79, v79
  s_waitcnt lgkmcnt(0)
  v_cvt_pk_bf16_f32 v95, v78, v79
  s_lshl_b32 s46, s44, 11
  s_add_u32 s46, s46, 0
  v_add_u32 v153, s46, v3
  global_load_dwordx4 v[156:159], v153, s[12:13]
  v_mfma_f32_32x32x16_bf16 v[64:79], v[100:103], v[12:15], v[32:47]
  ds_read_b128 v[96:99], v4 offset:20480
  v_exp_f32 v48, v48
  v_exp_f32 v49, v49
  v_mfma_f32_32x32x16_bf16 v[136:151], v[108:111], v[92:95], v[136:151]
  v_exp_f32 v50, v50
  v_cvt_pk_bf16_f32 v80, v48, v49
  v_exp_f32 v51, v51
  v_exp_f32 v52, v52
  v_cvt_pk_bf16_f32 v81, v50, v51
  v_exp_f32 v53, v53
  v_exp_f32 v54, v54
  v_cvt_pk_bf16_f32 v82, v52, v53
  v_exp_f32 v55, v55
  v_exp_f32 v56, v56
  v_cvt_pk_bf16_f32 v83, v54, v55
  v_exp_f32 v57, v57
  v_exp_f32 v58, v58
  v_cvt_pk_bf16_f32 v84, v56, v57
  v_mfma_f32_32x32x16_bf16 v[120:135], v[112:115], v[80:83], v[120:135]
  v_exp_f32 v59, v59
  v_exp_f32 v60, v60
  v_cvt_pk_bf16_f32 v85, v58, v59
  v_exp_f32 v61, v61
  v_exp_f32 v62, v62
  v_cvt_pk_bf16_f32 v86, v60, v61
  v_exp_f32 v63, v63
  s_waitcnt lgkmcnt(0)
  v_cvt_pk_bf16_f32 v87, v62, v63
  v_mfma_f32_32x32x16_bf16 v[48:63], v[96:99], v[8:11], v[16:31]
  s_mov_b64 exec, s[34:35]
  ds_read_b128 v[104:107], v5 offset:20480
  s_mov_b64 exec, -1
  v_exp_f32 v64, v64
  v_exp_f32 v65, v65
  v_mfma_f32_32x32x16_bf16 v[120:135], v[116:119], v[84:87], v[120:135]
  v_exp_f32 v66, v66
  v_cvt_pk_bf16_f32 v88, v64, v65
  v_exp_f32 v67, v67
  s_mov_b64 exec, s[34:35]
  ds_read_b128 v[108:111], v5 offset:20992
  s_mov_b64 exec, -1
  v_exp_f32 v68, v68
  v_cvt_pk_bf16_f32 v89, v66, v67
  v_exp_f32 v69, v69
  v_exp_f32 v70, v70
  v_cvt_pk_bf16_f32 v90, v68, v69
  v_exp_f32 v71, v71
  v_exp_f32 v72, v72
  v_cvt_pk_bf16_f32 v91, v70, v71
  v_exp_f32 v73, v73
  v_exp_f32 v74, v74
  v_cvt_pk_bf16_f32 v92, v72, v73
  v_mfma_f32_32x32x16_bf16 v[136:151], v[112:115], v[88:91], v[136:151]
  v_exp_f32 v75, v75
  v_exp_f32 v76, v76
  v_cvt_pk_bf16_f32 v93, v74, v75
  v_exp_f32 v77, v77
  v_exp_f32 v78, v78
  v_cvt_pk_bf16_f32 v94, v76, v77
  v_exp_f32 v79, v79
  s_waitcnt lgkmcnt(0)
  v_cvt_pk_bf16_f32 v95, v78, v79
  s_lshl_b32 s46, s44, 11
  s_add_u32 s46, s46, 1024
  v_add_u32 v153, s46, v3
  global_load_dwordx4 v[160:163], v153, s[12:13]
  v_mfma_f32_32x32x16_bf16 v[64:79], v[96:99], v[12:15], v[32:47]
  ds_read_b128 v[100:103], v4 offset:21504
  v_exp_f32 v48, v48
  v_exp_f32 v49, v49
  v_mfma_f32_32x32x16_bf16 v[136:151], v[116:119], v[92:95], v[136:151]
  v_exp_f32 v50, v50
  v_cvt_pk_bf16_f32 v80, v48, v49
  v_exp_f32 v51, v51
  v_exp_f32 v52, v52
  v_cvt_pk_bf16_f32 v81, v50, v51
  v_exp_f32 v53, v53
  v_exp_f32 v54, v54
  v_cvt_pk_bf16_f32 v82, v52, v53
  v_exp_f32 v55, v55
  v_exp_f32 v56, v56
  v_cvt_pk_bf16_f32 v83, v54, v55
  v_exp_f32 v57, v57
  v_exp_f32 v58, v58
  v_cvt_pk_bf16_f32 v84, v56, v57
  v_mfma_f32_32x32x16_bf16 v[120:135], v[104:107], v[80:83], v[120:135]
  v_exp_f32 v59, v59
  v_exp_f32 v60, v60
  v_cvt_pk_bf16_f32 v85, v58, v59
  v_exp_f32 v61, v61
  v_exp_f32 v62, v62
  v_cvt_pk_bf16_f32 v86, v60, v61
  v_exp_f32 v63, v63
  s_waitcnt lgkmcnt(0)
  v_cvt_pk_bf16_f32 v87, v62, v63
  v_mfma_f32_32x32x16_bf16 v[48:63], v[100:103], v[8:11], v[16:31]
  s_mov_b64 exec, s[34:35]
  ds_read_b128 v[112:115], v5 offset:21504
  s_mov_b64 exec, -1
  v_exp_f32 v64, v64
  v_exp_f32 v65, v65
  v_mfma_f32_32x32x16_bf16 v[120:135], v[108:111], v[84:87], v[120:135]
  v_exp_f32 v66, v66
  v_cvt_pk_bf16_f32 v88, v64, v65
  v_exp_f32 v67, v67
  s_mov_b64 exec, s[34:35]
  ds_read_b128 v[116:119], v5 offset:22016
  s_mov_b64 exec, -1
  v_exp_f32 v68, v68
  v_cvt_pk_bf16_f32 v89, v66, v67
  v_exp_f32 v69, v69
  v_exp_f32 v70, v70
  v_cvt_pk_bf16_f32 v90, v68, v69
  v_exp_f32 v71, v71
  v_exp_f32 v72, v72
  v_cvt_pk_bf16_f32 v91, v70, v71
  v_exp_f32 v73, v73
  v_exp_f32 v74, v74
  v_cvt_pk_bf16_f32 v92, v72, v73
  v_mfma_f32_32x32x16_bf16 v[136:151], v[104:107], v[88:91], v[136:151]
  v_exp_f32 v75, v75
  v_exp_f32 v76, v76
  v_cvt_pk_bf16_f32 v93, v74, v75
  v_exp_f32 v77, v77
  v_exp_f32 v78, v78
  v_cvt_pk_bf16_f32 v94, v76, v77
  v_exp_f32 v79, v79
  s_waitcnt lgkmcnt(0)
  v_cvt_pk_bf16_f32 v95, v78, v79
  v_mfma_f32_32x32x16_bf16 v[64:79], v[100:103], v[12:15], v[32:47]
  ds_read_b128 v[96:99], v4 offset:22528
  v_exp_f32 v48, v48
  v_exp_f32 v49, v49
  v_mfma_f32_32x32x16_bf16 v[136:151], v[108:111], v[92:95], v[136:151]
  v_exp_f32 v50, v50
  v_cvt_pk_bf16_f32 v80, v48, v49
  v_exp_f32 v51, v51
  v_exp_f32 v52, v52
  v_cvt_pk_bf16_f32 v81, v50, v51
  v_exp_f32 v53, v53
  v_exp_f32 v54, v54
  v_cvt_pk_bf16_f32 v82, v52, v53
  v_exp_f32 v55, v55
  v_exp_f32 v56, v56
  v_cvt_pk_bf16_f32 v83, v54, v55
  v_exp_f32 v57, v57
  v_exp_f32 v58, v58
  v_cvt_pk_bf16_f32 v84, v56, v57
  v_mfma_f32_32x32x16_bf16 v[120:135], v[112:115], v[80:83], v[120:135]
  v_exp_f32 v59, v59
  v_exp_f32 v60, v60
  v_cvt_pk_bf16_f32 v85, v58, v59
  v_exp_f32 v61, v61
  v_exp_f32 v62, v62
  v_cvt_pk_bf16_f32 v86, v60, v61
  v_exp_f32 v63, v63
  s_waitcnt lgkmcnt(0)
  v_cvt_pk_bf16_f32 v87, v62, v63
  v_mfma_f32_32x32x16_bf16 v[48:63], v[96:99], v[8:11], v[16:31]
  s_mov_b64 exec, s[34:35]
  ds_read_b128 v[104:107], v5 offset:22528
  s_mov_b64 exec, -1
  v_exp_f32 v64, v64
  v_exp_f32 v65, v65
  v_mfma_f32_32x32x16_bf16 v[120:135], v[116:119], v[84:87], v[120:135]
  v_exp_f32 v66, v66
  v_cvt_pk_bf16_f32 v88, v64, v65
  v_exp_f32 v67, v67
  s_mov_b64 exec, s[34:35]
  ds_read_b128 v[108:111], v5 offset:23040
  s_mov_b64 exec, -1
  v_exp_f32 v68, v68
  v_cvt_pk_bf16_f32 v89, v66, v67
  v_exp_f32 v69, v69
  v_exp_f32 v70, v70
  v_cvt_pk_bf16_f32 v90, v68, v69
  v_exp_f32 v71, v71
  v_exp_f32 v72, v72
  v_cvt_pk_bf16_f32 v91, v70, v71
  v_exp_f32 v73, v73
  v_exp_f32 v74, v74
  v_cvt_pk_bf16_f32 v92, v72, v73
  v_mfma_f32_32x32x16_bf16 v[136:151], v[112:115], v[88:91], v[136:151]
  v_exp_f32 v75, v75
  v_exp_f32 v76, v76
  v_cvt_pk_bf16_f32 v93, v74, v75
  v_exp_f32 v77, v77
  v_exp_f32 v78, v78
  v_cvt_pk_bf16_f32 v94, v76, v77
  v_exp_f32 v79, v79
  s_waitcnt lgkmcnt(0)
  v_cvt_pk_bf16_f32 v95, v78, v79
  s_cmp_lg_u32 s22, 0
  s_cbranch_scc1 L_p2_nw2
  v_min_u32 v153, 42, v2
  s_mul_i32 s46, s2, 43
  v_add_u32 v153, s46, v153
  v_lshlrev_b32 v153, 7, v153
  global_load_dword v164, v153, s[14:15]
L_p2_nw2:
  v_mfma_f32_32x32x16_bf16 v[64:79], v[96:99], v[12:15], v[32:47]
  ds_read_b128 v[100:103], v4 offset:23552
  v_exp_f32 v48, v48
  v_exp_f32 v49, v49
  v_mfma_f32_32x32x16_bf16 v[136:151], v[116:119], v[92:95], v[136:151]
  v_exp_f32 v50, v50
  v_cvt_pk_bf16_f32 v80, v48, v49
  v_exp_f32 v51, v51
  v_exp_f32 v52, v52
  v_cvt_pk_bf16_f32 v81, v50, v51
  v_exp_f32 v53, v53
  v_exp_f32 v54, v54
  v_cvt_pk_bf16_f32 v82, v52, v53
  v_exp_f32 v55, v55
  v_exp_f32 v56, v56
  v_cvt_pk_bf16_f32 v83, v54, v55
  v_exp_f32 v57, v57
  v_exp_f32 v58, v58
  v_cvt_pk_bf16_f32 v84, v56, v57
  v_mfma_f32_32x32x16_bf16 v[120:135], v[104:107], v[80:83], v[120:135]
  v_exp_f32 v59, v59
  v_exp_f32 v60, v60
  v_cvt_pk_bf16_f32 v85, v58, v59
  v_exp_f32 v61, v61
  v_exp_f32 v62, v62
  v_cvt_pk_bf16_f32 v86, v60, v61
  v_exp_f32 v63, v63
  s_waitcnt lgkmcnt(0)
  v_cvt_pk_bf16_f32 v87, v62, v63
  v_mfma_f32_32x32x16_bf16 v[48:63], v[100:103], v[8:11], v[16:31]
  s_mov_b64 exec, s[34:35]
  ds_read_b128 v[112:115], v5 offset:23552
  s_mov_b64 exec, -1
  v_exp_f32 v64, v64
  v_exp_f32 v65, v65
  v_mfma_f32_32x32x16_bf16 v[120:135], v[108:111], v[84:87], v[120:135]
  v_exp_f32 v66, v66
  v_cvt_pk_bf16_f32 v88, v64, v65
  v_exp_f32 v67, v67
  s_mov_b64 exec, s[34:35]
  ds_read_b128 v[116:119], v5 offset:24064
  s_mov_b64 exec, -1
  v_exp_f32 v68, v68
  v_cvt_pk_bf16_f32 v89, v66, v67
  v_exp_f32 v69, v69
  v_exp_f32 v70, v70
  v_cvt_pk_bf16_f32 v90, v68, v69
  v_exp_f32 v71, v71
  v_exp_f32 v72, v72
  v_cvt_pk_bf16_f32 v91, v70, v71
  v_exp_f32 v73, v73
  v_exp_f32 v74, v74
  v_cvt_pk_bf16_f32 v92, v72, v73
  v_mfma_f32_32x32x16_bf16 v[136:151], v[104:107], v[88:91], v[136:151]
  v_exp_f32 v75, v75
  v_exp_f32 v76, v76
  v_cvt_pk_bf16_f32 v93, v74, v75
  v_exp_f32 v77, v77
  v_exp_f32 v78, v78
  v_cvt_pk_bf16_f32 v94, v76, v77
  v_exp_f32 v79, v79
  s_waitcnt lgkmcnt(0)
  v_cvt_pk_bf16_f32 v95, v78, v79
  v_mfma_f32_32x32x16_bf16 v[64:79], v[100:103], v[12:15], v[32:47]
  ds_read_b128 v[96:99], v4 offset:24576
  v_exp_f32 v48, v48
  v_exp_f32 v49, v49
  v_mfma_f32_32x32x16_bf16 v[136:151], v[108:111], v[92:95], v[136:151]
  v_exp_f32 v50, v50
  v_cvt_pk_bf16_f32 v80, v48, v49
  v_exp_f32 v51, v51
  v_exp_f32 v52, v52
  v_cvt_pk_bf16_f32 v81, v50, v51
  v_exp_f32 v53, v53
  v_exp_f32 v54, v54
  v_cvt_pk_bf16_f32 v82, v52, v53
  v_exp_f32 v55, v55
  v_exp_f32 v56, v56
  v_cvt_pk_bf16_f32 v83, v54, v55
  v_exp_f32 v57, v57
  v_exp_f32 v58, v58
  v_cvt_pk_bf16_f32 v84, v56, v57
  v_mfma_f32_32x32x16_bf16 v[120:135], v[112:115], v[80:83], v[120:135]
  v_exp_f32 v59, v59
  v_exp_f32 v60, v60
  v_cvt_pk_bf16_f32 v85, v58, v59
  v_exp_f32 v61, v61
  v_exp_f32 v62, v62
  v_cvt_pk_bf16_f32 v86, v60, v61
  v_exp_f32 v63, v63
  s_waitcnt lgkmcnt(0)
  v_cvt_pk_bf16_f32 v87, v62, v63
  v_mfma_f32_32x32x16_bf16 v[48:63], v[96:99], v[8:11], v[16:31]
  s_mov_b64 exec, s[34:35]
  ds_read_b128 v[104:107], v5 offset:24576
  s_mov_b64 exec, -1
  v_exp_f32 v64, v64
  v_exp_f32 v65, v65
  v_mfma_f32_32x32x16_bf16 v[120:135], v[116:119], v[84:87], v[120:135]
  v_exp_f32 v66, v66
  v_cvt_pk_bf16_f32 v88, v64, v65
  v_exp_f32 v67, v67
  s_mov_b64 exec, s[34:35]
  ds_read_b128 v[108:111], v5 offset:25088
  s_mov_b64 exec, -1
  v_exp_f32 v68, v68
  v_cvt_pk_bf16_f32 v89, v66, v67
  v_exp_f32 v69, v69
  v_exp_f32 v70, v70
  v_cvt_pk_bf16_f32 v90, v68, v69
  v_exp_f32 v71, v71
  v_exp_f32 v72, v72
  v_cvt_pk_bf16_f32 v91, v70, v71
  v_exp_f32 v73, v73
  v_exp_f32 v74, v74
  v_cvt_pk_bf16_f32 v92, v72, v73
  v_mfma_f32_32x32x16_bf16 v[136:151], v[112:115], v[88:91], v[136:151]
  v_exp_f32 v75, v75
  v_exp_f32 v76, v76
  v_cvt_pk_bf16_f32 v93, v74, v75
  v_exp_f32 v77, v77
  v_exp_f32 v78, v78
  v_cvt_pk_bf16_f32 v94, v76, v77
  v_exp_f32 v79, v79
  s_waitcnt lgkmcnt(0)
  v_cvt_pk_bf16_f32 v95, v78, v79
  s_getpc_b64 s[44:45]
L_p2_pc:
  s_add_u32 s44, s44, L_p2_done-L_p2_pc
  s_addc_u32 s45, s45, 0
  s_lshr_b32 s46, s2, 3
  s_lshl_b32 s47, s22, 5
  s_add_u32 s46, s46, s47
  s_lshl_b32 s46, s46, 10
  v_add_u32 v153, s46, v3
  v_min_u32 v153, L_text_end-L_p2_done-16, v153
  global_load_dwordx4 v[192:195], v153, s[44:45]
  v_mfma_f32_32x32x16_bf16 v[64:79], v[96:99], v[12:15], v[32:47]
  ds_read_b128 v[100:103], v4 offset:25600
  v_exp_f32 v48, v48
  v_exp_f32 v49, v49
  v_mfma_f32_32x32x16_bf16 v[136:151], v[116:119], v[92:95], v[136:151]
  v_exp_f32 v50, v50
  v_cvt_pk_bf16_f32 v80, v48, v49
  v_exp_f32 v51, v51
  v_exp_f32 v52, v52
  v_cvt_pk_bf16_f32 v81, v50, v51
  v_exp_f32 v53, v53
  v_exp_f32 v54, v54
  v_cvt_pk_bf16_f32 v82, v52, v53
  v_exp_f32 v55, v55
  v_exp_f32 v56, v56
  v_cvt_pk_bf16_f32 v83, v54, v55
  v_exp_f32 v57, v57
  v_exp_f32 v58, v58
  v_cvt_pk_bf16_f32 v84, v56, v57
  v_mfma_f32_32x32x16_bf16 v[120:135], v[104:107], v[80:83], v[120:135]
  v_exp_f32 v59, v59
  v_exp_f32 v60, v60
  v_cvt_pk_bf16_f32 v85, v58, v59
  v_exp_f32 v61, v61
  v_exp_f32 v62, v62
  v_cvt_pk_bf16_f32 v86, v60, v61
  v_exp_f32 v63, v63
  s_waitcnt lgkmcnt(0)
  v_cvt_pk_bf16_f32 v87, v62, v63
  v_mfma_f32_32x32x16_bf16 v[48:63], v[100:103], v[8:11], v[16:31]
  s_mov_b64 exec, s[34:35]
  ds_read_b128 v[112:115], v5 offset:25600
  s_mov_b64 exec, -1
  v_exp_f32 v64, v64
  v_exp_f32 v65, v65
  v_mfma_f32_32x32x16_bf16 v[120:135], v[108:111], v[84:87], v[120:135]
  v_exp_f32 v66, v66
  v_cvt_pk_bf16_f32 v88, v64, v65
  v_exp_f32 v67, v67
  s_mov_b64 exec, s[34:35]
  ds_read_b128 v[116:119], v5 offset:26112
  s_mov_b64 exec, -1
  v_exp_f32 v68, v68
  v_cvt_pk_bf16_f32 v89, v66, v67
  v_exp_f32 v69, v69
  v_exp_f32 v70, v70
  v_cvt_pk_bf16_f32 v90, v68, v69
  v_exp_f32 v71, v71
  v_exp_f32 v72, v72
  v_cvt_pk_bf16_f32 v91, v70, v71
  v_exp_f32 v73, v73
  v_exp_f32 v74, v74
  v_cvt_pk_bf16_f32 v92, v72, v73
  v_mfma_f32_32x32x16_bf16 v[136:151], v[104:107], v[88:91], v[136:151]
  v_exp_f32 v75, v75
  v_exp_f32 v76, v76
  v_cvt_pk_bf16_f32 v93, v74, v75
  v_exp_f32 v77, v77
  v_exp_f32 v78, v78
  v_cvt_pk_bf16_f32 v94, v76, v77
  v_exp_f32 v79, v79
  s_waitcnt lgkmcnt(0)
  v_cvt_pk_bf16_f32 v95, v78, v79
  s_setprio 0
  v_mfma_f32_32x32x16_bf16 v[64:79], v[100:103], v[12:15], v[32:47]
  ds_read_b128 v[96:99], v4 offset:26624
  v_exp_f32 v48, v48
  v_exp_f32 v49, v49
  v_mfma_f32_32x32x16_bf16 v[136:151], v[108:111], v[92:95], v[136:151]
  v_exp_f32 v50, v50
  v_cvt_pk_bf16_f32 v80, v48, v49
  v_exp_f32 v51, v51
  v_exp_f32 v52, v52
  v_cvt_pk_bf16_f32 v81, v50, v51
  v_exp_f32 v53, v53
  v_exp_f32 v54, v54
  v_cvt_pk_bf16_f32 v82, v52, v53
  v_exp_f32 v55, v55
  v_exp_f32 v56, v56
  v_cvt_pk_bf16_f32 v83, v54, v55
  v_exp_f32 v57, v57
  v_exp_f32 v58, v58
  v_cvt_pk_bf16_f32 v84, v56, v57
  v_mfma_f32_32x32x16_bf16 v[120:135], v[112:115], v[80:83], v[120:135]
  v_exp_f32 v59, v59
  v_exp_f32 v60, v60
  v_cvt_pk_bf16_f32 v85, v58, v59
  v_exp_f32 v61, v61
  v_exp_f32 v62, v62
  v_cvt_pk_bf16_f32 v86, v60, v61
  v_exp_f32 v63, v63
  s_waitcnt lgkmcnt(0)
  v_cvt_pk_bf16_f32 v87, v62, v63
  v_mfma_f32_32x32x16_bf16 v[48:63], v[96:99], v[8:11], v[16:31]
  s_mov_b64 exec, s[34:35]
  ds_read_b128 v[104:107], v5 offset:26624
  s_mov_b64 exec, -1
  v_exp_f32 v64, v64
  v_exp_f32 v65, v65
  v_mfma_f32_32x32x16_bf16 v[120:135], v[116:119], v[84:87], v[120:135]
  v_exp_f32 v66, v66
  v_cvt_pk_bf16_f32 v88, v64, v65
  v_exp_f32 v67, v67
  s_mov_b64 exec, s[34:35]
  ds_read_b128 v[108:111], v5 offset:27136
  s_mov_b64 exec, -1
  v_exp_f32 v68, v68
  v_cvt_pk_bf16_f32 v89, v66, v67
  v_exp_f32 v69, v69
  v_exp_f32 v70, v70
  v_cvt_pk_bf16_f32 v90, v68, v69
  v_exp_f32 v71, v71
  v_exp_f32 v72, v72
  v_cvt_pk_bf16_f32 v91, v70, v71
  v_exp_f32 v73, v73
  v_exp_f32 v74, v74
  v_cvt_pk_bf16_f32 v92, v72, v73
  v_mfma_f32_32x32x16_bf16 v[136:151], v[112:115], v[88:91], v[136:151]
  v_exp_f32 v75, v75
  v_exp_f32 v76, v76
  v_cvt_pk_bf16_f32 v93, v74, v75
  v_exp_f32 v77, v77
  v_exp_f32 v78, v78
  v_cvt_pk_bf16_f32 v94, v76, v77
  v_exp_f32 v79, v79
  s_waitcnt lgkmcnt(0)
  v_cvt_pk_bf16_f32 v95, v78, v79
  v_mov_b32 v196, 36044800
  v_mov_b32 v198, 0
  s_cmp_lt_u32 s22, 4
  s_cbranch_scc1 L_p2_nc1
  s_and_b32 s66, s2, 1
  s_lshl_b32 s66, s66, 2
  s_bfe_u32 s67, s2, 0x20003
  s_add_u32 s66, s66, s67
  s_bfe_u32 s67, s2, 0x20001
  s_lshl_b32 s67, s67, 3
  s_lshr_b32 s64, s2, 5
  s_add_u32 s67, s67, s64
  s_mul_i32 s64, s67, 3
  s_lshl_b32 s65, s67, 1
  s_add_u32 s65, s65, 22
  s_cmp_lt_u32 s67, 22
  s_cselect_b32 s64, s64, s65
  s_cselect_b32 s65, 1, 0
  s_lshr_b32 s40, s64, 1
  s_add_u32 s41, s64, 2
  s_lshr_b32 s41, s41, 1
  s_min_u32 s41, s41, 42
  v_and_b32 v196, 31, v2
  v_mul_u32_u24 v196, 43, v196
  v_mov_b32 v197, s40
  v_mov_b32 v198, s41
  v_cmp_gt_u32 vcc, 32, v2
  s_nop 1
  v_cndmask_b32 v197, v198, v197, vcc
  v_add_u32 v196, v196, v197
  v_lshlrev_b32 v196, 7, v196
  v_add_u32 v196, 36044800, v196
  global_load_dword v197, v196, s[8:9] sc1
L_p2_nc1:
  v_mfma_f32_32x32x16_bf16 v[64:79], v[96:99], v[12:15], v[32:47]
  ds_read_b128 v[100:103], v4 offset:27648
  v_exp_f32 v48, v48
  v_exp_f32 v49, v49
  v_mfma_f32_32x32x16_bf16 v[136:151], v[116:119], v[92:95], v[136:151]
  v_exp_f32 v50, v50
  v_cvt_pk_bf16_f32 v80, v48, v49
  v_exp_f32 v51, v51
  v_exp_f32 v52, v52
  v_cvt_pk_bf16_f32 v81, v50, v51
  v_exp_f32 v53, v53
  v_exp_f32 v54, v54
  v_cvt_pk_bf16_f32 v82, v52, v53
  v_exp_f32 v55, v55
  v_exp_f32 v56, v56
  v_cvt_pk_bf16_f32 v83, v54, v55
  v_exp_f32 v57, v57
  v_exp_f32 v58, v58
  v_cvt_pk_bf16_f32 v84, v56, v57
  v_mfma_f32_32x32x16_bf16 v[120:135], v[104:107], v[80:83], v[120:135]
  v_exp_f32 v59, v59
  v_exp_f32 v60, v60
  v_cvt_pk_bf16_f32 v85, v58, v59
  v_exp_f32 v61, v61
  v_exp_f32 v62, v62
  v_cvt_pk_bf16_f32 v86, v60, v61
  v_exp_f32 v63, v63
  s_waitcnt lgkmcnt(0)
  v_cvt_pk_bf16_f32 v87, v62, v63
  v_mfma_f32_32x32x16_bf16 v[48:63], v[100:103], v[8:11], v[16:31]
  s_mov_b64 exec, s[34:35]
  ds_read_b128 v[112:115], v5 offset:27648
  s_mov_b64 exec, -1
  v_exp_f32 v64, v64
  v_exp_f32 v65, v65
  v_mfma_f32_32x32x16_bf16 v[120:135], v[108:111], v[84:87], v[120:135]
  v_exp_f32 v66, v66
  v_cvt_pk_bf16_f32 v88, v64, v65
  v_exp_f32 v67, v67
  s_mov_b64 exec, s[34:35]
  ds_read_b128 v[116:119], v5 offset:28160
  s_mov_b64 exec, -1
  v_exp_f32 v68, v68
  v_cvt_pk_bf16_f32 v89, v66, v67
  v_exp_f32 v69, v69
  v_exp_f32 v70, v70
  v_cvt_pk_bf16_f32 v90, v68, v69
  v_exp_f32 v71, v71
  v_exp_f32 v72, v72
  v_cvt_pk_bf16_f32 v91, v70, v71
  v_exp_f32 v73, v73
  v_exp_f32 v74, v74
  v_cvt_pk_bf16_f32 v92, v72, v73
  v_mfma_f32_32x32x16_bf16 v[136:151], v[104:107], v[88:91], v[136:151]
  v_exp_f32 v75, v75
  v_exp_f32 v76, v76
  v_cvt_pk_bf16_f32 v93, v74, v75
  v_exp_f32 v77, v77
  v_exp_f32 v78, v78
  v_cvt_pk_bf16_f32 v94, v76, v77
  v_exp_f32 v79, v79
  s_waitcnt lgkmcnt(0)
  v_cvt_pk_bf16_f32 v95, v78, v79
  v_mfma_f32_32x32x16_bf16 v[64:79], v[100:103], v[12:15], v[32:47]
  ds_read_b128 v[96:99], v4 offset:28672
  v_exp_f32 v48, v48
  v_exp_f32 v49, v49
  v_mfma_f32_32x32x16_bf16 v[136:151], v[108:111], v[92:95], v[136:151]
  v_exp_f32 v50, v50
  v_cvt_pk_bf16_f32 v80, v48, v49
  v_exp_f32 v51, v51
  v_exp_f32 v52, v52
  v_cvt_pk_bf16_f32 v81, v50, v51
  v_exp_f32 v53, v53
  v_exp_f32 v54, v54
  v_cvt_pk_bf16_f32 v82, v52, v53
  v_exp_f32 v55, v55
  v_exp_f32 v56, v56
  v_cvt_pk_bf16_f32 v83, v54, v55
  v_exp_f32 v57, v57
  v_exp_f32 v58, v58
  v_cvt_pk_bf16_f32 v84, v56, v57
  v_mfma_f32_32x32x16_bf16 v[120:135], v[112:115], v[80:83], v[120:135]
  v_exp_f32 v59, v59
  v_exp_f32 v60, v60
  v_cvt_pk_bf16_f32 v85, v58, v59
  v_exp_f32 v61, v61
  v_exp_f32 v62, v62
  v_cvt_pk_bf16_f32 v86, v60, v61
  v_exp_f32 v63, v63
  s_waitcnt lgkmcnt(0)
  v_cvt_pk_bf16_f32 v87, v62, v63
  v_mfma_f32_32x32x16_bf16 v[48:63], v[96:99], v[8:11], v[16:31]
  s_mov_b64 exec, s[34:35]
  ds_read_b128 v[104:107], v5 offset:28672
  s_mov_b64 exec, -1
  v_exp_f32 v64, v64
  v_exp_f32 v65, v65
  v_mfma_f32_32x32x16_bf16 v[120:135], v[116:119], v[84:87], v[120:135]
  v_exp_f32 v66, v66
  v_cvt_pk_bf16_f32 v88, v64, v65
  v_exp_f32 v67, v67
  s_mov_b64 exec, s[34:35]
  ds_read_b128 v[108:111], v5 offset:29184
  s_mov_b64 exec, -1
  v_exp_f32 v68, v68
  v_cvt_pk_bf16_f32 v89, v66, v67
  v_exp_f32 v69, v69
  v_exp_f32 v70, v70
  v_cvt_pk_bf16_f32 v90, v68, v69
  v_exp_f32 v71, v71
  v_exp_f32 v72, v72
  v_cvt_pk_bf16_f32 v91, v70, v71
  v_exp_f32 v73, v73
  v_exp_f32 v74, v74
  v_cvt_pk_bf16_f32 v92, v72, v73
  v_mfma_f32_32x32x16_bf16 v[136:151], v[112:115], v[88:91], v[136:151]
  v_exp_f32 v75, v75
  v_exp_f32 v76, v76
  v_cvt_pk_bf16_f32 v93, v74, v75
  v_exp_f32 v77, v77
  v_exp_f32 v78, v78
  v_cvt_pk_bf16_f32 v94, v76, v77
  v_exp_f32 v79, v79
  s_waitcnt lgkmcnt(0)
  v_cvt_pk_bf16_f32 v95, v78, v79
  v_mfma_f32_32x32x16_bf16 v[64:79], v[96:99], v[12:15], v[32:47]
  ds_read_b128 v[100:103], v4 offset:29696
  v_exp_f32 v48, v48
  v_exp_f32 v49, v49
  v_mfma_f32_32x32x16_bf16 v[136:151], v[116:119], v[92:95], v[136:151]
  v_exp_f32 v50, v50
  v_cvt_pk_bf16_f32 v80, v48, v49
  v_exp_f32 v51, v51
  v_exp_f32 v52, v52
  v_cvt_pk_bf16_f32 v81, v50, v51
  v_exp_f32 v53, v53
  v_exp_f32 v54, v54
  v_cvt_pk_bf16_f32 v82, v52, v53
  v_exp_f32 v55, v55
  v_exp_f32 v56, v56
  v_cvt_pk_bf16_f32 v83, v54, v55
  v_exp_f32 v57, v57
  v_exp_f32 v58, v58
  v_cvt_pk_bf16_f32 v84, v56, v57
  v_mfma_f32_32x32x16_bf16 v[120:135], v[104:107], v[80:83], v[120:135]
  v_exp_f32 v59, v59
  v_exp_f32 v60, v60
  v_cvt_pk_bf16_f32 v85, v58, v59
  v_exp_f32 v61, v61
  v_exp_f32 v62, v62
  v_cvt_pk_bf16_f32 v86, v60, v61
  v_exp_f32 v63, v63
  s_waitcnt lgkmcnt(0)
  v_cvt_pk_bf16_f32 v87, v62, v63
  v_mfma_f32_32x32x16_bf16 v[48:63], v[100:103], v[8:11], v[16:31]
  s_mov_b64 exec, s[34:35]
  ds_read_b128 v[112:115], v5 offset:29696
  s_mov_b64 exec, -1
  v_exp_f32 v64, v64
  v_exp_f32 v65, v65
  v_mfma_f32_32x32x16_bf16 v[120:135], v[108:111], v[84:87], v[120:135]
  v_exp_f32 v66, v66
  v_cvt_pk_bf16_f32 v88, v64, v65
  v_exp_f32 v67, v67
  s_mov_b64 exec, s[34:35]
  ds_read_b128 v[116:119], v5 offset:30208
  s_mov_b64 exec, -1
  v_exp_f32 v68, v68
  v_cvt_pk_bf16_f32 v89, v66, v67
  v_exp_f32 v69, v69
  v_exp_f32 v70, v70
  v_cvt_pk_bf16_f32 v90, v68, v69
  v_exp_f32 v71, v71
  v_exp_f32 v72, v72
  v_cvt_pk_bf16_f32 v91, v70, v71
  v_exp_f32 v73, v73
  v_exp_f32 v74, v74
  v_cvt_pk_bf16_f32 v92, v72, v73
  v_mfma_f32_32x32x16_bf16 v[136:151], v[104:107], v[88:91], v[136:151]
  v_exp_f32 v75, v75
  v_exp_f32 v76, v76
  v_cvt_pk_bf16_f32 v93, v74, v75
  v_exp_f32 v77, v77
  v_exp_f32 v78, v78
  v_cvt_pk_bf16_f32 v94, v76, v77
  v_exp_f32 v79, v79
  s_waitcnt lgkmcnt(0)
  v_cvt_pk_bf16_f32 v95, v78, v79
  s_cmp_lt_u32 s22, 4
  s_cbranch_scc1 L_p2_nc2
  s_waitcnt vmcnt(0)
  v_cmp_ne_u32 vcc, s72, v197
  s_nop 1
  s_cbranch_vccz L_mega_kernel_26
  s_mov_b32 s73, 0
Lq_mega_kernel_27:
  global_load_dword v197, v196, s[8:9] sc1
  s_waitcnt vmcnt(0)
  s_add_u32 s73, s73, 1
  s_cmp_gt_u32 s73, 200000
  s_cbranch_scc1 Lqx_mega_kernel_28
  v_cmp_ne_u32 vcc, s72, v197
  s_nop 1
  s_cbranch_vccnz Lq_mega_kernel_27
Lqx_mega_kernel_28:
L_mega_kernel_26:
  v_lshlrev_b32 v198, 7, v2
  s_lshl_b32 s40, s64, 15
  s_sub_u32 s41, s22, 4
  s_lshl_b32 s41, s41, 13
  s_add_u32 s40, s40, s41
  s_add_u32 s40, s40, 14680064
L_p2_nc2:
  s_cmp_lt_u32 s22, 4
  s_cbranch_scc1 L_mega_kernel_29
  buffer_load_dword v232, v198, s[24:27], s40 offen sc1
  s_add_u32 s40, s40, 32768
L_mega_kernel_29:
  v_mfma_f32_32x32x16_bf16 v[64:79], v[100:103], v[12:15], v[32:47]
  ds_read_b128 v[96:99], v4 offset:30720
  v_exp_f32 v48, v48
  v_exp_f32 v49, v49
  v_mfma_f32_32x32x16_bf16 v[136:151], v[108:111], v[92:95], v[136:151]
  v_exp_f32 v50, v50
  v_cvt_pk_bf16_f32 v80, v48, v49
  v_exp_f32 v51, v51
  v_exp_f32 v52, v52
  v_cvt_pk_bf16_f32 v81, v50, v51
  v_exp_f32 v53, v53
  v_exp_f32 v54, v54
  v_cvt_pk_bf16_f32 v82, v52, v53
  v_exp_f32 v55, v55
  v_exp_f32 v56, v56
  v_cvt_pk_bf16_f32 v83, v54, v55
  v_exp_f32 v57, v57
  v_exp_f32 v58, v58
  v_cvt_pk_bf16_f32 v84, v56, v57
  v_mfma_f32_32x32x16_bf16 v[120:135], v[112:115], v[80:83], v[120:135]
  v_exp_f32 v59, v59
  v_exp_f32 v60, v60
  v_cvt_pk_bf16_f32 v85, v58, v59
  v_exp_f32 v61, v61
  v_exp_f32 v62, v62
  v_cvt_pk_bf16_f32 v86, v60, v61
  v_exp_f32 v63, v63
  s_waitcnt lgkmcnt(0)
  v_cvt_pk_bf16_f32 v87, v62, v63
  v_mfma_f32_32x32x16_bf16 v[48:63], v[96:99], v[8:11], v[16:31]
  s_mov_b64 exec, s[34:35]
  ds_read_b128 v[104:107], v5 offset:30720
  s_mov_b64 exec, -1
  v_exp_f32 v64, v64
  v_exp_f32 v65, v65
  v_mfma_f32_32x32x16_bf16 v[120:135], v[116:119], v[84:87], v[120:135]
  v_exp_f32 v66, v66
  v_cvt_pk_bf16_f32 v88, v64, v65
  v_exp_f32 v67, v67
  s_mov_b64 exec, s[34:35]
  ds_read_b128 v[108:111], v5 offset:31232
  s_mov_b64 exec, -1
  v_exp_f32 v68, v68
  v_cvt_pk_bf16_f32 v89, v66, v67
  v_exp_f32 v69, v69
  v_exp_f32 v70, v70
  v_cvt_pk_bf16_f32 v90, v68, v69
  v_exp_f32 v71, v71
  v_exp_f32 v72, v72
  v_cvt_pk_bf16_f32 v91, v70, v71
  v_exp_f32 v73, v73
  v_exp_f32 v74, v74
  v_cvt_pk_bf16_f32 v92, v72, v73
  v_mfma_f32_32x32x16_bf16 v[136:151], v[112:115], v[88:91], v[136:151]
  v_exp_f32 v75, v75
  v_exp_f32 v76, v76
  v_cvt_pk_bf16_f32 v93, v74, v75
  v_exp_f32 v77, v77
  v_exp_f32 v78, v78
  v_cvt_pk_bf16_f32 v94, v76, v77
  v_exp_f32 v79, v79
  s_waitcnt lgkmcnt(0)
  v_cvt_pk_bf16_f32 v95, v78, v79
  s_cmp_lt_u32 s22, 4
  s_cbranch_scc1 L_mega_kernel_30
  buffer_load_dword v233, v198, s[24:27], s40 offen sc1
  s_add_u32 s40, s40, 32768
L_mega_kernel_30:
  v_mfma_f32_32x32x16_bf16 v[64:79], v[96:99], v[12:15], v[32:47]
  ds_read_b128 v[100:103], v4 offset:31744
  v_exp_f32 v48, v48
  v_exp_f32 v49, v49
  v_mfma_f32_32x32x16_bf16 v[136:151], v[116:119], v[92:95], v[136:151]
  v_exp_f32 v50, v50
  v_cvt_pk_bf16_f32 v80, v48, v49
  v_exp_f32 v51, v51
  v_exp_f32 v52, v52
  v_cvt_pk_bf16_f32 v81, v50, v51
  v_exp_f32 v53, v53
  v_exp_f32 v54, v54
  v_cvt_pk_bf16_f32 v82, v52, v53
  v_exp_f32 v55, v55
  v_exp_f32 v56, v56
  v_cvt_pk_bf16_f32 v83, v54, v55
  v_exp_f32 v57, v57
  v_exp_f32 v58, v58
  v_cvt_pk_bf16_f32 v84, v56, v57
  v_mfma_f32_32x32x16_bf16 v[120:135], v[104:107], v[80:83], v[120:135]
  v_exp_f32 v59, v59
  v_exp_f32 v60, v60
  v_cvt_pk_bf16_f32 v85, v58, v59
  v_exp_f32 v61, v61
  v_exp_f32 v62, v62
  v_cvt_pk_bf16_f32 v86, v60, v61
  v_exp_f32 v63, v63
  s_waitcnt lgkmcnt(0)
  v_cvt_pk_bf16_f32 v87, v62, v63
  v_mfma_f32_32x32x16_bf16 v[48:63], v[100:103], v[8:11], v[16:31]
  s_mov_b64 exec, s[34:35]
  ds_read_b128 v[112:115], v5 offset:31744
  s_mov_b64 exec, -1
  v_exp_f32 v64, v64
  v_exp_f32 v65, v65
  v_mfma_f32_32x32x16_bf16 v[120:135], v[108:111], v[84:87], v[120:135]
  v_exp_f32 v66, v66
  v_cvt_pk_bf16_f32 v88, v64, v65
  v_exp_f32 v67, v67
  s_mov_b64 exec, s[34:35]
  ds_read_b128 v[116:119], v5 offset:32256
  s_mov_b64 exec, -1
  v_exp_f32 v68, v68
  v_cvt_pk_bf16_f32 v89, v66, v67
  v_exp_f32 v69, v69
  v_exp_f32 v70, v70
  v_cvt_pk_bf16_f32 v90, v68, v69
  v_exp_f32 v71, v71
  v_exp_f32 v72, v72
  v_cvt_pk_bf16_f32 v91, v70, v71
  v_exp_f32 v73, v73
  v_exp_f32 v74, v74
  v_cvt_pk_bf16_f32 v92, v72, v73
  v_mfma_f32_32x32x16_bf16 v[136:151], v[104:107], v[88:91], v[136:151]
  v_exp_f32 v75, v75
  v_exp_f32 v76, v76
  v_cvt_pk_bf16_f32 v93, v74, v75
  v_exp_f32 v77, v77
  v_exp_f32 v78, v78
  v_cvt_pk_bf16_f32 v94, v76, v77
  v_exp_f32 v79, v79
  s_waitcnt lgkmcnt(0)
  v_cvt_pk_bf16_f32 v95, v78, v79
  s_cmp_lt_u32 s22, 4
  s_cbranch_scc1 L_mega_kernel_31
  buffer_load_dword v234, v198, s[24:27], s40 offen sc1
  s_add_u32 s40, s40, 32768
L_mega_kernel_31:
  v_mfma_f32_32x32x16_bf16 v[64:79], v[100:103], v[12:15], v[32:47]
  ds_read_b128 v[96:99], v4 offset:32768
  v_exp_f32 v48, v48
  v_exp_f32 v49, v49
  v_mfma_f32_32x32x16_bf16 v[136:151], v[108:111], v[92:95], v[136:151]
  v_exp_f32 v50, v50
  v_cvt_pk_bf16_f32 v80, v48, v49
  v_exp_f32 v51, v51
  v_exp_f32 v52, v52
  v_cvt_pk_bf16_f32 v81, v50, v51
  v_exp_f32 v53, v53
  v_exp_f32 v54, v54
  v_cvt_pk_bf16_f32 v82, v52, v53
  v_exp_f32 v55, v55
  v_exp_f32 v56, v56
  v_cvt_pk_bf16_f32 v83, v54, v55
  v_exp_f32 v57, v57
  v_exp_f32 v58, v58
  v_cvt_pk_bf16_f32 v84, v56, v57
  v_mfma_f32_32x32x16_bf16 v[120:135], v[112:115], v[80:83], v[120:135]
  v_exp_f32 v59, v59
  v_exp_f32 v60, v60
  v_cvt_pk_bf16_f32 v85, v58, v59
  v_exp_f32 v61, v61
  v_exp_f32 v62, v62
  v_cvt_pk_bf16_f32 v86, v60, v61
  v_exp_f32 v63, v63
  s_waitcnt lgkmcnt(0)
  v_cvt_pk_bf16_f32 v87, v62, v63
  v_mfma_f32_32x32x16_bf16 v[48:63], v[96:99], v[8:11], v[16:31]
  s_mov_b64 exec, s[34:35]
  ds_read_b128 v[104:107], v5 offset:32768
  s_mov_b64 exec, -1
  v_exp_f32 v64, v64
  v_exp_f32 v65, v65
  v_mfma_f32_32x32x16_bf16 v[120:135], v[116:119], v[84:87], v[120:135]
  v_exp_f32 v66, v66
  v_cvt_pk_bf16_f32 v88, v64, v65
  v_exp_f32 v67, v67
  s_mov_b64 exec, s[34:35]
  ds_read_b128 v[108:111], v5 offset:33280
  s_mov_b64 exec, -1
  v_exp_f32 v68, v68
  v_cvt_pk_bf16_f32 v89, v66, v67
  v_exp_f32 v69, v69
  v_exp_f32 v70, v70
  v_cvt_pk_bf16_f32 v90, v68, v69
  v_exp_f32 v71, v71
  v_exp_f32 v72, v72
  v_cvt_pk_bf16_f32 v91, v70, v71
  v_exp_f32 v73, v73
  v_exp_f32 v74, v74
  v_cvt_pk_bf16_f32 v92, v72, v73
  v_mfma_f32_32x32x16_bf16 v[136:151], v[112:115], v[88:91], v[136:151]
  v_exp_f32 v75, v75
  v_exp_f32 v76, v76
  v_cvt_pk_bf16_f32 v93, v74, v75
  v_exp_f32 v77, v77
  v_exp_f32 v78, v78
  v_cvt_pk_bf16_f32 v94, v76, v77
  v_exp_f32 v79, v79
  s_waitcnt lgkmcnt(0)
  v_cvt_pk_bf16_f32 v95, v78, v79
  s_branch L_p2_done
L_p2_retry:
  s_mov_b32 s37, 0
L_p2_loop:
  v_mfma_f32_32x32x16_bf16 v[64:79], v[96:99], v[12:15], v[32:47]
  ds_read_b128 v[100:103], v4 offset:1024
  v_exp_f32 v48, v48
  v_exp_f32 v49, v49
  v_mfma_f32_32x32x16_bf16 v[136:151], v[116:119], v[92:95], v[136:151]
  v_exp_f32 v50, v50
  v_cvt_pk_bf16_f32 v80, v48, v49
  v_exp_f32 v51, v51
  v_exp_f32 v52, v52
  v_cvt_pk_bf16_f32 v81, v50, v51
  v_exp_f32 v53, v53
  v_exp_f32 v54, v54
  v_cvt_pk_bf16_f32 v82, v52, v53
  v_exp_f32 v55, v55
  v_exp_f32 v56, v56
  v_cvt_pk_bf16_f32 v83, v54, v55
  v_exp_f32 v57, v57
  v_exp_f32 v58, v58
  v_cvt_pk_bf16_f32 v84, v56, v57
  v_mfma_f32_32x32x16_bf16 v[120:135], v[104:107], v[80:83], v[120:135]
  v_exp_f32 v59, v59
  v_exp_f32 v60, v60
  v_cvt_pk_bf16_f32 v85, v58, v59
  v_exp_f32 v61, v61
  v_exp_f32 v62, v62
  v_cvt_pk_bf16_f32 v86, v60, v61
  v_exp_f32 v63, v63
  s_waitcnt lgkmcnt(0)
  v_cvt_pk_bf16_f32 v87, v62, v63
  v_mfma_f32_32x32x16_bf16 v[48:63], v[100:103], v[8:11], v[16:31]
  s_mov_b64 exec, s[34:35]
  ds_read_b128 v[112:115], v5 offset:1024
  s_mov_b64 exec, -1
  v_exp_f32 v64, v64
  v_exp_f32 v65, v65
  v_mfma_f32_32x32x16_bf16 v[120:135], v[108:111], v[84:87], v[120:135]
  v_exp_f32 v66, v66
  v_cvt_pk_bf16_f32 v88, v64, v65
  v_exp_f32 v67, v67
  s_mov_b64 exec, s[34:35]
  ds_read_b128 v[116:119], v5 offset:1536
  s_mov_b64 exec, -1
  v_exp_f32 v68, v68
  v_cvt_pk_bf16_f32 v89, v66, v67
  v_exp_f32 v69, v69
  v_exp_f32 v70, v70
  v_cvt_pk_bf16_f32 v90, v68, v69
  v_exp_f32 v71, v71
  v_exp_f32 v72, v72
  v_cvt_pk_bf16_f32 v91, v70, v71
  v_exp_f32 v73, v73
  v_exp_f32 v74, v74
  v_cvt_pk_bf16_f32 v92, v72, v73
  v_mfma_f32_32x32x16_bf16 v[136:151], v[104:107], v[88:91], v[136:151]
  v_exp_f32 v75, v75
  v_exp_f32 v76, v76
  v_cvt_pk_bf16_f32 v93, v74, v75
  v_exp_f32 v77, v77
  v_exp_f32 v78, v78
  v_cvt_pk_bf16_f32 v94, v76, v77
  v_exp_f32 v79, v79
  s_waitcnt lgkmcnt(0)
  v_cvt_pk_bf16_f32 v95, v78, v79
  v_mfma_f32_32x32x16_bf16 v[64:79], v[100:103], v[12:15], v[32:47]
  ds_read_b128 v[96:99], v4 offset:2048
  v_exp_f32 v48, v48
  v_exp_f32 v49, v49
  v_mfma_f32_32x32x16_bf16 v[136:151], v[108:111], v[92:95], v[136:151]
  v_exp_f32 v50, v50
  v_cvt_pk_bf16_f32 v80, v48, v49
  v_exp_f32 v51, v51
  v_exp_f32 v52, v52
  v_cvt_pk_bf16_f32 v81, v50, v51
  v_exp_f32 v53, v53
  v_exp_f32 v54, v54
  v_cvt_pk_bf16_f32 v82, v52, v53
  v_exp_f32 v55, v55
  v_exp_f32 v56, v56
  v_cvt_pk_bf16_f32 v83, v54, v55
  v_exp_f32 v57, v57
  v_exp_f32 v58, v58
  v_cvt_pk_bf16_f32 v84, v56, v57
  v_mfma_f32_32x32x16_bf16 v[120:135], v[112:115], v[80:83], v[120:135]
  v_exp_f32 v59, v59
  v_exp_f32 v60, v60
  v_cvt_pk_bf16_f32 v85, v58, v59
  v_exp_f32 v61, v61
  v_exp_f32 v62, v62
  v_cvt_pk_bf16_f32 v86, v60, v61
  v_exp_f32 v63, v63
  s_waitcnt lgkmcnt(0)
  v_cvt_pk_bf16_f32 v87, v62, v63
  v_mfma_f32_32x32x16_bf16 v[48:63], v[96:99], v[8:11], v[16:31]
  s_mov_b64 exec, s[34:35]
  ds_read_b128 v[104:107], v5 offset:2048
  s_mov_b64 exec, -1
  v_exp_f32 v64, v64
  v_exp_f32 v65, v65
  v_mfma_f32_32x32x16_bf16 v[120:135], v[116:119], v[84:87], v[120:135]
  v_exp_f32 v66, v66
  v_cvt_pk_bf16_f32 v88, v64, v65
  v_exp_f32 v67, v67
  s_mov_b64 exec, s[34:35]
  ds_read_b128 v[108:111], v5 offset:2560
  s_mov_b64 exec, -1
  v_exp_f32 v68, v68
  v_cvt_pk_bf16_f32 v89, v66, v67
  v_exp_f32 v69, v69
  v_exp_f32 v70, v70
  v_cvt_pk_bf16_f32 v90, v68, v69
  v_exp_f32 v71, v71
  v_exp_f32 v72, v72
  v_cvt_pk_bf16_f32 v91, v70, v71
  v_exp_f32 v73, v73
  v_exp_f32 v74, v74
  v_cvt_pk_bf16_f32 v92, v72, v73
  v_mfma_f32_32x32x16_bf16 v[136:151], v[112:115], v[88:91], v[136:151]
  v_exp_f32 v75, v75
  v_exp_f32 v76, v76
  v_cvt_pk_bf16_f32 v93, v74, v75
  v_exp_f32 v77, v77
  v_exp_f32 v78, v78
  v_cvt_pk_bf16_f32 v94, v76, v77
  v_exp_f32 v79, v79
  s_waitcnt lgkmcnt(0)
  v_cvt_pk_bf16_f32 v95, v78, v79
  v_add_u32 v4, 2048, v4
  v_add_u32 v5, 2048, v5
  s_add_u32 s37, s37, 1
  s_cmp_lt_u32 s37, 16
  s_cbranch_scc1 L_p2_loop
L_p2_done:
  s_nop 1
  v_mfma_f32_32x32x16_bf16 v[136:151], v[116:119], v[92:95], v[136:151]
  s_nop 7
  s_nop 3
  s_lshl_b32 s38, s22, 11
  s_add_u32 s38, s38, 131072
  v_add_u32 v1, s38, v3
  s_lshl_b32 s38, s22, 8
  s_add_u32 s38, s38, 147456
  v_lshlrev_b32 v86, 2, v2
  v_add_u32 v86, s38, v86
  s_cmp_eq_u32 s33, 0
  s_cbranch_scc1 L_p2_s0
  ds_write_b128 v1, v[120:123]
  ds_write_b128 v1, v[124:127] offset:1024
  ds_write_b32 v86, v128
  s_branch L_p2_s1
L_p2_s0:
  ds_write_b128 v1, v[136:139]
  ds_write_b128 v1, v[140:143] offset:1024
  ds_write_b32 v86, v144
L_p2_s1:
  v_max3_f32 v80, abs(v120), abs(v121), abs(v122)
  v_max3_f32 v80, v80, abs(v123), abs(v124)
  v_max3_f32 v80, v80, abs(v125), abs(v126)
  v_max3_f32 v80, v80, abs(v127), v128
  v_add_f32 v82, v120, v121
  v_add_f32 v82, v82, v122
  v_add_f32 v82, v82, v123
  v_add_f32 v82, v82, v124
  v_add_f32 v82, v82, v125
  v_add_f32 v82, v82, v126
  v_add_f32 v82, v82, v127
  v_add_f32 v82, v82, v128
  v_max3_f32 v80, v80, abs(v136), abs(v137)
  v_max_f32 v80, v80, abs(v138)
  v_max3_f32 v80, v80, abs(v139), abs(v140)
  v_max3_f32 v80, v80, abs(v141), abs(v142)
  v_max3_f32 v80, v80, abs(v143), v144
  v_add_f32 v83, v136, v137
  v_add_f32 v83, v83, v138
  v_add_f32 v83, v83, v139
  v_add_f32 v83, v83, v140
  v_add_f32 v83, v83, v141
  v_add_f32 v83, v83, v142
  v_add_f32 v83, v83, v143
  v_add_f32 v83, v83, v144
  v_add_f32 v82, v82, v83
  v_mov_b32 v81, 0x71800000
  v_cmp_nlt_f32 vcc, v80, v81
  v_cmp_u_f32 s[40:41], v82, v82
  s_nop 3
  s_or_b64 vcc, vcc, s[40:41]
  s_cmp_lg_u64 vcc, 0
  s_cselect_b32 s42, 1, 0
  s_and_b32 s42, s42, s36
  s_lshl_b32 s43, s22, 2
  s_add_u32 s43, s43, 149504
  v_mov_b32 v84, s43
  v_mov_b32 v85, s42
  ds_write_b32 v84, v85
  s_waitcnt lgkmcnt(0)
  s_barrier
  s_xor_b32 s39, s22, 4
  s_lshl_b32 s38, s39, 11
  s_add_u32 s38, s38, 131072
  v_add_u32 v1, s38, v3
  s_lshl_b32 s38, s39, 8
  s_add_u32 s38, s38, 147456
  v_lshlrev_b32 v86, 2, v2
  v_add_u32 v86, s38, v86
  ds_read_b128 v[48:51], v1
  ds_read_b128 v[52:55], v1 offset:1024
  ds_read_b32 v56, v86
  v_mov_b32 v84, 149504
  ds_read_b128 v[60:63], v84
  ds_read_b128 v[88:91], v84 offset:16
  s_cmp_eq_u32 s33, 0
  s_cbranch_scc1 L_p2_c0
  v_mov_b64 v[64:65], v[136:137]
  v_mov_b64 v[66:67], v[138:139]
  v_mov_b64 v[68:69], v[140:141]
  v_mov_b64 v[70:71], v[142:143]
  v_mov_b32 v72, v144
  s_branch L_p2_c1
L_p2_c0:
  v_mov_b64 v[64:65], v[120:121]
  v_mov_b64 v[66:67], v[122:123]
  v_mov_b64 v[68:69], v[124:125]
  v_mov_b64 v[70:71], v[126:127]
  v_mov_b32 v72, v128
L_p2_c1:
  s_waitcnt lgkmcnt(0)
  v_or_b32 v60, v60, v61
  v_or_b32 v62, v62, v63
  v_or_b32 v88, v88, v89
  v_or_b32 v90, v90, v91
  v_or_b32 v60, v60, v62
  v_or_b32 v88, v88, v90
  v_or_b32 v60, v60, v88
  v_add_f32 v64, v64, v48
  v_add_f32 v65, v65, v49
  v_add_f32 v66, v66, v50
  v_add_f32 v67, v67, v51
  v_add_f32 v68, v68, v52
  v_add_f32 v69, v69, v53
  v_add_f32 v70, v70, v54
  v_add_f32 v71, v71, v55
  v_add_f32 v72, v72, v56
  v_readfirstlane_b32 s42, v60
  s_nop 3
  s_cmp_eq_u32 s42, 0
  s_cbranch_scc1 L_p2_fin
  s_barrier
  s_mov_b32 s36, 0
  s_waitcnt vmcnt(0)
  v_mov_b32 v4, v3
  v_mov_b32 v80, 0xff800000
  v_mov_b32 v88, 0xff800000
  s_mov_b32 s37, 0
L_p2_mx:
  ds_read_b128 v[96:99], v4
  s_waitcnt lgkmcnt(0)
  v_mfma_f32_32x32x16_bf16 v[48:63], v[96:99], v[8:11], 0
  v_mfma_f32_32x32x16_bf16 v[64:79], v[96:99], v[12:15], 0
  v_add_u32 v4, 1024, v4
  s_nop 7
  s_nop 3
  v_max3_f32 v80, v80, v48, v49
  v_max3_f32 v80, v80, v50, v51
  v_max3_f32 v80, v80, v52, v53
  v_max3_f32 v80, v80, v54, v55
  v_max3_f32 v80, v80, v56, v57
  v_max3_f32 v80, v80, v58, v59
  v_max3_f32 v80, v80, v60, v61
  v_max3_f32 v80, v80, v62, v63
  v_max3_f32 v88, v88, v64, v65
  v_max3_f32 v88, v88, v66, v67
  v_max3_f32 v88, v88, v68, v69
  v_max3_f32 v88, v88, v70, v71
  v_max3_f32 v88, v88, v72, v73
  v_max3_f32 v88, v88, v74, v75
  v_max3_f32 v88, v88, v76, v77
  v_max3_f32 v88, v88, v78, v79
  s_add_u32 s37, s37, 1
  s_cmp_lt_u32 s37, 64
  s_cbranch_scc1 L_p2_mx
  s_branch L_p2_setm
L_p2_fin:
  s_setprio 0
  v_rcp_f32 v80, v72
  s_nop 0
  v_mul_f32 v64, v64, v80
  v_mul_f32 v65, v65, v80
  v_mul_f32 v66, v66, v80
  v_mul_f32 v67, v67, v80
  v_mul_f32 v68, v68, v80
  v_mul_f32 v69, v69, v80
  v_mul_f32 v70, v70, v80
  v_mul_f32 v71, v71, v80
  v_cvt_pk_bf16_f32 v84, v64, v65
  v_cvt_pk_bf16_f32 v85, v66, v67
  v_cvt_pk_bf16_f32 v86, v68, v69
  v_cvt_pk_bf16_f32 v87, v70, v71
  s_add_u32 s29, s29, s33
  s_lshl_b32 s30, s29, 15
  s_lshl_b32 s31, s20, 10
  s_add_u32 s30, s30, s31
  s_add_u32 s30, s30, 11534336
  buffer_store_dwordx4 v[84:87], v3, s[24:27], s30 offen sc1
  s_lshl_b32 s30, s21, 5
  s_add_u32 s30, s30, s20
  s_waitcnt vmcnt(0)
  s_barrier
  s_cmp_lg_u32 s22, 0
  s_cbranch_scc1 Lpub_mega_kernel_32
  s_lshl_b32 s73, s30, 7
  s_add_u32 s73, s73, 35717120
  v_mov_b32 v4, s73
  v_mov_b32 v5, s72
  s_mov_b64 exec, 1
  global_store_dword v4, v5, s[8:9] sc1
  s_mov_b64 exec, -1
Lpub_mega_kernel_32:
  s_load_dwordx2 s[12:13], s[0:1], 16
  s_lshr_b32 s59, s2, 5
  s_waitcnt lgkmcnt(0)
  s_mov_b32 s12, s12
  s_and_b32 s13, s13, 0xffff
  s_mov_b32 s14, 524288
  s_mov_b32 s15, 0x20000
  v_lshrrev_b32 v8, 3, v2
  v_bfe_u32 v9, v2, 4, 1
  v_lshlrev_b32 v9, 2, v9
  v_lshlrev_b32 v8, 10, v8
  v_and_b32 v10, 7, v2
  v_xor_b32 v9, v9, v10
  v_lshl_add_u32 v8, v9, 4, v8
  s_and_b32 s60, s22, 1
  s_lshr_b32 s61, s22, 1
  s_lshl_b32 s62, s59, 7
  s_lshl_b32 s63, s60, 13
  s_add_u32 s62, s62, s63
  s_lshl_b32 s63, s61, 17
  s_add_u32 s62, s62, s63
  s_lshl_b32 s61, s61, 14
  s_lshl_b32 s60, s60, 10
  s_add_u32 s61, s61, s60
  s_add_u32 m0, s61, 0
  s_add_u32 s63, s62, 0
  buffer_load_dwordx4 v8, s[12:15], s63 offen lds
  s_add_u32 m0, s61, 2048
  s_add_u32 s63, s62, 16384
  buffer_load_dwordx4 v8, s[12:15], s63 offen lds
  s_add_u32 m0, s61, 4096
  s_add_u32 s63, s62, 32768
  buffer_load_dwordx4 v8, s[12:15], s63 offen lds
  s_add_u32 m0, s61, 6144
  s_add_u32 s63, s62, 49152
  buffer_load_dwordx4 v8, s[12:15], s63 offen lds
  s_add_u32 m0, s61, 8192
  s_add_u32 s63, s62, 65536
  buffer_load_dwordx4 v8, s[12:15], s63 offen lds
  s_add_u32 m0, s61, 10240
  s_add_u32 s63, s62, 81920
  buffer_load_dwordx4 v8, s[12:15], s63 offen lds
  s_add_u32 m0, s61, 12288
  s_add_u32 s63, s62, 98304
  buffer_load_dwordx4 v8, s[12:15], s63 offen lds
  s_add_u32 m0, s61, 14336
  s_add_u32 s63, s62, 114688
  buffer_load_dwordx4 v8, s[12:15], s63 offen lds
  s_cmp_lt_u32 s2, 192
  s_cbranch_scc1 L_mega_kernel_33
  v_lshlrev_b32 v208, 16, v208
  v_mul_f32 v224, 0xbfb8aa3b, v208
  v_exp_f32 v224, v224
  s_nop 0
  v_add_f32 v224, 1.0, v224
  v_rcp_f32 v224, v224
  s_nop 0
  v_mul_f32 v208, v208, v224
  v_cvt_pk_bf16_f32 v208, v208, v208
  v_lshlrev_b32 v208, 16, v208
  v_lshlrev_b32 v209, 16, v209
  v_mul_f32 v224, 0xbfb8aa3b, v209
  v_exp_f32 v224, v224
  s_nop 0
  v_add_f32 v224, 1.0, v224
  v_rcp_f32 v224, v224
  s_nop 0
  v_mul_f32 v209, v209, v224
  v_cvt_pk_bf16_f32 v209, v209, v209
  v_lshlrev_b32 v209, 16, v209
  v_lshlrev_b32 v224, 16, v200
  v_and_b32 v225, 0xffff0000, v200
  v_mul_f32 v216, v208, v224
  v_mul_f32 v217, v208, v225
  v_lshlrev_b32 v224, 16, v201
  v_and_b32 v225, 0xffff0000, v201
  v_mul_f32 v218, v208, v224
  v_mul_f32 v219, v208, v225
  v_lshlrev_b32 v224, 16, v202
  v_and_b32 v225, 0xffff0000, v202
  v_mul_f32 v220, v208, v224
  v_mul_f32 v221, v208, v225
  v_lshlrev_b32 v224, 16, v203
  v_and_b32 v225, 0xffff0000, v203
  v_mul_f32 v222, v208, v224
  v_mul_f32 v223, v208, v225
  v_lshlrev_b32 v224, 16, v204
  v_and_b32 v225, 0xffff0000, v204
  v_fmac_f32 v216, v209, v224
  v_fmac_f32 v217, v209, v225
  v_lshlrev_b32 v224, 16, v205
  v_and_b32 v225, 0xffff0000, v205
  v_fmac_f32 v218, v209, v224
  v_fmac_f32 v219, v209, v225
  v_lshlrev_b32 v224, 16, v206
  v_and_b32 v225, 0xffff0000, v206
  v_fmac_f32 v220, v209, v224
  v_fmac_f32 v221, v209, v225
  v_lshlrev_b32 v224, 16, v207
  v_and_b32 v225, 0xffff0000, v207
  v_fmac_f32 v222, v209, v224
  v_fmac_f32 v223, v209, v225
  v_add_f32_dpp v216, v216, v216 row_ror:2 row_mask:0xf bank_mask:0xf
  v_add_f32_dpp v217, v217, v217 row_ror:2 row_mask:0xf bank_mask:0xf
  v_add_f32_dpp v218, v218, v218 row_ror:2 row_mask:0xf bank_mask:0xf
  v_add_f32_dpp v219, v219, v219 row_ror:2 row_mask:0xf bank_mask:0xf
  v_add_f32_dpp v220, v220, v220 row_ror:2 row_mask:0xf bank_mask:0xf
  v_add_f32_dpp v221, v221, v221 row_ror:2 row_mask:0xf bank_mask:0xf
  v_add_f32_dpp v222, v222, v222 row_ror:2 row_mask:0xf bank_mask:0xf
  v_add_f32_dpp v223, v223, v223 row_ror:2 row_mask:0xf bank_mask:0xf
  v_add_f32_dpp v216, v216, v216 row_ror:4 row_mask:0xf bank_mask:0xf
  v_add_f32_dpp v217, v217, v217 row_ror:4 row_mask:0xf bank_mask:0xf
  v_add_f32_dpp v218, v218, v218 row_ror:4 row_mask:0xf bank_mask:0xf
  v_add_f32_dpp v219, v219, v219 row_ror:4 row_mask:0xf bank_mask:0xf
  v_add_f32_dpp v220, v220, v220 row_ror:4 row_mask:0xf bank_mask:0xf
  v_add_f32_dpp v221, v221, v221 row_ror:4 row_mask:0xf bank_mask:0xf
  v_add_f32_dpp v222, v222, v222 row_ror:4 row_mask:0xf bank_mask:0xf
  v_add_f32_dpp v223, v223, v223 row_ror:4 row_mask:0xf bank_mask:0xf
  v_add_f32_dpp v216, v216, v216 row_ror:8 row_mask:0xf bank_mask:0xf
  v_add_f32_dpp v217, v217, v217 row_ror:8 row_mask:0xf bank_mask:0xf
  v_add_f32_dpp v218, v218, v218 row_ror:8 row_mask:0xf bank_mask:0xf
  v_add_f32_dpp v219, v219, v219 row_ror:8 row_mask:0xf bank_mask:0xf
  v_add_f32_dpp v220, v220, v220 row_ror:8 row_mask:0xf bank_mask:0xf
  v_add_f32_dpp v221, v221, v221 row_ror:8 row_mask:0xf bank_mask:0xf
  v_add_f32_dpp v222, v222, v222 row_ror:8 row_mask:0xf bank_mask:0xf
  v_add_f32_dpp v223, v223, v223 row_ror:8 row_mask:0xf bank_mask:0xf
  s_lshl_b32 s37, s22, 8
  s_add_u32 s37, s37, 151552
  v_lshrrev_b32 v224, 4, v2
  v_lshlrev_b32 v224, 6, v224
  v_and_b32 v225, 1, v2
  v_lshl_add_u32 v224, v225, 5, v224
  v_add_u32 v224, s37, v224
  v_and_b32 v225, 15, v2
  v_cmp_gt_u32 vcc, 2, v225
  s_nop 3
  s_and_saveexec_b64 s[38:39], vcc
  ds_write_b128 v224, v[216:219]
  ds_write_b128 v224, v[220:223] offset:16
  s_mov_b64 exec, s[38:39]
  s_waitcnt lgkmcnt(0)
  s_barrier
  s_cmp_lg_u32 s22, 4
  s_cbranch_scc1 L_sm_done
  v_and_b32 v200, 15, v2
  v_lshrrev_b32 v201, 4, v2
  v_lshlrev_b32 v201, 9, v201
  v_lshl_add_u32 v201, v200, 2, v201
  v_add_u32 v201, 151552, v201
  ds_read_b32 v202, v201 offset:0
  ds_read_b32 v203, v201 offset:64
  ds_read_b32 v204, v201 offset:128
  ds_read_b32 v205, v201 offset:192
  ds_read_b32 v206, v201 offset:256
  ds_read_b32 v207, v201 offset:320
  ds_read_b32 v208, v201 offset:384
  ds_read_b32 v209, v201 offset:448
  s_waitcnt lgkmcnt(0)
  v_add_f32 v202, v202, v203
  v_add_f32 v204, v204, v205
  v_add_f32 v206, v206, v207
  v_add_f32 v208, v208, v209
  v_add_f32 v202, v202, v204
  v_add_f32 v206, v206, v208
  v_add_f32 v202, v202, v206
  v_mov_b32 v203, v202
  s_nop 1
  v_permlane16_swap_b32 v202, v203
  v_add_f32 v202, v202, v203
  v_mov_b32 v203, v202
  s_nop 1
  v_permlane32_swap_b32 v202, v203
  v_add_f32 v202, v202, v203
  v_cvt_pk_bf16_f32 v202, v202, v202
  v_lshlrev_b32 v202, 16, v202
  s_lshl_b32 s38, s58, 6
  s_add_u32 s38, s38, 0
  v_lshlrev_b32 v203, 2, v200
  buffer_store_dword v202, v203, s[24:27], s38 offen sc1
  s_waitcnt vmcnt(0)
  s_cmp_ge_u32 s58, 160
  s_cselect_b32 s38, 128, 64
  s_sub_u32 s38, s58, s38
  s_lshl_b32 s38, s38, 7
  s_add_u32 s38, s38, 35815424
  v_mov_b32 v203, s38
  v_mov_b32 v204, s72
  s_mov_b64 exec, 1
  global_store_dword v203, v204, s[8:9] sc1
  s_mov_b64 exec, -1
L_sm_done:
L_mega_kernel_33:
  s_and_b32 s16, s2, 7
  s_lshr_b32 s17, s2, 3
  s_lshl_b32 s20, s16, 2
  s_and_b32 s18, s17, 3
  s_add_u32 s20, s20, s18
  s_lshr_b32 s21, s17, 2
  s_lshr_b32 s30, s20, 2
  s_lshl_b32 s30, s30, 5
  s_cmp_ge_u32 s22, 1
  s_cbranch_scc1 Lw_mega_kernel_34
  s_lshl_b32 s73, s30, 7
  s_add_u32 s73, s73, 35717120
  v_lshlrev_b32 v4, 7, v2
  v_add_u32 v4, s73, v4
  s_mov_b64 exec, 0xffffffff
  s_mov_b32 s73, 0
  global_load_dword v5, v4, s[8:9] sc1
Lp_mega_kernel_35:
  s_waitcnt vmcnt(0)
  v_cmp_ne_u32 vcc, s72, v5
  s_nop 1
  s_cbranch_vccz Lx_mega_kernel_36
  s_sleep 4
  global_load_dword v5, v4, s[8:9] sc1
  s_add_u32 s73, s73, 1
  s_cmp_lt_u32 s73, 100000
  s_cbranch_scc1 Lp_mega_kernel_35
Lx_mega_kernel_36:
  s_waitcnt vmcnt(0)
  s_mov_b64 exec, -1
Lw_mega_kernel_34:
  s_load_dwordx2 s[10:11], s[0:1], 0
  s_and_b32 s55, s22, 1
  s_lshl_b32 s54, s20, 1
  s_add_u32 s54, s54, s55
  s_lshr_b32 s55, s22, 1
  s_and_b32 s55, s55, 1
  s_lshl_b32 s57, s21, 1
  s_add_u32 s57, s57, s55
  v_lshrrev_b32 v31, 5, v2
  v_lshlrev_b32 v30, 4, v31
  s_cmp_ge_u32 s22, 4
  s_cbranch_scc1 L_p3_ld
  v_bfe_u32 v5, v2, 2, 2
  v_lshrrev_b32 v6, 5, v2
  v_lshl_add_u32 v6, v6, 2, v5
  v_lshlrev_b32 v6, 7, v6
  v_lshrrev_b32 v5, 1, v5
  v_lshlrev_b32 v5, 2, v5
  v_bfe_u32 v7, v2, 4, 1
  v_lshlrev_b32 v7, 1, v7
  v_bfe_u32 v8, v2, 1, 1
  v_add_u32 v7, v7, v8
  s_lshr_b32 s62, s22, 1
  s_lshl_b32 s62, s62, 2
  v_add_u32 v7, s62, v7
  v_xor_b32 v7, v7, v5
  v_lshl_add_u32 v6, v7, 4, v6
  v_and_b32 v7, 1, v2
  v_lshl_add_u32 v5, v7, 3, v6
  s_lshl_b32 s30, s54, 15
  s_add_u32 s30, s30, 11534336
  s_waitcnt lgkmcnt(0)
  s_mov_b32 s12, s10
  s_and_b32 s13, s11, 0xffff
  s_mov_b32 s14, 0x200000
  s_mov_b32 s15, 0x20000
  v_and_b32 v29, 31, v2
  v_lshlrev_b32 v29, 10, v29
  v_lshl_add_u32 v29, v31, 3, v29
  s_lshl_b32 s53, s54, 15
  s_lshl_b32 s52, s57, 6
  s_add_u32 s53, s53, s52
  v_add_u32 v29, s53, v29
  v_and_b32 v24, 1, v2
  s_lshl_b32 s56, s57, 1
  v_add_u32 v24, s56, v24
  v_lshlrev_b32 v24, 7, v24
  v_add_u32 v24, 35815424, v24
  v_mov_b64 v[64:65], 0
  v_mov_b64 v[66:67], 0
  v_mov_b64 v[68:69], 0
  v_mov_b64 v[70:71], 0
  v_mov_b64 v[72:73], 0
  v_mov_b64 v[74:75], 0
  v_mov_b64 v[76:77], 0
  v_mov_b64 v[78:79], 0
  s_waitcnt vmcnt(0)
  s_barrier
  s_and_b32 s62, s22, 1
  s_lshl_b32 s62, s62, 10
  s_add_u32 s62, s62, 65536
  v_add_u32 v4, s62, v3
  s_barrier
  ds_read_b64_tr_b16 v[8:9], v5 offset:0
  ds_read_b64_tr_b16 v[10:11], v5 offset:1024
  ds_read_b128 v[12:15], v4 offset:0
  ds_read_b64_tr_b16 v[16:17], v5 offset:2048
  ds_read_b64_tr_b16 v[18:19], v5 offset:3072
  ds_read_b128 v[20:23], v4 offset:2048
  s_waitcnt lgkmcnt(3)
  v_mfma_f32_32x32x16_bf16 v[64:79], v[8:11], v[12:15], v[64:79]
  ds_read_b64_tr_b16 v[8:9], v5 offset:4096
  ds_read_b64_tr_b16 v[10:11], v5 offset:5120
  ds_read_b128 v[12:15], v4 offset:4096
  s_waitcnt lgkmcnt(3)
  v_mfma_f32_32x32x16_bf16 v[64:79], v[16:19], v[20:23], v[64:79]
  ds_read_b64_tr_b16 v[16:17], v5 offset:6144
  ds_read_b64_tr_b16 v[18:19], v5 offset:7168
  ds_read_b128 v[20:23], v4 offset:6144
  s_mov_b64 exec, 3
  global_load_dword v25, v24, s[8:9] sc1
  s_mov_b64 exec, -1
  s_waitcnt lgkmcnt(3)
  v_mfma_f32_32x32x16_bf16 v[64:79], v[8:11], v[12:15], v[64:79]
  ds_read_b64_tr_b16 v[8:9], v5 offset:8192
  ds_read_b64_tr_b16 v[10:11], v5 offset:9216
  ds_read_b128 v[12:15], v4 offset:8192
  s_waitcnt lgkmcnt(3)
  v_mfma_f32_32x32x16_bf16 v[64:79], v[16:19], v[20:23], v[64:79]
  ds_read_b64_tr_b16 v[16:17], v5 offset:10240
  ds_read_b64_tr_b16 v[18:19], v5 offset:11264
  ds_read_b128 v[20:23], v4 offset:10240
  s_waitcnt lgkmcnt(3)
  v_mfma_f32_32x32x16_bf16 v[64:79], v[8:11], v[12:15], v[64:79]
  ds_read_b64_tr_b16 v[8:9], v5 offset:12288
  ds_read_b64_tr_b16 v[10:11], v5 offset:13312
  ds_read_b128 v[12:15], v4 offset:12288
  s_waitcnt lgkmcnt(3)
  v_mfma_f32_32x32x16_bf16 v[64:79], v[16:19], v[20:23], v[64:79]
  ds_read_b64_tr_b16 v[16:17], v5 offset:14336
  ds_read_b64_tr_b16 v[18:19], v5 offset:15360
  ds_read_b128 v[20:23], v4 offset:14336
  s_waitcnt lgkmcnt(3)
  v_mfma_f32_32x32x16_bf16 v[64:79], v[8:11], v[12:15], v[64:79]
  s_barrier
  ds_read_b64_tr_b16 v[8:9], v5 offset:16384
  ds_read_b64_tr_b16 v[10:11], v5 offset:17408
  ds_read_b128 v[12:15], v4 offset:16384
  s_waitcnt lgkmcnt(3)
  v_mfma_f32_32x32x16_bf16 v[64:79], v[16:19], v[20:23], v[64:79]
  ds_read_b64_tr_b16 v[16:17], v5 offset:18432
  ds_read_b64_tr_b16 v[18:19], v5 offset:19456
  ds_read_b128 v[20:23], v4 offset:18432
  s_waitcnt lgkmcnt(3)
  v_mfma_f32_32x32x16_bf16 v[64:79], v[8:11], v[12:15], v[64:79]
  ds_read_b64_tr_b16 v[8:9], v5 offset:20480
  ds_read_b64_tr_b16 v[10:11], v5 offset:21504
  ds_read_b128 v[12:15], v4 offset:20480
  buffer_load_dwordx2 v[56:57], v29, s[12:15], 0 offen offset:0
  s_waitcnt lgkmcnt(3)
  v_mfma_f32_32x32x16_bf16 v[64:79], v[16:19], v[20:23], v[64:79]
  ds_read_b64_tr_b16 v[16:17], v5 offset:22528
  ds_read_b64_tr_b16 v[18:19], v5 offset:23552
  ds_read_b128 v[20:23], v4 offset:22528
  buffer_load_dwordx2 v[58:59], v29, s[12:15], 0 offen offset:16
  s_waitcnt lgkmcnt(3)
  v_mfma_f32_32x32x16_bf16 v[64:79], v[8:11], v[12:15], v[64:79]
  ds_read_b64_tr_b16 v[8:9], v5 offset:24576
  ds_read_b64_tr_b16 v[10:11], v5 offset:25600
  ds_read_b128 v[12:15], v4 offset:24576
  buffer_load_dwordx2 v[60:61], v29, s[12:15], 0 offen offset:32
  s_waitcnt lgkmcnt(3)
  v_mfma_f32_32x32x16_bf16 v[64:79], v[16:19], v[20:23], v[64:79]
  ds_read_b64_tr_b16 v[16:17], v5 offset:26624
  ds_read_b64_tr_b16 v[18:19], v5 offset:27648
  ds_read_b128 v[20:23], v4 offset:26624
  buffer_load_dwordx2 v[62:63], v29, s[12:15], 0 offen offset:48
  s_waitcnt lgkmcnt(3)
  v_mfma_f32_32x32x16_bf16 v[64:79], v[8:11], v[12:15], v[64:79]
  ds_read_b64_tr_b16 v[8:9], v5 offset:28672
  ds_read_b64_tr_b16 v[10:11], v5 offset:29696
  ds_read_b128 v[12:15], v4 offset:28672
  s_lshl_b32 s56, s57, 7
  s_add_u32 s56, s56, 8192
  buffer_load_dwordx4 v[112:115], v30, s[24:27], s56 offen offset:0 sc1
  buffer_load_dwordx4 v[116:119], v30, s[24:27], s56 offen offset:32 sc1
  buffer_load_dwordx4 v[120:123], v30, s[24:27], s56 offen offset:64 sc1
  buffer_load_dwordx4 v[124:127], v30, s[24:27], s56 offen offset:96 sc1
  s_waitcnt lgkmcnt(3)
  v_mfma_f32_32x32x16_bf16 v[64:79], v[16:19], v[20:23], v[64:79]
  ds_read_b64_tr_b16 v[16:17], v5 offset:30720
  ds_read_b64_tr_b16 v[18:19], v5 offset:31744
  ds_read_b128 v[20:23], v4 offset:30720
  s_waitcnt lgkmcnt(3)
  v_mfma_f32_32x32x16_bf16 v[64:79], v[8:11], v[12:15], v[64:79]
  s_barrier
  ds_read_b64_tr_b16 v[8:9], v5 offset:32768
  ds_read_b64_tr_b16 v[10:11], v5 offset:33792
  ds_read_b128 v[12:15], v4 offset:32768
  s_waitcnt lgkmcnt(3)
  v_mfma_f32_32x32x16_bf16 v[64:79], v[16:19], v[20:23], v[64:79]
  ds_read_b64_tr_b16 v[16:17], v5 offset:34816
  ds_read_b64_tr_b16 v[18:19], v5 offset:35840
  ds_read_b128 v[20:23], v4 offset:34816
  s_waitcnt lgkmcnt(3)
  v_mfma_f32_32x32x16_bf16 v[64:79], v[8:11], v[12:15], v[64:79]
  ds_read_b64_tr_b16 v[8:9], v5 offset:36864
  ds_read_b64_tr_b16 v[10:11], v5 offset:37888
  ds_read_b128 v[12:15], v4 offset:36864
  s_waitcnt lgkmcnt(3)
  v_mfma_f32_32x32x16_bf16 v[64:79], v[16:19], v[20:23], v[64:79]
  ds_read_b64_tr_b16 v[16:17], v5 offset:38912
  ds_read_b64_tr_b16 v[18:19], v5 offset:39936
  ds_read_b128 v[20:23], v4 offset:38912
  s_waitcnt vmcnt(8)
  s_mov_b64 exec, 3
  v_cmp_ne_u32 vcc, s72, v25
  s_mov_b64 exec, -1
  s_nop 1
  s_cbranch_vccz L_mega_kernel_37
  s_mov_b64 exec, 0x3
  s_mov_b32 s73, 0
Lq_mega_kernel_38:
  global_load_dword v25, v24, s[8:9] sc1
  s_waitcnt vmcnt(0)
  s_add_u32 s73, s73, 1
  s_cmp_gt_u32 s73, 200000
  s_cbranch_scc1 Lqx_mega_kernel_39
  v_cmp_ne_u32 vcc, s72, v25
  s_nop 1
  s_cbranch_vccnz Lq_mega_kernel_38
Lqx_mega_kernel_39:
  s_mov_b64 exec, -1
L_mega_kernel_37:
  s_lshl_b32 s56, s57, 7
  s_add_u32 s56, s56, 4096
  buffer_load_dwordx4 v[96:99], v30, s[24:27], s56 offen offset:0 sc1
  buffer_load_dwordx4 v[100:103], v30, s[24:27], s56 offen offset:32 sc1
  buffer_load_dwordx4 v[104:107], v30, s[24:27], s56 offen offset:64 sc1
  buffer_load_dwordx4 v[108:111], v30, s[24:27], s56 offen offset:96 sc1
  s_waitcnt lgkmcnt(3)
  v_mfma_f32_32x32x16_bf16 v[64:79], v[8:11], v[12:15], v[64:79]
  ds_read_b64_tr_b16 v[8:9], v5 offset:40960
  ds_read_b64_tr_b16 v[10:11], v5 offset:41984
  ds_read_b128 v[12:15], v4 offset:40960
  s_waitcnt lgkmcnt(3)
  v_mfma_f32_32x32x16_bf16 v[64:79], v[16:19], v[20:23], v[64:79]
  ds_read_b64_tr_b16 v[16:17], v5 offset:43008
  ds_read_b64_tr_b16 v[18:19], v5 offset:44032
  ds_read_b128 v[20:23], v4 offset:43008
  s_waitcnt lgkmcnt(3)
  v_mfma_f32_32x32x16_bf16 v[64:79], v[8:11], v[12:15], v[64:79]
  ds_read_b64_tr_b16 v[8:9], v5 offset:45056
  ds_read_b64_tr_b16 v[10:11], v5 offset:46080
  ds_read_b128 v[12:15], v4 offset:45056
  s_waitcnt lgkmcnt(3)
  v_mfma_f32_32x32x16_bf16 v[64:79], v[16:19], v[20:23], v[64:79]
  ds_read_b64_tr_b16 v[16:17], v5 offset:47104
  ds_read_b64_tr_b16 v[18:19], v5 offset:48128
  ds_read_b128 v[20:23], v4 offset:47104
  s_waitcnt lgkmcnt(3)
  v_mfma_f32_32x32x16_bf16 v[64:79], v[8:11], v[12:15], v[64:79]
  s_barrier
  ds_read_b64_tr_b16 v[8:9], v5 offset:49152
  ds_read_b64_tr_b16 v[10:11], v5 offset:50176
  ds_read_b128 v[12:15], v4 offset:49152
  s_waitcnt lgkmcnt(3)
  v_mfma_f32_32x32x16_bf16 v[64:79], v[16:19], v[20:23], v[64:79]
  ds_read_b64_tr_b16 v[16:17], v5 offset:51200
  ds_read_b64_tr_b16 v[18:19], v5 offset:52224
  ds_read_b128 v[20:23], v4 offset:51200
  s_waitcnt lgkmcnt(3)
  v_mfma_f32_32x32x16_bf16 v[64:79], v[8:11], v[12:15], v[64:79]
  ds_read_b64_tr_b16 v[8:9], v5 offset:53248
  ds_read_b64_tr_b16 v[10:11], v5 offset:54272
  ds_read_b128 v[12:15], v4 offset:53248
  s_waitcnt lgkmcnt(3)
  v_mfma_f32_32x32x16_bf16 v[64:79], v[16:19], v[20:23], v[64:79]
  ds_read_b64_tr_b16 v[16:17], v5 offset:55296
  ds_read_b64_tr_b16 v[18:19], v5 offset:56320
  ds_read_b128 v[20:23], v4 offset:55296
  s_waitcnt lgkmcnt(3)
  v_mfma_f32_32x32x16_bf16 v[64:79], v[8:11], v[12:15], v[64:79]
  ds_read_b64_tr_b16 v[8:9], v5 offset:57344
  ds_read_b64_tr_b16 v[10:11], v5 offset:58368
  ds_read_b128 v[12:15], v4 offset:57344
  s_waitcnt lgkmcnt(3)
  v_mfma_f32_32x32x16_bf16 v[64:79], v[16:19], v[20:23], v[64:79]
  ds_read_b64_tr_b16 v[16:17], v5 offset:59392
  ds_read_b64_tr_b16 v[18:19], v5 offset:60416
  ds_read_b128 v[20:23], v4 offset:59392
  s_waitcnt lgkmcnt(3)
  v_mfma_f32_32x32x16_bf16 v[64:79], v[8:11], v[12:15], v[64:79]
  ds_read_b64_tr_b16 v[8:9], v5 offset:61440
  ds_read_b64_tr_b16 v[10:11], v5 offset:62464
  ds_read_b128 v[12:15], v4 offset:61440
  s_waitcnt lgkmcnt(3)
  v_mfma_f32_32x32x16_bf16 v[64:79], v[16:19], v[20:23], v[64:79]
  ds_read_b64_tr_b16 v[16:17], v5 offset:63488
  ds_read_b64_tr_b16 v[18:19], v5 offset:64512
  ds_read_b128 v[20:23], v4 offset:63488
  s_waitcnt lgkmcnt(3)
  v_mfma_f32_32x32x16_bf16 v[64:79], v[8:11], v[12:15], v[64:79]
  s_waitcnt lgkmcnt(0)
  v_mfma_f32_32x32x16_bf16 v[64:79], v[16:19], v[20:23], v[64:79]
  s_waitcnt vmcnt(0)
  s_nop 7
  s_nop 1
  v_lshlrev_b32 v32, 16, v56
  v_and_b32 v33, 0xffff0000, v56
  v_lshlrev_b32 v34, 16, v57
  v_and_b32 v35, 0xffff0000, v57
  v_lshlrev_b32 v36, 16, v58
  v_and_b32 v37, 0xffff0000, v58
  v_lshlrev_b32 v38, 16, v59
  v_and_b32 v39, 0xffff0000, v59
  v_lshlrev_b32 v40, 16, v60
  v_and_b32 v41, 0xffff0000, v60
  v_lshlrev_b32 v42, 16, v61
  v_and_b32 v43, 0xffff0000, v61
  v_lshlrev_b32 v44, 16, v62
  v_and_b32 v45, 0xffff0000, v62
  v_lshlrev_b32 v46, 16, v63
  v_and_b32 v47, 0xffff0000, v63
  v_fmac_f32 v32, v96, v64
  v_fmac_f32 v33, v97, v65
  v_fmac_f32 v34, v98, v66
  v_fmac_f32 v35, v99, v67
  v_fmac_f32 v36, v100, v68
  v_fmac_f32 v37, v101, v69
  v_fmac_f32 v38, v102, v70
  v_fmac_f32 v39, v103, v71
  v_fmac_f32 v40, v104, v72
  v_fmac_f32 v41, v105, v73
  v_fmac_f32 v42, v106, v74
  v_fmac_f32 v43, v107, v75
  v_fmac_f32 v44, v108, v76
  v_fmac_f32 v45, v109, v77
  v_fmac_f32 v46, v110, v78
  v_fmac_f32 v47, v111, v79
  v_cvt_pk_bf16_f32 v48, v32, v33
  v_cvt_pk_bf16_f32 v49, v34, v35
  v_cvt_pk_bf16_f32 v50, v36, v37
  v_cvt_pk_bf16_f32 v51, v38, v39
  v_cvt_pk_bf16_f32 v52, v40, v41
  v_cvt_pk_bf16_f32 v53, v42, v43
  v_cvt_pk_bf16_f32 v54, v44, v45
  v_cvt_pk_bf16_f32 v55, v46, v47
  s_lshl_b32 s53, s54, 15
  s_lshl_b32 s52, s57, 11
  s_add_u32 s53, s53, s52
  s_add_u32 s52, s53, 19922944
  buffer_store_dwordx4 v[48:51], v3, s[24:27], s52 offen sc1
  buffer_store_dwordx4 v[52:55], v3, s[24:27], s52 offen offset:1024 sc1
  v_lshlrev_b32 v32, 16, v48
  v_and_b32 v33, 0xffff0000, v48
  v_lshlrev_b32 v34, 16, v49
  v_and_b32 v35, 0xffff0000, v49
  v_lshlrev_b32 v36, 16, v50
  v_and_b32 v37, 0xffff0000, v50
  v_lshlrev_b32 v38, 16, v51
  v_and_b32 v39, 0xffff0000, v51
  v_lshlrev_b32 v40, 16, v52
  v_and_b32 v41, 0xffff0000, v52
  v_lshlrev_b32 v42, 16, v53
  v_and_b32 v43, 0xffff0000, v53
  v_lshlrev_b32 v44, 16, v54
  v_and_b32 v45, 0xffff0000, v54
  v_lshlrev_b32 v46, 16, v55
  v_and_b32 v47, 0xffff0000, v55
  v_mul_f32 v80, v32, v112
  v_mul_f32 v81, v33, v113
  v_mul_f32 v82, v34, v114
  v_mul_f32 v83, v35, v115
  v_mul_f32 v84, v36, v116
  v_mul_f32 v85, v37, v117
  v_mul_f32 v86, v38, v118
  v_mul_f32 v87, v39, v119
  v_mul_f32 v88, v40, v120
  v_mul_f32 v89, v41, v121
  v_mul_f32 v90, v42, v122
  v_mul_f32 v91, v43, v123
  v_mul_f32 v92, v44, v124
  v_mul_f32 v93, v45, v125
  v_mul_f32 v94, v46, v126
  v_mul_f32 v95, v47, v127
  v_cvt_pk_bf16_f32 v56, v80, v81
  v_cvt_pk_bf16_f32 v57, v82, v83
  v_cvt_pk_bf16_f32 v58, v84, v85
  v_cvt_pk_bf16_f32 v59, v86, v87
  v_cvt_pk_bf16_f32 v60, v88, v89
  v_cvt_pk_bf16_f32 v61, v90, v91
  v_cvt_pk_bf16_f32 v62, v92, v93
  v_cvt_pk_bf16_f32 v63, v94, v95
  s_add_u32 s52, s53, 22020096
  buffer_store_dwordx4 v[56:59], v3, s[24:27], s52 offen sc1
  buffer_store_dwordx4 v[60:63], v3, s[24:27], s52 offen offset:1024 sc1
  v_add_f32 v20, v32, v33
  v_add_f32 v21, v34, v35
  v_mul_f32 v22, v32, v32
  v_mul_f32 v23, v33, v33
  v_fmac_f32 v22, v34, v34
  v_fmac_f32 v23, v35, v35
  v_add_f32 v20, v20, v36
  v_add_f32 v21, v21, v37
  v_fmac_f32 v22, v36, v36
  v_fmac_f32 v23, v37, v37
  v_add_f32 v20, v20, v38
  v_add_f32 v21, v21, v39
  v_fmac_f32 v22, v38, v38
  v_fmac_f32 v23, v39, v39
  v_add_f32 v20, v20, v40
  v_add_f32 v21, v21, v41
  v_fmac_f32 v22, v40, v40
  v_fmac_f32 v23, v41, v41
  v_add_f32 v20, v20, v42
  v_add_f32 v21, v21, v43
  v_fmac_f32 v22, v42, v42
  v_fmac_f32 v23, v43, v43
  v_add_f32 v20, v20, v44
  v_add_f32 v21, v21, v45
  v_fmac_f32 v22, v44, v44
  v_fmac_f32 v23, v45, v45
  v_add_f32 v20, v20, v46
  v_add_f32 v21, v21, v47
  v_fmac_f32 v22, v46, v46
  v_fmac_f32 v23, v47, v47
  v_add_f32 v20, v20, v21
  v_add_f32 v21, v22, v23
  v_mov_b32 v22, v20
  v_mov_b32 v23, v21
  s_nop 1
  v_permlane32_swap_b32 v20, v22
  v_permlane32_swap_b32 v21, v23
  v_add_f32 v20, v20, v22
  v_add_f32 v21, v21, v23
  v_cmp_gt_u32 vcc, 32, v2
  s_nop 1
  v_cndmask_b32 v20, v21, v20, vcc
  v_lshlrev_b32 v8, 2, v2
  s_lshl_b32 s53, s54, 12
  s_lshl_b32 s52, s57, 8
  s_add_u32 s53, s53, s52
  s_add_u32 s53, s53, 65536
  buffer_store_dword v20, v8, s[24:27], s53 offen sc1
  s_barrier
  s_lshr_b32 s30, s20, 2
  s_lshl_b32 s30, s30, 5
  s_and_b32 s31, s20, 3
  s_lshl_b32 s31, s31, 3
  s_add_u32 s30, s30, s31
  s_add_u32 s30, s30, s21
  s_lshl_b32 s30, s30, 2
  s_add_u32 s30, s30, s22
  s_lshl_b32 s30, s30, 7
  s_add_u32 s30, s30, 35913728
  v_mov_b32 v4, s30
  v_mov_b32 v5, s72
  s_waitcnt vmcnt(0)
  s_mov_b64 exec, 1
  global_store_dword v4, v5, s[8:9] sc1
  s_mov_b64 exec, -1
  s_branch L_p3_fin
L_p3_ld:
  s_and_b32 s66, s2, 1
  s_lshl_b32 s66, s66, 2
  s_bfe_u32 s67, s2, 0x20003
  s_add_u32 s66, s66, s67
  s_bfe_u32 s67, s2, 0x20001
  s_lshl_b32 s67, s67, 3
  s_lshr_b32 s64, s2, 5
  s_add_u32 s67, s67, s64
  s_mul_i32 s64, s67, 3
  s_lshl_b32 s65, s67, 1
  s_add_u32 s65, s65, 22
  s_cmp_lt_u32 s67, 22
  s_cselect_b32 s64, s64, s65
  s_cselect_b32 s65, 1, 0
  s_sub_u32 s44, s22, 4
  s_lshl_b32 s45, s64, 15
  s_lshl_b32 s46, s44, 10
  s_add_u32 s45, s45, s46
  s_add_u32 s45, s45, 14680064
  s_mul_i32 s46, s44, 3072
  s_add_u32 s46, s46, 65536
  s_and_b32 s61, s44, 1
  s_lshl_b32 s59, s20, 1
  s_add_u32 s59, s59, s61
  s_lshl_b32 s59, s59, 15
  s_add_u32 s59, s59, 11534336
  s_lshr_b32 s58, s44, 1
  s_lshl_b32 s57, s58, 10
  s_add_u32 s59, s59, s57
  s_lshl_b32 s58, s58, 11
  s_lshl_b32 s61, s61, 10
  s_add_u32 s58, s58, s61
  s_add_u32 s58, s58, 65536
  s_barrier
  s_add_u32 m0, s58, 0
  s_add_u32 s63, s59, 0
  buffer_load_dwordx4 v3, s[24:27], s63 offen sc1 lds
  s_add_u32 m0, s58, 4096
  s_add_u32 s63, s59, 2048
  buffer_load_dwordx4 v3, s[24:27], s63 offen sc1 lds
  s_add_u32 m0, s58, 8192
  s_add_u32 s63, s59, 4096
  buffer_load_dwordx4 v3, s[24:27], s63 offen sc1 lds
  s_add_u32 m0, s58, 12288
  s_add_u32 s63, s59, 6144
  buffer_load_dwordx4 v3, s[24:27], s63 offen sc1 lds
  s_add_u32 m0, s58, 16384
  s_add_u32 s63, s59, 8192
  buffer_load_dwordx4 v3, s[24:27], s63 offen sc1 lds
  s_add_u32 m0, s58, 20480
  s_add_u32 s63, s59, 10240
  buffer_load_dwordx4 v3, s[24:27], s63 offen sc1 lds
  s_add_u32 m0, s58, 24576
  s_add_u32 s63, s59, 12288
  buffer_load_dwordx4 v3, s[24:27], s63 offen sc1 lds
  s_add_u32 m0, s58, 28672
  s_add_u32 s63, s59, 14336
  buffer_load_dwordx4 v3, s[24:27], s63 offen sc1 lds
  s_waitcnt vmcnt(4)
  s_barrier
  s_add_u32 m0, s58, 32768
  s_add_u32 s63, s59, 16384
  buffer_load_dwordx4 v3, s[24:27], s63 offen sc1 lds
  s_add_u32 m0, s58, 36864
  s_add_u32 s63, s59, 18432
  buffer_load_dwordx4 v3, s[24:27], s63 offen sc1 lds
  s_add_u32 m0, s58, 40960
  s_add_u32 s63, s59, 20480
  buffer_load_dwordx4 v3, s[24:27], s63 offen sc1 lds
  s_add_u32 m0, s58, 45056
  s_add_u32 s63, s59, 22528
  buffer_load_dwordx4 v3, s[24:27], s63 offen sc1 lds
  s_waitcnt vmcnt(4)
  s_barrier
  s_add_u32 m0, s58, 49152
  s_add_u32 s63, s59, 24576
  buffer_load_dwordx4 v3, s[24:27], s63 offen sc1 lds
  s_add_u32 m0, s58, 53248
  s_add_u32 s63, s59, 26624
  buffer_load_dwordx4 v3, s[24:27], s63 offen sc1 lds
  s_add_u32 m0, s58, 57344
  s_add_u32 s63, s59, 28672
  buffer_load_dwordx4 v3, s[24:27], s63 offen sc1 lds
  s_add_u32 m0, s58, 61440
  s_add_u32 s63, s59, 30720
  buffer_load_dwordx4 v3, s[24:27], s63 offen sc1 lds
  s_waitcnt vmcnt(4)
  s_barrier
  s_waitcnt vmcnt(0)
  s_barrier
  s_barrier
  s_add_u32 m0, s46, 0
  s_add_u32 s63, s45, 0
  buffer_load_dwordx4 v3, s[24:27], s63 offen sc1 lds
  s_add_u32 m0, s46, 1024
  s_add_u32 s63, s45, 32768
  buffer_load_dwordx4 v3, s[24:27], s63 offen sc1 lds
  s_add_u32 m0, s46, 2048
  s_add_u32 s63, s45, 65536
  buffer_load_dwordx4 v3, s[24:27], s63 offen sc1 lds
  s_add_u32 m0, s46, 12288
  s_add_u32 s63, s45, 4096
  buffer_load_dwordx4 v3, s[24:27], s63 offen sc1 lds
  s_add_u32 m0, s46, 13312
  s_add_u32 s63, s45, 36864
  buffer_load_dwordx4 v3, s[24:27], s63 offen sc1 lds
  s_add_u32 m0, s46, 14336
  s_add_u32 s63, s45, 69632
  buffer_load_dwordx4 v3, s[24:27], s63 offen sc1 lds
  s_add_u32 m0, s46, 24576
  s_add_u32 s63, s45, 8192
  buffer_load_dwordx4 v3, s[24:27], s63 offen sc1 lds
  s_add_u32 m0, s46, 25600
  s_add_u32 s63, s45, 40960
  buffer_load_dwordx4 v3, s[24:27], s63 offen sc1 lds
  s_add_u32 m0, s46, 26624
  s_add_u32 s63, s45, 73728
  buffer_load_dwordx4 v3, s[24:27], s63 offen sc1 lds
  s_add_u32 m0, s46, 36864
  s_add_u32 s63, s45, 12288
  buffer_load_dwordx4 v3, s[24:27], s63 offen sc1 lds
  s_add_u32 m0, s46, 37888
  s_add_u32 s63, s45, 45056
  buffer_load_dwordx4 v3, s[24:27], s63 offen sc1 lds
  s_add_u32 m0, s46, 38912
  s_add_u32 s63, s45, 77824
  buffer_load_dwordx4 v3, s[24:27], s63 offen sc1 lds
  s_add_u32 m0, s46, 49152
  s_add_u32 s63, s45, 16384
  buffer_load_dwordx4 v3, s[24:27], s63 offen sc1 lds
  s_add_u32 m0, s46, 50176
  s_add_u32 s63, s45, 49152
  buffer_load_dwordx4 v3, s[24:27], s63 offen sc1 lds
  s_add_u32 m0, s46, 51200
  s_add_u32 s63, s45, 81920
  buffer_load_dwordx4 v3, s[24:27], s63 offen sc1 lds
  s_add_u32 m0, s46, 61440
  s_add_u32 s63, s45, 20480
  buffer_load_dwordx4 v3, s[24:27], s63 offen sc1 lds
  s_add_u32 m0, s46, 62464
  s_add_u32 s63, s45, 53248
  buffer_load_dwordx4 v3, s[24:27], s63 offen sc1 lds
  s_add_u32 m0, s46, 63488
  s_add_u32 s63, s45, 86016
  buffer_load_dwordx4 v3, s[24:27], s63 offen sc1 lds
  s_add_u32 m0, s46, 73728
  s_add_u32 s63, s45, 24576
  buffer_load_dwordx4 v3, s[24:27], s63 offen sc1 lds
  s_add_u32 m0, s46, 74752
  s_add_u32 s63, s45, 57344
  buffer_load_dwordx4 v3, s[24:27], s63 offen sc1 lds
  s_add_u32 m0, s46, 75776
  s_add_u32 s63, s45, 90112
  buffer_load_dwordx4 v3, s[24:27], s63 offen sc1 lds
  s_add_u32 m0, s46, 86016
  s_add_u32 s63, s45, 28672
  buffer_load_dwordx4 v3, s[24:27], s63 offen sc1 lds
  s_add_u32 m0, s46, 87040
  s_add_u32 s63, s45, 61440
  buffer_load_dwordx4 v3, s[24:27], s63 offen sc1 lds
  s_add_u32 m0, s46, 88064
  s_add_u32 s63, s45, 94208
  buffer_load_dwordx4 v3, s[24:27], s63 offen sc1 lds
  s_cmp_eq_u32 s22, 4
  s_cbranch_scc1 L_p3_fin
  s_sub_u32 s60, s22, 5
  s_add_u32 s60, s60, s64
  s_lshl_b32 s60, s60, 8
  s_add_u32 s60, s60, 655360
  v_lshlrev_b32 v40, 2, v2
  buffer_load_dword v64, v40, s[24:27], s60 offen sc1
  v_bfe_u32 v42, v2, 3, 2
  v_mov_b32 v43, 1.0
  v_cmp_eq_u32 vcc, 1, v42
  v_mov_b32 v52, 0xbfb8aa3b
  s_nop 0
  v_cndmask_b32 v43, v43, v52, vcc
  v_cmp_eq_u32 vcc, 3, v42
  v_mov_b32 v52, 0xbf317218
  s_nop 0
  v_cndmask_b32 v43, v43, v52, vcc
  s_waitcnt vmcnt(0)
  v_mul_f32 v64, v64, v43
  s_sub_u32 s60, s22, 5
  s_lshl_b32 s60, s60, 8
  s_add_u32 s60, s60, 0
  v_add_u32 v40, s60, v40
  ds_write_b32 v40, v64
  s_waitcnt lgkmcnt(0)
L_p3_fin:
  s_and_b32 s66, s2, 1
  s_lshl_b32 s66, s66, 2
  s_bfe_u32 s67, s2, 0x20003
  s_add_u32 s66, s66, s67
  s_bfe_u32 s67, s2, 0x20001
  s_lshl_b32 s67, s67, 3
  s_lshr_b32 s64, s2, 5
  s_add_u32 s67, s67, s64
  s_mul_i32 s64, s67, 3
  s_lshl_b32 s65, s67, 1
  s_add_u32 s65, s65, 22
  s_cmp_lt_u32 s67, 22
  s_cselect_b32 s64, s64, s65
  s_cselect_b32 s65, 1, 0
  s_waitcnt vmcnt(0)
  s_barrier
  s_cmp_ge_u32 s22, 2
  s_cbranch_scc1 L_mega_kernel_40
  s_lshl_b32 s30, s66, 14
  s_lshl_b32 s31, s22, 13
  s_add_u32 s30, s30, s31
  s_add_u32 s30, s30, 35913728
  v_lshlrev_b32 v4, 7, v2
  v_add_u32 v4, s30, v4
  s_mov_b32 s73, 0
  global_load_dword v5, v4, s[8:9] sc1
Lp_mega_kernel_41:
  s_waitcnt vmcnt(0)
  v_cmp_ne_u32 vcc, s72, v5
  s_nop 1
  s_cbranch_vccz Lx_mega_kernel_42
  s_sleep 4
  global_load_dword v5, v4, s[8:9] sc1
  s_add_u32 s73, s73, 1
  s_cmp_lt_u32 s73, 100000
  s_cbranch_scc1 Lp_mega_kernel_41
Lx_mega_kernel_42:
  s_waitcnt vmcnt(0)
L_mega_kernel_40:
  s_waitcnt vmcnt(0)
  s_barrier
  s_lshl_b32 s28, s66, 3
  s_add_u32 s28, s28, s22
  s_lshl_b32 s30, s28, 15
  s_add_u32 s30, s30, 22020096
  buffer_load_dwordx4 v[128:131], v3, s[24:27], s30 offen offset:0 sc1
  buffer_load_dwordx4 v[132:135], v3, s[24:27], s30 offen offset:1024 sc1
  buffer_load_dwordx4 v[136:139], v3, s[24:27], s30 offen offset:2048 sc1
  v_mov_b64 v[64:65], 0
  v_mov_b64 v[66:67], 0
  v_mov_b64 v[68:69], 0
  v_mov_b64 v[70:71], 0
  v_mov_b64 v[72:73], 0
  v_mov_b64 v[74:75], 0
  v_mov_b64 v[76:77], 0
  v_mov_b64 v[78:79], 0
  v_mov_b64 v[80:81], 0
  v_mov_b64 v[82:83], 0
  v_mov_b64 v[84:85], 0
  v_mov_b64 v[86:87], 0
  v_mov_b64 v[88:89], 0
  v_mov_b64 v[90:91], 0
  v_mov_b64 v[92:93], 0
  v_mov_b64 v[94:95], 0
  v_mov_b64 v[96:97], 0
  v_mov_b64 v[98:99], 0
  v_mov_b64 v[100:101], 0
  v_mov_b64 v[102:103], 0
  v_mov_b64 v[104:105], 0
  v_mov_b64 v[106:107], 0
  v_mov_b64 v[108:109], 0
  v_mov_b64 v[110:111], 0
  v_lshlrev_b32 v6, 2, v2
  v_lshrrev_b32 v7, 5, v2
  v_lshlrev_b32 v7, 7, v7
  v_add_u32 v7, 0, v7
  v_add_u32 v4, 65536, v3
  v_add_u32 v5, 114688, v3
  ds_read_b128 v[8:11], v4 offset:0
  ds_read_b128 v[12:15], v4 offset:1024
  ds_read_b128 v[16:19], v4 offset:2048
  s_waitcnt vmcnt(2) lgkmcnt(0)
  v_mfma_f32_32x32x16_bf16 v[64:79], v[8:11], v[128:131], v[64:79]
  ds_read_b128 v[20:23], v4 offset:3072
  ds_read_b128 v[24:27], v4 offset:4096
  ds_read_b128 v[28:31], v4 offset:5120
  v_mfma_f32_32x32x16_bf16 v[80:95], v[12:15], v[128:131], v[80:95]
  buffer_load_dwordx4 v[140:143], v3, s[24:27], s30 offen offset:3072 sc1
  s_add_u32 s30, s30, 4096
  buffer_load_dwordx4 v[144:147], v3, s[24:27], s30 offen offset:0 sc1
  v_mfma_f32_32x32x16_bf16 v[96:111], v[16:19], v[128:131], v[96:111]
  s_load_dwordx2 s[42:43], s[0:1], 48
  s_lshr_b32 s44, s2, 3
  s_lshl_b32 s44, s44, 3
  s_add_u32 s44, s44, s22
  s_waitcnt vmcnt(3) lgkmcnt(0)
  v_mfma_f32_32x32x16_bf16 v[64:79], v[20:23], v[132:135], v[64:79]
  ds_read_b128 v[8:11], v4 offset:6144
  ds_read_b128 v[12:15], v4 offset:7168
  ds_read_b128 v[16:19], v4 offset:8192
  v_mfma_f32_32x32x16_bf16 v[80:95], v[24:27], v[132:135], v[80:95]
  buffer_load_dwordx4 v[148:151], v3, s[24:27], s30 offen offset:1024 sc1
  buffer_load_dwordx4 v[152:155], v3, s[24:27], s30 offen offset:2048 sc1
  v_mfma_f32_32x32x16_bf16 v[96:111], v[28:31], v[132:135], v[96:111]
  s_waitcnt vmcnt(4) lgkmcnt(0)
  v_mfma_f32_32x32x16_bf16 v[64:79], v[8:11], v[136:139], v[64:79]
  ds_read_b128 v[20:23], v4 offset:9216
  ds_read_b128 v[24:27], v4 offset:10240
  ds_read_b128 v[28:31], v4 offset:11264
  v_mfma_f32_32x32x16_bf16 v[80:95], v[12:15], v[136:139], v[80:95]
  buffer_load_dwordx4 v[156:159], v3, s[24:27], s30 offen offset:3072 sc1
  s_add_u32 s30, s30, 4096
  buffer_load_dwordx4 v[160:163], v3, s[24:27], s30 offen offset:0 sc1
  v_mfma_f32_32x32x16_bf16 v[96:111], v[16:19], v[136:139], v[96:111]
  s_waitcnt vmcnt(5) lgkmcnt(0)
  v_mfma_f32_32x32x16_bf16 v[64:79], v[20:23], v[140:143], v[64:79]
  ds_read_b128 v[8:11], v4 offset:12288
  ds_read_b128 v[12:15], v4 offset:13312
  ds_read_b128 v[16:19], v4 offset:14336
  v_mfma_f32_32x32x16_bf16 v[80:95], v[24:27], v[140:143], v[80:95]
  buffer_load_dwordx4 v[164:167], v3, s[24:27], s30 offen offset:1024 sc1
  v_mfma_f32_32x32x16_bf16 v[96:111], v[28:31], v[140:143], v[96:111]
  s_waitcnt vmcnt(5) lgkmcnt(0)
  v_mfma_f32_32x32x16_bf16 v[64:79], v[8:11], v[144:147], v[64:79]
  ds_read_b128 v[20:23], v4 offset:15360
  ds_read_b128 v[24:27], v4 offset:16384
  ds_read_b128 v[28:31], v4 offset:17408
  v_mfma_f32_32x32x16_bf16 v[80:95], v[12:15], v[144:147], v[80:95]
  buffer_load_dwordx4 v[168:171], v3, s[24:27], s30 offen offset:2048 sc1
  v_mfma_f32_32x32x16_bf16 v[96:111], v[16:19], v[144:147], v[96:111]
  s_waitcnt vmcnt(5) lgkmcnt(0)
  v_mfma_f32_32x32x16_bf16 v[64:79], v[20:23], v[148:151], v[64:79]
  ds_read_b128 v[8:11], v4 offset:18432
  ds_read_b128 v[12:15], v4 offset:19456
  ds_read_b128 v[16:19], v4 offset:20480
  v_mfma_f32_32x32x16_bf16 v[80:95], v[24:27], v[148:151], v[80:95]
  buffer_load_dwordx4 v[172:175], v3, s[24:27], s30 offen offset:3072 sc1
  v_mfma_f32_32x32x16_bf16 v[96:111], v[28:31], v[148:151], v[96:111]
  s_waitcnt vmcnt(5) lgkmcnt(0)
  v_mfma_f32_32x32x16_bf16 v[64:79], v[8:11], v[152:155], v[64:79]
  ds_read_b128 v[20:23], v4 offset:21504
  ds_read_b128 v[24:27], v4 offset:22528
  ds_read_b128 v[28:31], v4 offset:23552
  v_mfma_f32_32x32x16_bf16 v[80:95], v[12:15], v[152:155], v[80:95]
  s_add_u32 s30, s30, 4096
  buffer_load_dwordx4 v[176:179], v3, s[24:27], s30 offen offset:0 sc1
  v_mfma_f32_32x32x16_bf16 v[96:111], v[16:19], v[152:155], v[96:111]
  s_waitcnt vmcnt(5) lgkmcnt(0)
  v_mfma_f32_32x32x16_bf16 v[64:79], v[20:23], v[156:159], v[64:79]
  ds_read_b128 v[8:11], v4 offset:24576
  ds_read_b128 v[12:15], v4 offset:25600
  ds_read_b128 v[16:19], v4 offset:26624
  v_mfma_f32_32x32x16_bf16 v[80:95], v[24:27], v[156:159], v[80:95]
  buffer_load_dwordx4 v[180:183], v3, s[24:27], s30 offen offset:1024 sc1
  v_mfma_f32_32x32x16_bf16 v[96:111], v[28:31], v[156:159], v[96:111]
  s_waitcnt vmcnt(5) lgkmcnt(0)
  v_mfma_f32_32x32x16_bf16 v[64:79], v[8:11], v[160:163], v[64:79]
  ds_read_b128 v[20:23], v4 offset:27648
  ds_read_b128 v[24:27], v4 offset:28672
  ds_read_b128 v[28:31], v4 offset:29696
  v_mfma_f32_32x32x16_bf16 v[80:95], v[12:15], v[160:163], v[80:95]
  buffer_load_dwordx4 v[184:187], v3, s[24:27], s30 offen offset:2048 sc1
  v_mfma_f32_32x32x16_bf16 v[96:111], v[16:19], v[160:163], v[96:111]
  s_waitcnt vmcnt(5) lgkmcnt(0)
  v_mfma_f32_32x32x16_bf16 v[64:79], v[20:23], v[164:167], v[64:79]
  ds_read_b128 v[8:11], v4 offset:30720
  ds_read_b128 v[12:15], v4 offset:31744
  ds_read_b128 v[16:19], v4 offset:32768
  v_mfma_f32_32x32x16_bf16 v[80:95], v[24:27], v[164:167], v[80:95]
  buffer_load_dwordx4 v[188:191], v3, s[24:27], s30 offen offset:3072 sc1
  v_mfma_f32_32x32x16_bf16 v[96:111], v[28:31], v[164:167], v[96:111]
  s_waitcnt lgkmcnt(0)
  s_waitcnt vmcnt(5)
  v_mfma_f32_32x32x16_bf16 v[64:79], v[8:11], v[168:171], v[64:79]
  ds_read_b128 v[20:23], v4 offset:33792
  ds_read_b128 v[24:27], v4 offset:34816
  ds_read_b128 v[28:31], v4 offset:35840
  v_mfma_f32_32x32x16_bf16 v[80:95], v[12:15], v[168:171], v[80:95]
  s_add_u32 s30, s30, 4096
  buffer_load_dwordx4 v[192:195], v3, s[24:27], s30 offen offset:0 sc1
  v_mfma_f32_32x32x16_bf16 v[96:111], v[16:19], v[168:171], v[96:111]
  s_waitcnt vmcnt(5) lgkmcnt(0)
  v_mfma_f32_32x32x16_bf16 v[64:79], v[20:23], v[172:175], v[64:79]
  ds_read_b128 v[8:11], v4 offset:36864
  ds_read_b128 v[12:15], v4 offset:37888
  ds_read_b128 v[16:19], v4 offset:38912
  v_mfma_f32_32x32x16_bf16 v[80:95], v[24:27], v[172:175], v[80:95]
  buffer_load_dwordx4 v[196:199], v3, s[24:27], s30 offen offset:1024 sc1
  v_mfma_f32_32x32x16_bf16 v[96:111], v[28:31], v[172:175], v[96:111]
  s_waitcnt vmcnt(5) lgkmcnt(0)
  v_mfma_f32_32x32x16_bf16 v[64:79], v[8:11], v[176:179], v[64:79]
  ds_read_b128 v[20:23], v4 offset:39936
  ds_read_b128 v[24:27], v4 offset:40960
  ds_read_b128 v[28:31], v4 offset:41984
  v_mfma_f32_32x32x16_bf16 v[80:95], v[12:15], v[176:179], v[80:95]
  buffer_load_dwordx4 v[200:203], v3, s[24:27], s30 offen offset:2048 sc1
  v_mfma_f32_32x32x16_bf16 v[96:111], v[16:19], v[176:179], v[96:111]
  s_waitcnt vmcnt(5) lgkmcnt(0)
  v_mfma_f32_32x32x16_bf16 v[64:79], v[20:23], v[180:183], v[64:79]
  ds_read_b128 v[8:11], v4 offset:43008
  ds_read_b128 v[12:15], v4 offset:44032
  ds_read_b128 v[16:19], v4 offset:45056
  v_mfma_f32_32x32x16_bf16 v[80:95], v[24:27], v[180:183], v[80:95]
  buffer_load_dwordx4 v[204:207], v3, s[24:27], s30 offen offset:3072 sc1
  v_mfma_f32_32x32x16_bf16 v[96:111], v[28:31], v[180:183], v[96:111]
  s_waitcnt vmcnt(5) lgkmcnt(0)
  v_mfma_f32_32x32x16_bf16 v[64:79], v[8:11], v[184:187], v[64:79]
  ds_read_b128 v[20:23], v4 offset:46080
  ds_read_b128 v[24:27], v4 offset:47104
  ds_read_b128 v[28:31], v4 offset:48128
  v_mfma_f32_32x32x16_bf16 v[80:95], v[12:15], v[184:187], v[80:95]
  s_add_u32 s30, s30, 4096
  buffer_load_dwordx4 v[208:211], v3, s[24:27], s30 offen offset:0 sc1
  v_mfma_f32_32x32x16_bf16 v[96:111], v[16:19], v[184:187], v[96:111]
  s_waitcnt vmcnt(5) lgkmcnt(0)
  v_mfma_f32_32x32x16_bf16 v[64:79], v[20:23], v[188:191], v[64:79]
  ds_read_b128 v[8:11], v5 offset:0
  ds_read_b128 v[12:15], v5 offset:1024
  ds_read_b128 v[16:19], v5 offset:2048
  v_mfma_f32_32x32x16_bf16 v[80:95], v[24:27], v[188:191], v[80:95]
  buffer_load_dwordx4 v[212:215], v3, s[24:27], s30 offen offset:1024 sc1
  v_mfma_f32_32x32x16_bf16 v[96:111], v[28:31], v[188:191], v[96:111]
  s_waitcnt vmcnt(5) lgkmcnt(0)
  v_mfma_f32_32x32x16_bf16 v[64:79], v[8:11], v[192:195], v[64:79]
  ds_read_b128 v[20:23], v5 offset:3072
  ds_read_b128 v[24:27], v5 offset:4096
  ds_read_b128 v[28:31], v5 offset:5120
  v_mfma_f32_32x32x16_bf16 v[80:95], v[12:15], v[192:195], v[80:95]
  buffer_load_dwordx4 v[216:219], v3, s[24:27], s30 offen offset:2048 sc1
  v_mfma_f32_32x32x16_bf16 v[96:111], v[16:19], v[192:195], v[96:111]
  s_waitcnt vmcnt(5) lgkmcnt(0)
  v_mfma_f32_32x32x16_bf16 v[64:79], v[20:23], v[196:199], v[64:79]
  ds_read_b128 v[8:11], v5 offset:6144
  ds_read_b128 v[12:15], v5 offset:7168
  ds_read_b128 v[16:19], v5 offset:8192
  v_mfma_f32_32x32x16_bf16 v[80:95], v[24:27], v[196:199], v[80:95]
  buffer_load_dwordx4 v[220:223], v3, s[24:27], s30 offen offset:3072 sc1
  v_mfma_f32_32x32x16_bf16 v[96:111], v[28:31], v[196:199], v[96:111]
  s_waitcnt vmcnt(5) lgkmcnt(0)
  v_mfma_f32_32x32x16_bf16 v[64:79], v[8:11], v[200:203], v[64:79]
  ds_read_b128 v[20:23], v5 offset:9216
  ds_read_b128 v[24:27], v5 offset:10240
  ds_read_b128 v[28:31], v5 offset:11264
  v_mfma_f32_32x32x16_bf16 v[80:95], v[12:15], v[200:203], v[80:95]
  s_add_u32 s30, s30, 4096
  buffer_load_dwordx4 v[224:227], v3, s[24:27], s30 offen offset:0 sc1
  v_mfma_f32_32x32x16_bf16 v[96:111], v[16:19], v[200:203], v[96:111]
  s_waitcnt vmcnt(5) lgkmcnt(0)
  v_mfma_f32_32x32x16_bf16 v[64:79], v[20:23], v[204:207], v[64:79]
  ds_read_b128 v[8:11], v5 offset:12288
  ds_read_b128 v[12:15], v5 offset:13312
  ds_read_b128 v[16:19], v5 offset:14336
  v_mfma_f32_32x32x16_bf16 v[80:95], v[24:27], v[204:207], v[80:95]
  buffer_load_dwordx4 v[228:231], v3, s[24:27], s30 offen offset:1024 sc1
  v_mfma_f32_32x32x16_bf16 v[96:111], v[28:31], v[204:207], v[96:111]
  s_waitcnt vmcnt(5) lgkmcnt(0)
  v_mfma_f32_32x32x16_bf16 v[64:79], v[8:11], v[208:211], v[64:79]
  ds_read_b128 v[20:23], v5 offset:15360
  ds_read_b128 v[24:27], v5 offset:16384
  ds_read_b128 v[28:31], v5 offset:17408
  v_mfma_f32_32x32x16_bf16 v[80:95], v[12:15], v[208:211], v[80:95]
  buffer_load_dwordx4 v[232:235], v3, s[24:27], s30 offen offset:2048 sc1
  v_mfma_f32_32x32x16_bf16 v[96:111], v[16:19], v[208:211], v[96:111]
  s_lshl_b32 s37, s28, 12
  s_add_u32 s37, s37, 65536
  buffer_load_dword v32, v6, s[24:27], s37 offen offset:0 sc1
  buffer_load_dword v33, v6, s[24:27], s37 offen offset:256 sc1
  buffer_load_dword v34, v6, s[24:27], s37 offen offset:512 sc1
  buffer_load_dword v35, v6, s[24:27], s37 offen offset:768 sc1
  s_waitcnt vmcnt(9) lgkmcnt(0)
  v_mfma_f32_32x32x16_bf16 v[64:79], v[20:23], v[212:215], v[64:79]
  ds_read_b128 v[8:11], v5 offset:18432
  ds_read_b128 v[12:15], v5 offset:19456
  ds_read_b128 v[16:19], v5 offset:20480
  v_mfma_f32_32x32x16_bf16 v[80:95], v[24:27], v[212:215], v[80:95]
  buffer_load_dwordx4 v[236:239], v3, s[24:27], s30 offen offset:3072 sc1
  v_mfma_f32_32x32x16_bf16 v[96:111], v[28:31], v[212:215], v[96:111]
  buffer_load_dword v36, v6, s[24:27], s37 offen offset:1024 sc1
  buffer_load_dword v37, v6, s[24:27], s37 offen offset:1280 sc1
  buffer_load_dword v38, v6, s[24:27], s37 offen offset:1536 sc1
  buffer_load_dword v39, v6, s[24:27], s37 offen offset:1792 sc1
  s_waitcnt vmcnt(13) lgkmcnt(0)
  v_mfma_f32_32x32x16_bf16 v[64:79], v[8:11], v[216:219], v[64:79]
  ds_read_b128 v[20:23], v5 offset:21504
  ds_read_b128 v[24:27], v5 offset:22528
  ds_read_b128 v[28:31], v5 offset:23552
  v_mfma_f32_32x32x16_bf16 v[80:95], v[12:15], v[216:219], v[80:95]
  s_add_u32 s30, s30, 4096
  buffer_load_dwordx4 v[240:243], v3, s[24:27], s30 offen offset:0 sc1
  v_mfma_f32_32x32x16_bf16 v[96:111], v[16:19], v[216:219], v[96:111]
  buffer_load_dword v40, v6, s[24:27], s37 offen offset:2048 sc1
  buffer_load_dword v41, v6, s[24:27], s37 offen offset:2304 sc1
  buffer_load_dword v42, v6, s[24:27], s37 offen offset:2560 sc1
  buffer_load_dword v43, v6, s[24:27], s37 offen offset:2816 sc1
  s_waitcnt vmcnt(17) lgkmcnt(0)
  v_mfma_f32_32x32x16_bf16 v[64:79], v[20:23], v[220:223], v[64:79]
  ds_read_b128 v[8:11], v5 offset:24576
  ds_read_b128 v[12:15], v5 offset:25600
  ds_read_b128 v[16:19], v5 offset:26624
  v_mfma_f32_32x32x16_bf16 v[80:95], v[24:27], v[220:223], v[80:95]
  buffer_load_dwordx4 v[244:247], v3, s[24:27], s30 offen offset:1024 sc1
  v_mfma_f32_32x32x16_bf16 v[96:111], v[28:31], v[220:223], v[96:111]
  buffer_load_dword v44, v6, s[24:27], s37 offen offset:3072 sc1
  buffer_load_dword v45, v6, s[24:27], s37 offen offset:3328 sc1
  buffer_load_dword v46, v6, s[24:27], s37 offen offset:3584 sc1
  buffer_load_dword v47, v6, s[24:27], s37 offen offset:3840 sc1
  s_waitcnt vmcnt(21) lgkmcnt(0)
  v_mfma_f32_32x32x16_bf16 v[64:79], v[8:11], v[224:227], v[64:79]
  ds_read_b128 v[20:23], v5 offset:27648
  ds_read_b128 v[24:27], v5 offset:28672
  ds_read_b128 v[28:31], v5 offset:29696
  v_mfma_f32_32x32x16_bf16 v[80:95], v[12:15], v[224:227], v[80:95]
  buffer_load_dwordx4 v[248:251], v3, s[24:27], s30 offen offset:2048 sc1
  v_mfma_f32_32x32x16_bf16 v[96:111], v[16:19], v[224:227], v[96:111]
  s_waitcnt vmcnt(21) lgkmcnt(0)
  v_mfma_f32_32x32x16_bf16 v[64:79], v[20:23], v[228:231], v[64:79]
  ds_read_b128 v[8:11], v5 offset:30720
  ds_read_b128 v[12:15], v5 offset:31744
  ds_read_b128 v[16:19], v5 offset:32768
  v_mfma_f32_32x32x16_bf16 v[80:95], v[24:27], v[228:231], v[80:95]
  buffer_load_dwordx4 v[252:255], v3, s[24:27], s30 offen offset:3072 sc1
  v_mfma_f32_32x32x16_bf16 v[96:111], v[28:31], v[228:231], v[96:111]
  s_waitcnt vmcnt(21) lgkmcnt(0)
  v_mfma_f32_32x32x16_bf16 v[64:79], v[8:11], v[232:235], v[64:79]
  ds_read_b128 v[20:23], v5 offset:33792
  ds_read_b128 v[24:27], v5 offset:34816
  ds_read_b128 v[28:31], v5 offset:35840
  v_mfma_f32_32x32x16_bf16 v[80:95], v[12:15], v[232:235], v[80:95]
  v_mfma_f32_32x32x16_bf16 v[96:111], v[16:19], v[232:235], v[96:111]
  s_waitcnt vmcnt(16) lgkmcnt(0)
  v_mfma_f32_32x32x16_bf16 v[64:79], v[20:23], v[236:239], v[64:79]
  ds_read_b128 v[8:11], v5 offset:36864
  ds_read_b128 v[12:15], v5 offset:37888
  ds_read_b128 v[16:19], v5 offset:38912
  v_mfma_f32_32x32x16_bf16 v[80:95], v[24:27], v[236:239], v[80:95]
  v_mfma_f32_32x32x16_bf16 v[96:111], v[28:31], v[236:239], v[96:111]
  s_waitcnt vmcnt(2)
  v_add_f32 v32, v32, v33
  v_add_f32 v34, v34, v35
  v_add_f32 v36, v36, v37
  v_add_f32 v38, v38, v39
  v_add_f32 v40, v40, v41
  v_add_f32 v42, v42, v43
  v_add_f32 v44, v44, v45
  v_add_f32 v46, v46, v47
  v_add_f32 v32, v32, v34
  v_add_f32 v36, v36, v38
  v_add_f32 v40, v40, v42
  v_add_f32 v44, v44, v46
  v_add_f32 v32, v32, v36
  v_add_f32 v40, v40, v44
  v_add_f32 v32, v32, v40
  s_waitcnt lgkmcnt(0)
  v_mfma_f32_32x32x16_bf16 v[64:79], v[8:11], v[240:243], v[64:79]
  ds_read_b128 v[20:23], v5 offset:39936
  ds_read_b128 v[24:27], v5 offset:40960
  ds_read_b128 v[28:31], v5 offset:41984
  v_mfma_f32_32x32x16_bf16 v[80:95], v[12:15], v[240:243], v[80:95]
  v_mfma_f32_32x32x16_bf16 v[96:111], v[16:19], v[240:243], v[96:111]
  s_min_u32 s45, s44, 171
  s_lshl_b32 s45, s45, 13
  v_lshlrev_b32 v56, 7, v2
  v_add_u32 v56, s45, v56
  global_load_dword v60, v56, s[42:43]
  v_mov_b32 v33, v32
  s_nop 1
  v_permlane32_swap_b32 v32, v33
  v_mul_f32 v32, 0x3b000000, v32
  v_mul_f32 v33, 0x3b000000, v33
  v_fma_f32 v33, -v32, v32, v33
  v_max_f32 v33, 0, v33
  v_add_f32 v33, 0x3727c5ac, v33
  v_rsq_f32 v33, v33
  ds_read_b128 v[128:131], v7 offset:0
  ds_read_b128 v[132:135], v7 offset:16
  ds_read_b128 v[136:139], v7 offset:32
  ds_read_b128 v[140:143], v7 offset:48
  ds_read_b128 v[144:147], v7 offset:64
  ds_read_b128 v[148:151], v7 offset:80
  s_waitcnt lgkmcnt(6)
  v_mfma_f32_32x32x16_bf16 v[64:79], v[20:23], v[244:247], v[64:79]
  ds_read_b128 v[8:11], v5 offset:43008
  ds_read_b128 v[12:15], v5 offset:44032
  ds_read_b128 v[16:19], v5 offset:45056
  v_mfma_f32_32x32x16_bf16 v[80:95], v[24:27], v[244:247], v[80:95]
  v_mfma_f32_32x32x16_bf16 v[96:111], v[28:31], v[244:247], v[96:111]
  v_mul_f32 v34, v32, v33
  v_mul_f32 v35, 0xbfb8aa3b, v33
  v_mul_f32 v36, 0x3fb8aa3b, v34
  v_mul_f32 v37, 0xbf317218, v33
  v_mul_f32 v38, 0x3f317218, v34
  ds_read_b128 v[152:155], v7 offset:96
  ds_read_b128 v[156:159], v7 offset:112
  ds_read_b128 v[160:163], v7 offset:256
  ds_read_b128 v[164:167], v7 offset:272
  ds_read_b128 v[168:171], v7 offset:288
  ds_read_b128 v[172:175], v7 offset:304
  s_waitcnt vmcnt(2) lgkmcnt(6)
  v_mfma_f32_32x32x16_bf16 v[64:79], v[8:11], v[248:251], v[64:79]
  ds_read_b128 v[20:23], v5 offset:46080
  ds_read_b128 v[24:27], v5 offset:47104
  ds_read_b128 v[28:31], v5 offset:48128
  v_mfma_f32_32x32x16_bf16 v[80:95], v[12:15], v[248:251], v[80:95]
  v_mfma_f32_32x32x16_bf16 v[96:111], v[16:19], v[248:251], v[96:111]
  ds_read_b128 v[176:179], v7 offset:320
  ds_read_b128 v[180:183], v7 offset:336
  ds_read_b128 v[184:187], v7 offset:352
  ds_read_b128 v[188:191], v7 offset:368
  ds_read_b128 v[192:195], v7 offset:512
  ds_read_b128 v[196:199], v7 offset:528
  s_waitcnt vmcnt(1) lgkmcnt(6)
  v_mfma_f32_32x32x16_bf16 v[64:79], v[20:23], v[252:255], v[64:79]
  v_mfma_f32_32x32x16_bf16 v[80:95], v[24:27], v[252:255], v[80:95]
  v_mfma_f32_32x32x16_bf16 v[96:111], v[28:31], v[252:255], v[96:111]
  ds_read_b128 v[200:203], v7 offset:544
  ds_read_b128 v[204:207], v7 offset:560
  ds_read_b128 v[208:211], v7 offset:576
  ds_read_b128 v[212:215], v7 offset:592
  ds_read_b128 v[216:219], v7 offset:608
  ds_read_b128 v[220:223], v7 offset:624
  s_waitcnt lgkmcnt(0)
  s_mul_i32 s37, s28, 88064
  s_lshl_b32 s36, s64, 10
  s_add_u32 s37, s37, s36
  s_add_u32 s37, s37, 24117248
  v_fma_f32 v136, v36, v128, v136
  v_fma_f32 v137, v36, v129, v137
  v_fma_f32 v138, v36, v130, v138
  v_fma_f32 v139, v36, v131, v139
  v_fma_f32 v140, v36, v132, v140
  v_fma_f32 v141, v36, v133, v141
  v_fma_f32 v142, v36, v134, v142
  v_fma_f32 v143, v36, v135, v143
  v_fma_f32 v152, v38, v144, v152
  v_fma_f32 v153, v38, v145, v153
  v_fma_f32 v154, v38, v146, v154
  v_fma_f32 v155, v38, v147, v155
  v_fma_f32 v156, v38, v148, v156
  v_fma_f32 v157, v38, v149, v157
  v_fma_f32 v158, v38, v150, v158
  v_fma_f32 v159, v38, v151, v159
  v_fma_f32 v64, v64, v35, v136
  v_fma_f32 v65, v65, v35, v137
  v_fma_f32 v66, v66, v35, v138
  v_fma_f32 v67, v67, v35, v139
  v_fma_f32 v68, v68, v35, v140
  v_fma_f32 v69, v69, v35, v141
  v_fma_f32 v70, v70, v35, v142
  v_fma_f32 v71, v71, v35, v143
  v_exp_f32 v40, v64
  v_exp_f32 v41, v65
  v_exp_f32 v42, v66
  v_exp_f32 v43, v67
  v_exp_f32 v44, v68
  v_exp_f32 v45, v69
  v_exp_f32 v46, v70
  v_exp_f32 v47, v71
  v_fma_f32 v72, v72, v37, v152
  v_fma_f32 v73, v73, v37, v153
  v_fma_f32 v74, v74, v37, v154
  v_fma_f32 v75, v75, v37, v155
  v_fma_f32 v76, v76, v37, v156
  v_fma_f32 v77, v77, v37, v157
  v_fma_f32 v78, v78, v37, v158
  v_fma_f32 v79, v79, v37, v159
  v_add_f32 v40, 1.0, v40
  v_add_f32 v41, 1.0, v41
  v_add_f32 v42, 1.0, v42
  v_add_f32 v43, 1.0, v43
  v_add_f32 v44, 1.0, v44
  v_add_f32 v45, 1.0, v45
  v_add_f32 v46, 1.0, v46
  v_add_f32 v47, 1.0, v47
  v_mul_f32 v64, v64, v72
  v_mul_f32 v65, v65, v73
  v_mul_f32 v66, v66, v74
  v_mul_f32 v67, v67, v75
  v_mul_f32 v68, v68, v76
  v_mul_f32 v69, v69, v77
  v_mul_f32 v70, v70, v78
  v_mul_f32 v71, v71, v79
  v_rcp_f32 v40, v40
  v_rcp_f32 v41, v41
  v_rcp_f32 v42, v42
  v_rcp_f32 v43, v43
  v_rcp_f32 v44, v44
  v_rcp_f32 v45, v45
  v_rcp_f32 v46, v46
  v_rcp_f32 v47, v47
  s_nop 0
  v_mul_f32 v64, v64, v40
  v_mul_f32 v65, v65, v41
  v_mul_f32 v66, v66, v42
  v_mul_f32 v67, v67, v43
  v_mul_f32 v68, v68, v44
  v_mul_f32 v69, v69, v45
  v_mul_f32 v70, v70, v46
  v_mul_f32 v71, v71, v47
  v_cvt_pk_bf16_f32 v48, v64, v65
  v_cvt_pk_bf16_f32 v49, v66, v67
  v_cvt_pk_bf16_f32 v50, v68, v69
  v_cvt_pk_bf16_f32 v51, v70, v71
  buffer_store_dwordx4 v[48:51], v3, s[24:27], s37 offen offset:0 sc1
  v_fma_f32 v168, v36, v160, v168
  v_fma_f32 v169, v36, v161, v169
  v_fma_f32 v170, v36, v162, v170
  v_fma_f32 v171, v36, v163, v171
  v_fma_f32 v172, v36, v164, v172
  v_fma_f32 v173, v36, v165, v173
  v_fma_f32 v174, v36, v166, v174
  v_fma_f32 v175, v36, v167, v175
  v_fma_f32 v184, v38, v176, v184
  v_fma_f32 v185, v38, v177, v185
  v_fma_f32 v186, v38, v178, v186
  v_fma_f32 v187, v38, v179, v187
  v_fma_f32 v188, v38, v180, v188
  v_fma_f32 v189, v38, v181, v189
  v_fma_f32 v190, v38, v182, v190
  v_fma_f32 v191, v38, v183, v191
  v_fma_f32 v80, v80, v35, v168
  v_fma_f32 v81, v81, v35, v169
  v_fma_f32 v82, v82, v35, v170
  v_fma_f32 v83, v83, v35, v171
  v_fma_f32 v84, v84, v35, v172
  v_fma_f32 v85, v85, v35, v173
  v_fma_f32 v86, v86, v35, v174
  v_fma_f32 v87, v87, v35, v175
  v_exp_f32 v40, v80
  v_exp_f32 v41, v81
  v_exp_f32 v42, v82
  v_exp_f32 v43, v83
  v_exp_f32 v44, v84
  v_exp_f32 v45, v85
  v_exp_f32 v46, v86
  v_exp_f32 v47, v87
  v_fma_f32 v88, v88, v37, v184
  v_fma_f32 v89, v89, v37, v185
  v_fma_f32 v90, v90, v37, v186
  v_fma_f32 v91, v91, v37, v187
  v_fma_f32 v92, v92, v37, v188
  v_fma_f32 v93, v93, v37, v189
  v_fma_f32 v94, v94, v37, v190
  v_fma_f32 v95, v95, v37, v191
  v_add_f32 v40, 1.0, v40
  v_add_f32 v41, 1.0, v41
  v_add_f32 v42, 1.0, v42
  v_add_f32 v43, 1.0, v43
  v_add_f32 v44, 1.0, v44
  v_add_f32 v45, 1.0, v45
  v_add_f32 v46, 1.0, v46
  v_add_f32 v47, 1.0, v47
  v_mul_f32 v80, v80, v88
  v_mul_f32 v81, v81, v89
  v_mul_f32 v82, v82, v90
  v_mul_f32 v83, v83, v91
  v_mul_f32 v84, v84, v92
  v_mul_f32 v85, v85, v93
  v_mul_f32 v86, v86, v94
  v_mul_f32 v87, v87, v95
  v_rcp_f32 v40, v40
  v_rcp_f32 v41, v41
  v_rcp_f32 v42, v42
  v_rcp_f32 v43, v43
  v_rcp_f32 v44, v44
  v_rcp_f32 v45, v45
  v_rcp_f32 v46, v46
  v_rcp_f32 v47, v47
  s_nop 0
  v_mul_f32 v80, v80, v40
  v_mul_f32 v81, v81, v41
  v_mul_f32 v82, v82, v42
  v_mul_f32 v83, v83, v43
  v_mul_f32 v84, v84, v44
  v_mul_f32 v85, v85, v45
  v_mul_f32 v86, v86, v46
  v_mul_f32 v87, v87, v47
  v_cvt_pk_bf16_f32 v52, v80, v81
  v_cvt_pk_bf16_f32 v53, v82, v83
  v_cvt_pk_bf16_f32 v54, v84, v85
  v_cvt_pk_bf16_f32 v55, v86, v87
  buffer_store_dwordx4 v[52:55], v3, s[24:27], s37 offen offset:1024 sc1
  s_cmp_eq_u32 s65, 0
  s_cbranch_scc1 L_p4_done
  v_fma_f32 v200, v36, v192, v200
  v_fma_f32 v201, v36, v193, v201
  v_fma_f32 v202, v36, v194, v202
  v_fma_f32 v203, v36, v195, v203
  v_fma_f32 v204, v36, v196, v204
  v_fma_f32 v205, v36, v197, v205
  v_fma_f32 v206, v36, v198, v206
  v_fma_f32 v207, v36, v199, v207
  v_fma_f32 v216, v38, v208, v216
  v_fma_f32 v217, v38, v209, v217
  v_fma_f32 v218, v38, v210, v218
  v_fma_f32 v219, v38, v211, v219
  v_fma_f32 v220, v38, v212, v220
  v_fma_f32 v221, v38, v213, v221
  v_fma_f32 v222, v38, v214, v222
  v_fma_f32 v223, v38, v215, v223
  v_fma_f32 v96, v96, v35, v200
  v_fma_f32 v97, v97, v35, v201
  v_fma_f32 v98, v98, v35, v202
  v_fma_f32 v99, v99, v35, v203
  v_fma_f32 v100, v100, v35, v204
  v_fma_f32 v101, v101, v35, v205
  v_fma_f32 v102, v102, v35, v206
  v_fma_f32 v103, v103, v35, v207
  v_exp_f32 v40, v96
  v_exp_f32 v41, v97
  v_exp_f32 v42, v98
  v_exp_f32 v43, v99
  v_exp_f32 v44, v100
  v_exp_f32 v45, v101
  v_exp_f32 v46, v102
  v_exp_f32 v47, v103
  v_fma_f32 v104, v104, v37, v216
  v_fma_f32 v105, v105, v37, v217
  v_fma_f32 v106, v106, v37, v218
  v_fma_f32 v107, v107, v37, v219
  v_fma_f32 v108, v108, v37, v220
  v_fma_f32 v109, v109, v37, v221
  v_fma_f32 v110, v110, v37, v222
  v_fma_f32 v111, v111, v37, v223
  v_add_f32 v40, 1.0, v40
  v_add_f32 v41, 1.0, v41
  v_add_f32 v42, 1.0, v42
  v_add_f32 v43, 1.0, v43
  v_add_f32 v44, 1.0, v44
  v_add_f32 v45, 1.0, v45
  v_add_f32 v46, 1.0, v46
  v_add_f32 v47, 1.0, v47
  v_mul_f32 v96, v96, v104
  v_mul_f32 v97, v97, v105
  v_mul_f32 v98, v98, v106
  v_mul_f32 v99, v99, v107
  v_mul_f32 v100, v100, v108
  v_mul_f32 v101, v101, v109
  v_mul_f32 v102, v102, v110
  v_mul_f32 v103, v103, v111
  v_rcp_f32 v40, v40
  v_rcp_f32 v41, v41
  v_rcp_f32 v42, v42
  v_rcp_f32 v43, v43
  v_rcp_f32 v44, v44
  v_rcp_f32 v45, v45
  v_rcp_f32 v46, v46
  v_rcp_f32 v47, v47
  s_nop 0
  v_mul_f32 v96, v96, v40
  v_mul_f32 v97, v97, v41
  v_mul_f32 v98, v98, v42
  v_mul_f32 v99, v99, v43
  v_mul_f32 v100, v100, v44
  v_mul_f32 v101, v101, v45
  v_mul_f32 v102, v102, v46
  v_mul_f32 v103, v103, v47
  v_cvt_pk_bf16_f32 v56, v96, v97
  v_cvt_pk_bf16_f32 v57, v98, v99
  v_cvt_pk_bf16_f32 v58, v100, v101
  v_cvt_pk_bf16_f32 v59, v102, v103
  buffer_store_dwordx4 v[56:59], v3, s[24:27], s37 offen offset:2048 sc1
L_p4_done:
  s_lshl_b32 s30, s66, 5
  s_add_u32 s30, s30, s67
  s_load_dwordx2 s[40:41], s[0:1], 48
  s_waitcnt vmcnt(0)
  s_barrier
  s_cmp_lg_u32 s22, 0
  s_cbranch_scc1 Lpub_mega_kernel_43
  s_lshl_b32 s73, s30, 7
  s_add_u32 s73, s73, 35782656
  v_mov_b32 v4, s73
  v_mov_b32 v5, s72
  s_mov_b64 exec, 1
  global_store_dword v4, v5, s[8:9] sc1
  s_mov_b64 exec, -1
Lpub_mega_kernel_43:
  s_lshr_b32 s59, s2, 5
  s_waitcnt lgkmcnt(0)
  s_mov_b32 s40, s40
  s_and_b32 s41, s41, 0xffff
  s_mov_b32 s42, 1409024
  s_mov_b32 s43, 0x20000
  v_lshrrev_b32 v8, 3, v2
  v_bfe_u32 v9, v2, 4, 1
  v_lshlrev_b32 v9, 2, v9
  v_lshlrev_b32 v8, 10, v8
  v_and_b32 v10, 7, v2
  v_xor_b32 v9, v9, v10
  v_lshl_add_u32 v8, v9, 4, v8
  s_and_b32 s60, s22, 1
  s_lshr_b32 s61, s22, 1
  s_lshl_b32 s62, s59, 7
  s_lshl_b32 s63, s60, 13
  s_add_u32 s62, s62, s63
  s_lshl_b32 s63, s61, 17
  s_add_u32 s62, s62, s63
  s_lshl_b32 s61, s61, 15
  s_lshl_b32 s60, s60, 10
  s_add_u32 s61, s61, s60
  s_add_u32 s61, s61, 2048
  s_add_u32 m0, s61, 0
  s_add_u32 s63, s62, 0
  buffer_load_dwordx4 v8, s[40:43], s63 offen lds
  s_add_u32 m0, s61, 4096
  s_add_u32 s63, s62, 16384
  buffer_load_dwordx4 v8, s[40:43], s63 offen lds
  s_add_u32 m0, s61, 8192
  s_add_u32 s63, s62, 32768
  buffer_load_dwordx4 v8, s[40:43], s63 offen lds
  s_add_u32 m0, s61, 12288
  s_add_u32 s63, s62, 49152
  buffer_load_dwordx4 v8, s[40:43], s63 offen lds
  s_add_u32 m0, s61, 16384
  s_add_u32 s63, s62, 65536
  buffer_load_dwordx4 v8, s[40:43], s63 offen lds
  s_add_u32 m0, s61, 20480
  s_add_u32 s63, s62, 81920
  buffer_load_dwordx4 v8, s[40:43], s63 offen lds
  s_add_u32 m0, s61, 24576
  s_add_u32 s63, s62, 98304
  buffer_load_dwordx4 v8, s[40:43], s63 offen lds
  s_add_u32 m0, s61, 28672
  s_add_u32 s63, s62, 114688
  buffer_load_dwordx4 v8, s[40:43], s63 offen lds
  s_and_b32 s60, s22, 1
  s_lshr_b32 s61, s22, 1
  s_lshl_b32 s62, s59, 7
  s_lshl_b32 s63, s60, 13
  s_add_u32 s62, s62, s63
  s_lshl_b32 s63, s61, 16
  s_add_u32 s62, s62, s63
  s_add_u32 s62, s62, 524288
  s_lshl_b32 s61, s61, 13
  s_lshl_b32 s60, s60, 10
  s_add_u32 s61, s61, s60
  s_add_u32 s61, s61, 131072
  s_add_u32 m0, s61, 0
  s_add_u32 s63, s62, 0
  buffer_load_dwordx4 v8, s[40:43], s63 offen lds
  s_add_u32 m0, s61, 2048
  s_add_u32 s63, s62, 16384
  buffer_load_dwordx4 v8, s[40:43], s63 offen lds
  s_add_u32 m0, s61, 4096
  s_add_u32 s63, s62, 32768
  buffer_load_dwordx4 v8, s[40:43], s63 offen lds
  s_add_u32 m0, s61, 6144
  s_add_u32 s63, s62, 49152
  buffer_load_dwordx4 v8, s[40:43], s63 offen lds
  s_and_b32 s16, s2, 7
  s_lshr_b32 s17, s2, 3
  s_lshl_b32 s20, s16, 2
  s_and_b32 s18, s17, 3
  s_add_u32 s20, s20, s18
  s_lshr_b32 s21, s17, 2
  s_cmp_lg_u32 s22, 1
  s_cbranch_scc1 L_mega_kernel_44
  v_lshlrev_b32 v24, 7, v2
  v_add_u32 v24, 35819520, v24
  s_mov_b64 exec, 0xffffffff
  s_mov_b32 s73, 0
Lq_mega_kernel_45:
  global_load_dword v25, v24, s[8:9] sc1
  s_waitcnt vmcnt(0)
  s_add_u32 s73, s73, 1
  s_cmp_gt_u32 s73, 200000
  s_cbranch_scc1 Lqx_mega_kernel_46
  v_cmp_ne_u32 vcc, s72, v25
  s_nop 1
  s_cbranch_vccnz Lq_mega_kernel_45
Lqx_mega_kernel_46:
  s_mov_b64 exec, -1
L_mega_kernel_44:
  s_lshr_b32 s30, s20, 2
  s_lshl_b32 s30, s30, 5
  s_cmp_ge_u32 s22, 1
  s_cbranch_scc1 Lw_mega_kernel_47
  s_lshl_b32 s73, s30, 7
  s_add_u32 s73, s73, 35782656
  v_lshlrev_b32 v4, 7, v2
  v_add_u32 v4, s73, v4
  s_mov_b64 exec, 0xffffffff
  s_mov_b32 s73, 0
  global_load_dword v5, v4, s[8:9] sc1
Lp_mega_kernel_48:
  s_waitcnt vmcnt(0)
  v_cmp_ne_u32 vcc, s72, v5
  s_nop 1
  s_cbranch_vccz Lx_mega_kernel_49
  s_sleep 4
  global_load_dword v5, v4, s[8:9] sc1
  s_add_u32 s73, s73, 1
  s_cmp_lt_u32 s73, 100000
  s_cbranch_scc1 Lp_mega_kernel_48
Lx_mega_kernel_49:
  s_waitcnt vmcnt(0)
  s_mov_b64 exec, -1
Lw_mega_kernel_47:
  s_and_b32 s16, s2, 7
  s_lshr_b32 s17, s2, 3
  s_lshl_b32 s20, s16, 2
  s_and_b32 s18, s17, 3
  s_add_u32 s20, s20, s18
  s_lshr_b32 s21, s17, 2
  s_load_dwordx2 s[10:11], s[0:1], 72
  s_and_b32 s55, s22, 1
  s_lshl_b32 s54, s20, 1
  s_add_u32 s54, s54, s55
  s_lshr_b32 s55, s22, 1
  s_and_b32 s55, s55, 1
  s_lshl_b32 s57, s21, 1
  s_add_u32 s57, s57, s55
  v_lshrrev_b32 v31, 5, v2
  v_lshlrev_b32 v30, 4, v31
  s_cmp_ge_u32 s22, 4
  s_cbranch_scc1 L_p5_ld
  s_and_b32 s62, s22, 1
  s_lshl_b32 s62, s62, 10
  v_add_u32 v4, s62, v3
  v_bfe_u32 v5, v2, 2, 2
  v_lshrrev_b32 v6, 5, v2
  v_lshl_add_u32 v6, v6, 2, v5
  v_lshlrev_b32 v6, 7, v6
  v_lshrrev_b32 v5, 1, v5
  v_lshlrev_b32 v5, 2, v5
  v_bfe_u32 v7, v2, 4, 1
  v_lshlrev_b32 v7, 1, v7
  v_bfe_u32 v8, v2, 1, 1
  v_add_u32 v7, v7, v8
  s_lshr_b32 s62, s22, 1
  s_lshl_b32 s62, s62, 2
  v_add_u32 v7, s62, v7
  v_xor_b32 v7, v7, v5
  v_lshl_add_u32 v6, v7, 4, v6
  v_and_b32 v7, 1, v2
  v_lshl_add_u32 v5, v7, 3, v6
  v_add_u32 v5, 2048, v5
  v_add_u32 v6, 65536, v4
  v_add_u32 v7, 65536, v5
  v_add_u32 v28, 129024, v5
  s_waitcnt vmcnt(0)
  s_barrier
  s_lshl_b32 s56, s57, 7
  s_add_u32 s56, s56, 10240
  buffer_load_dwordx4 v[128:131], v30, s[24:27], s56 offen offset:0 sc1
  buffer_load_dwordx4 v[132:135], v30, s[24:27], s56 offen offset:32 sc1
  buffer_load_dwordx4 v[136:139], v30, s[24:27], s56 offen offset:64 sc1
  buffer_load_dwordx4 v[140:143], v30, s[24:27], s56 offen offset:96 sc1
  s_waitcnt lgkmcnt(0)
  s_lshl_b32 s53, s54, 15
  s_lshl_b32 s52, s57, 11
  s_add_u32 s53, s53, s52
  s_add_u32 s52, s53, 19922944
  buffer_load_dwordx4 v[160:163], v3, s[24:27], s52 offen sc1
  buffer_load_dwordx4 v[164:167], v3, s[24:27], s52 offen offset:1024 sc1
  v_mov_b64 v[64:65], 0
  v_mov_b64 v[66:67], 0
  v_mov_b64 v[68:69], 0
  v_mov_b64 v[70:71], 0
  v_mov_b64 v[72:73], 0
  v_mov_b64 v[74:75], 0
  v_mov_b64 v[76:77], 0
  v_mov_b64 v[78:79], 0
  s_barrier
  ds_read_b128 v[8:11], v4 offset:0
  ds_read_b64_tr_b16 v[12:13], v5 offset:0
  ds_read_b64_tr_b16 v[14:15], v5 offset:1024
  ds_read_b128 v[16:19], v4 offset:4096
  ds_read_b64_tr_b16 v[20:21], v5 offset:4096
  ds_read_b64_tr_b16 v[22:23], v5 offset:5120
  s_waitcnt lgkmcnt(3)
  v_mfma_f32_32x32x16_bf16 v[64:79], v[12:15], v[8:11], v[64:79]
  ds_read_b128 v[8:11], v4 offset:8192
  ds_read_b64_tr_b16 v[12:13], v5 offset:8192
  ds_read_b64_tr_b16 v[14:15], v5 offset:9216
  s_waitcnt lgkmcnt(3)
  v_mfma_f32_32x32x16_bf16 v[64:79], v[20:23], v[16:19], v[64:79]
  ds_read_b128 v[16:19], v4 offset:12288
  ds_read_b64_tr_b16 v[20:21], v5 offset:12288
  ds_read_b64_tr_b16 v[22:23], v5 offset:13312
  s_waitcnt lgkmcnt(3)
  v_mfma_f32_32x32x16_bf16 v[64:79], v[12:15], v[8:11], v[64:79]
  s_barrier
  ds_read_b128 v[8:11], v4 offset:16384
  ds_read_b64_tr_b16 v[12:13], v5 offset:16384
  ds_read_b64_tr_b16 v[14:15], v5 offset:17408
  s_waitcnt lgkmcnt(3)
  v_mfma_f32_32x32x16_bf16 v[64:79], v[20:23], v[16:19], v[64:79]
  ds_read_b128 v[16:19], v4 offset:20480
  ds_read_b64_tr_b16 v[20:21], v5 offset:20480
  ds_read_b64_tr_b16 v[22:23], v5 offset:21504
  s_waitcnt lgkmcnt(3)
  v_mfma_f32_32x32x16_bf16 v[64:79], v[12:15], v[8:11], v[64:79]
  ds_read_b128 v[8:11], v4 offset:24576
  ds_read_b64_tr_b16 v[12:13], v5 offset:24576
  ds_read_b64_tr_b16 v[14:15], v5 offset:25600
  s_waitcnt lgkmcnt(3)
  v_mfma_f32_32x32x16_bf16 v[64:79], v[20:23], v[16:19], v[64:79]
  ds_read_b128 v[16:19], v4 offset:28672
  ds_read_b64_tr_b16 v[20:21], v5 offset:28672
  ds_read_b64_tr_b16 v[22:23], v5 offset:29696
  s_waitcnt lgkmcnt(3)
  v_mfma_f32_32x32x16_bf16 v[64:79], v[12:15], v[8:11], v[64:79]
  s_barrier
  ds_read_b128 v[8:11], v4 offset:32768
  ds_read_b64_tr_b16 v[12:13], v5 offset:32768
  ds_read_b64_tr_b16 v[14:15], v5 offset:33792
  s_waitcnt lgkmcnt(3)
  v_mfma_f32_32x32x16_bf16 v[64:79], v[20:23], v[16:19], v[64:79]
  ds_read_b128 v[16:19], v4 offset:36864
  ds_read_b64_tr_b16 v[20:21], v5 offset:36864
  ds_read_b64_tr_b16 v[22:23], v5 offset:37888
  s_waitcnt lgkmcnt(3)
  v_mfma_f32_32x32x16_bf16 v[64:79], v[12:15], v[8:11], v[64:79]
  ds_read_b128 v[8:11], v4 offset:40960
  ds_read_b64_tr_b16 v[12:13], v5 offset:40960
  ds_read_b64_tr_b16 v[14:15], v5 offset:41984
  s_waitcnt lgkmcnt(3)
  v_mfma_f32_32x32x16_bf16 v[64:79], v[20:23], v[16:19], v[64:79]
  ds_read_b128 v[16:19], v4 offset:45056
  ds_read_b64_tr_b16 v[20:21], v5 offset:45056
  ds_read_b64_tr_b16 v[22:23], v5 offset:46080
  s_waitcnt lgkmcnt(3)
  v_mfma_f32_32x32x16_bf16 v[64:79], v[12:15], v[8:11], v[64:79]
  s_barrier
  ds_read_b128 v[8:11], v4 offset:49152
  ds_read_b64_tr_b16 v[12:13], v5 offset:49152
  ds_read_b64_tr_b16 v[14:15], v5 offset:50176
  s_waitcnt lgkmcnt(3)
  v_mfma_f32_32x32x16_bf16 v[64:79], v[20:23], v[16:19], v[64:79]
  ds_read_b128 v[16:19], v4 offset:53248
  ds_read_b64_tr_b16 v[20:21], v5 offset:53248
  ds_read_b64_tr_b16 v[22:23], v5 offset:54272
  s_waitcnt lgkmcnt(3)
  v_mfma_f32_32x32x16_bf16 v[64:79], v[12:15], v[8:11], v[64:79]
  ds_read_b128 v[8:11], v4 offset:57344
  ds_read_b64_tr_b16 v[12:13], v5 offset:57344
  ds_read_b64_tr_b16 v[14:15], v5 offset:58368
  s_waitcnt lgkmcnt(3)
  v_mfma_f32_32x32x16_bf16 v[64:79], v[20:23], v[16:19], v[64:79]
  ds_read_b128 v[16:19], v4 offset:61440
  ds_read_b64_tr_b16 v[20:21], v5 offset:61440
  ds_read_b64_tr_b16 v[22:23], v5 offset:62464
  s_waitcnt lgkmcnt(3)
  v_mfma_f32_32x32x16_bf16 v[64:79], v[12:15], v[8:11], v[64:79]
  s_barrier
  ds_read_b128 v[8:11], v6 offset:0
  ds_read_b64_tr_b16 v[12:13], v7 offset:0
  ds_read_b64_tr_b16 v[14:15], v7 offset:1024
  s_waitcnt lgkmcnt(3)
  v_mfma_f32_32x32x16_bf16 v[64:79], v[20:23], v[16:19], v[64:79]
  ds_read_b128 v[16:19], v6 offset:4096
  ds_read_b64_tr_b16 v[20:21], v7 offset:4096
  ds_read_b64_tr_b16 v[22:23], v7 offset:5120
  s_waitcnt lgkmcnt(3)
  v_mfma_f32_32x32x16_bf16 v[64:79], v[12:15], v[8:11], v[64:79]
  ds_read_b128 v[8:11], v6 offset:8192
  ds_read_b64_tr_b16 v[12:13], v7 offset:8192
  ds_read_b64_tr_b16 v[14:15], v7 offset:9216
  s_waitcnt lgkmcnt(3)
  v_mfma_f32_32x32x16_bf16 v[64:79], v[20:23], v[16:19], v[64:79]
  ds_read_b128 v[16:19], v6 offset:12288
  ds_read_b64_tr_b16 v[20:21], v7 offset:12288
  ds_read_b64_tr_b16 v[22:23], v7 offset:13312
  s_waitcnt lgkmcnt(3)
  v_mfma_f32_32x32x16_bf16 v[64:79], v[12:15], v[8:11], v[64:79]
  s_barrier
  ds_read_b128 v[8:11], v6 offset:16384
  ds_read_b64_tr_b16 v[12:13], v7 offset:16384
  ds_read_b64_tr_b16 v[14:15], v7 offset:17408
  s_waitcnt lgkmcnt(3)
  v_mfma_f32_32x32x16_bf16 v[64:79], v[20:23], v[16:19], v[64:79]
  ds_read_b128 v[16:19], v6 offset:20480
  ds_read_b64_tr_b16 v[20:21], v7 offset:20480
  ds_read_b64_tr_b16 v[22:23], v7 offset:21504
  s_waitcnt lgkmcnt(3)
  v_mfma_f32_32x32x16_bf16 v[64:79], v[12:15], v[8:11], v[64:79]
  ds_read_b128 v[8:11], v6 offset:24576
  ds_read_b64_tr_b16 v[12:13], v7 offset:24576
  ds_read_b64_tr_b16 v[14:15], v7 offset:25600
  s_waitcnt lgkmcnt(3)
  v_mfma_f32_32x32x16_bf16 v[64:79], v[20:23], v[16:19], v[64:79]
  ds_read_b128 v[16:19], v6 offset:28672
  ds_read_b64_tr_b16 v[20:21], v7 offset:28672
  ds_read_b64_tr_b16 v[22:23], v7 offset:29696
  s_waitcnt lgkmcnt(3)
  v_mfma_f32_32x32x16_bf16 v[64:79], v[12:15], v[8:11], v[64:79]
  s_barrier
  ds_read_b128 v[8:11], v6 offset:32768
  ds_read_b64_tr_b16 v[12:13], v7 offset:32768
  ds_read_b64_tr_b16 v[14:15], v7 offset:33792
  s_waitcnt lgkmcnt(3)
  v_mfma_f32_32x32x16_bf16 v[64:79], v[20:23], v[16:19], v[64:79]
  ds_read_b128 v[16:19], v6 offset:36864
  ds_read_b64_tr_b16 v[20:21], v7 offset:36864
  ds_read_b64_tr_b16 v[22:23], v7 offset:37888
  s_waitcnt lgkmcnt(3)
  v_mfma_f32_32x32x16_bf16 v[64:79], v[12:15], v[8:11], v[64:79]
  ds_read_b128 v[8:11], v6 offset:40960
  ds_read_b64_tr_b16 v[12:13], v7 offset:40960
  ds_read_b64_tr_b16 v[14:15], v7 offset:41984
  s_waitcnt lgkmcnt(3)
  v_mfma_f32_32x32x16_bf16 v[64:79], v[20:23], v[16:19], v[64:79]
  ds_read_b128 v[16:19], v6 offset:45056
  ds_read_b64_tr_b16 v[20:21], v7 offset:45056
  ds_read_b64_tr_b16 v[22:23], v7 offset:46080
  s_waitcnt lgkmcnt(3)
  v_mfma_f32_32x32x16_bf16 v[64:79], v[12:15], v[8:11], v[64:79]
  s_barrier
  ds_read_b128 v[8:11], v6 offset:49152
  ds_read_b64_tr_b16 v[12:13], v7 offset:49152
  ds_read_b64_tr_b16 v[14:15], v7 offset:50176
  s_waitcnt lgkmcnt(3)
  v_mfma_f32_32x32x16_bf16 v[64:79], v[20:23], v[16:19], v[64:79]
  ds_read_b128 v[16:19], v6 offset:53248
  ds_read_b64_tr_b16 v[20:21], v7 offset:53248
  ds_read_b64_tr_b16 v[22:23], v7 offset:54272
  s_waitcnt lgkmcnt(3)
  v_mfma_f32_32x32x16_bf16 v[64:79], v[12:15], v[8:11], v[64:79]
  ds_read_b128 v[8:11], v6 offset:57344
  ds_read_b64_tr_b16 v[12:13], v7 offset:57344
  ds_read_b64_tr_b16 v[14:15], v7 offset:58368
  s_waitcnt lgkmcnt(3)
  v_mfma_f32_32x32x16_bf16 v[64:79], v[20:23], v[16:19], v[64:79]
  ds_read_b128 v[16:19], v6 offset:61440
  ds_read_b64_tr_b16 v[20:21], v7 offset:61440
  ds_read_b64_tr_b16 v[22:23], v7 offset:62464
  s_waitcnt lgkmcnt(3)
  v_mfma_f32_32x32x16_bf16 v[64:79], v[12:15], v[8:11], v[64:79]
  s_barrier
  ds_read_b128 v[8:11], v4 offset:0
  ds_read_b64_tr_b16 v[12:13], v28 offset:0
  ds_read_b64_tr_b16 v[14:15], v28 offset:1024
  s_waitcnt lgkmcnt(3)
  v_mfma_f32_32x32x16_bf16 v[64:79], v[20:23], v[16:19], v[64:79]
  ds_read_b128 v[16:19], v4 offset:4096
  ds_read_b64_tr_b16 v[20:21], v28 offset:2048
  ds_read_b64_tr_b16 v[22:23], v28 offset:3072
  s_waitcnt lgkmcnt(3)
  v_mfma_f32_32x32x16_bf16 v[64:79], v[12:15], v[8:11], v[64:79]
  ds_read_b128 v[8:11], v4 offset:8192
  ds_read_b64_tr_b16 v[12:13], v28 offset:4096
  ds_read_b64_tr_b16 v[14:15], v28 offset:5120
  s_waitcnt lgkmcnt(3)
  v_mfma_f32_32x32x16_bf16 v[64:79], v[20:23], v[16:19], v[64:79]
  ds_read_b128 v[16:19], v4 offset:12288
  ds_read_b64_tr_b16 v[20:21], v28 offset:6144
  ds_read_b64_tr_b16 v[22:23], v28 offset:7168
  s_waitcnt lgkmcnt(3)
  v_mfma_f32_32x32x16_bf16 v[64:79], v[12:15], v[8:11], v[64:79]
  s_barrier
  ds_read_b128 v[8:11], v4 offset:16384
  ds_read_b64_tr_b16 v[12:13], v28 offset:8192
  ds_read_b64_tr_b16 v[14:15], v28 offset:9216
  s_waitcnt lgkmcnt(3)
  v_mfma_f32_32x32x16_bf16 v[64:79], v[20:23], v[16:19], v[64:79]
  ds_read_b128 v[16:19], v4 offset:20480
  ds_read_b64_tr_b16 v[20:21], v28 offset:10240
  ds_read_b64_tr_b16 v[22:23], v28 offset:11264
  s_waitcnt lgkmcnt(3)
  v_mfma_f32_32x32x16_bf16 v[64:79], v[12:15], v[8:11], v[64:79]
  ds_read_b128 v[8:11], v4 offset:24576
  ds_read_b64_tr_b16 v[12:13], v28 offset:12288
  ds_read_b64_tr_b16 v[14:15], v28 offset:13312
  s_waitcnt lgkmcnt(3)
  v_mfma_f32_32x32x16_bf16 v[64:79], v[20:23], v[16:19], v[64:79]
  ds_read_b128 v[16:19], v4 offset:28672
  ds_read_b64_tr_b16 v[20:21], v28 offset:14336
  ds_read_b64_tr_b16 v[22:23], v28 offset:15360
  s_waitcnt lgkmcnt(3)
  v_mfma_f32_32x32x16_bf16 v[64:79], v[12:15], v[8:11], v[64:79]
  s_barrier
  ds_read_b128 v[8:11], v4 offset:32768
  ds_read_b64_tr_b16 v[12:13], v28 offset:16384
  ds_read_b64_tr_b16 v[14:15], v28 offset:17408
  s_waitcnt lgkmcnt(3)
  v_mfma_f32_32x32x16_bf16 v[64:79], v[20:23], v[16:19], v[64:79]
  ds_read_b128 v[16:19], v4 offset:36864
  ds_read_b64_tr_b16 v[20:21], v28 offset:18432
  ds_read_b64_tr_b16 v[22:23], v28 offset:19456
  s_waitcnt lgkmcnt(3)
  v_mfma_f32_32x32x16_bf16 v[64:79], v[12:15], v[8:11], v[64:79]
  ds_read_b128 v[8:11], v4 offset:40960
  ds_read_b64_tr_b16 v[12:13], v28 offset:20480
  ds_read_b64_tr_b16 v[14:15], v28 offset:21504
  s_waitcnt lgkmcnt(3)
  v_mfma_f32_32x32x16_bf16 v[64:79], v[20:23], v[16:19], v[64:79]
  ds_read_b128 v[16:19], v4 offset:45056
  ds_read_b64_tr_b16 v[20:21], v28 offset:22528
  ds_read_b64_tr_b16 v[22:23], v28 offset:23552
  s_waitcnt lgkmcnt(3)
  v_mfma_f32_32x32x16_bf16 v[64:79], v[12:15], v[8:11], v[64:79]
  s_barrier
  ds_read_b128 v[8:11], v4 offset:49152
  ds_read_b64_tr_b16 v[12:13], v28 offset:24576
  ds_read_b64_tr_b16 v[14:15], v28 offset:25600
  s_waitcnt lgkmcnt(3)
  v_mfma_f32_32x32x16_bf16 v[64:79], v[20:23], v[16:19], v[64:79]
  ds_read_b128 v[16:19], v4 offset:53248
  ds_read_b64_tr_b16 v[20:21], v28 offset:26624
  ds_read_b64_tr_b16 v[22:23], v28 offset:27648
  s_waitcnt lgkmcnt(3)
  v_mfma_f32_32x32x16_bf16 v[64:79], v[12:15], v[8:11], v[64:79]
  ds_read_b128 v[8:11], v4 offset:57344
  ds_read_b64_tr_b16 v[12:13], v28 offset:28672
  ds_read_b64_tr_b16 v[14:15], v28 offset:29696
  s_waitcnt lgkmcnt(3)
  v_mfma_f32_32x32x16_bf16 v[64:79], v[20:23], v[16:19], v[64:79]
  ds_read_b128 v[16:19], v4 offset:61440
  ds_read_b64_tr_b16 v[20:21], v28 offset:30720
  ds_read_b64_tr_b16 v[22:23], v28 offset:31744
  s_waitcnt lgkmcnt(3)
  v_mfma_f32_32x32x16_bf16 v[64:79], v[12:15], v[8:11], v[64:79]
  s_barrier
  ds_read_b128 v[8:11], v6 offset:0
  ds_read_b64_tr_b16 v[12:13], v7 offset:0
  ds_read_b64_tr_b16 v[14:15], v7 offset:1024
  s_waitcnt lgkmcnt(3)
  v_mfma_f32_32x32x16_bf16 v[64:79], v[20:23], v[16:19], v[64:79]
  ds_read_b128 v[16:19], v6 offset:4096
  ds_read_b64_tr_b16 v[20:21], v7 offset:4096
  ds_read_b64_tr_b16 v[22:23], v7 offset:5120
  s_waitcnt lgkmcnt(3)
  v_mfma_f32_32x32x16_bf16 v[64:79], v[12:15], v[8:11], v[64:79]
  ds_read_b128 v[8:11], v6 offset:8192
  ds_read_b64_tr_b16 v[12:13], v7 offset:8192
  ds_read_b64_tr_b16 v[14:15], v7 offset:9216
  s_waitcnt lgkmcnt(3)
  v_mfma_f32_32x32x16_bf16 v[64:79], v[20:23], v[16:19], v[64:79]
  ds_read_b128 v[16:19], v6 offset:12288
  ds_read_b64_tr_b16 v[20:21], v7 offset:12288
  ds_read_b64_tr_b16 v[22:23], v7 offset:13312
  s_waitcnt lgkmcnt(3)
  v_mfma_f32_32x32x16_bf16 v[64:79], v[12:15], v[8:11], v[64:79]
  s_barrier
  ds_read_b128 v[8:11], v6 offset:16384
  ds_read_b64_tr_b16 v[12:13], v7 offset:16384
  ds_read_b64_tr_b16 v[14:15], v7 offset:17408
  s_waitcnt lgkmcnt(3)
  v_mfma_f32_32x32x16_bf16 v[64:79], v[20:23], v[16:19], v[64:79]
  ds_read_b128 v[16:19], v6 offset:20480
  ds_read_b64_tr_b16 v[20:21], v7 offset:20480
  ds_read_b64_tr_b16 v[22:23], v7 offset:21504
  s_waitcnt lgkmcnt(3)
  v_mfma_f32_32x32x16_bf16 v[64:79], v[12:15], v[8:11], v[64:79]
  ds_read_b128 v[8:11], v6 offset:24576
  ds_read_b64_tr_b16 v[12:13], v7 offset:24576
  ds_read_b64_tr_b16 v[14:15], v7 offset:25600
  s_waitcnt lgkmcnt(3)
  v_mfma_f32_32x32x16_bf16 v[64:79], v[20:23], v[16:19], v[64:79]
  ds_read_b128 v[16:19], v6 offset:28672
  ds_read_b64_tr_b16 v[20:21], v7 offset:28672
  ds_read_b64_tr_b16 v[22:23], v7 offset:29696
  s_waitcnt lgkmcnt(3)
  v_mfma_f32_32x32x16_bf16 v[64:79], v[12:15], v[8:11], v[64:79]
  s_barrier
  ds_read_b128 v[8:11], v6 offset:32768
  ds_read_b64_tr_b16 v[12:13], v7 offset:32768
  ds_read_b64_tr_b16 v[14:15], v7 offset:33792
  s_waitcnt lgkmcnt(3)
  v_mfma_f32_32x32x16_bf16 v[64:79], v[20:23], v[16:19], v[64:79]
  ds_read_b128 v[16:19], v6 offset:36864
  ds_read_b64_tr_b16 v[20:21], v7 offset:36864
  ds_read_b64_tr_b16 v[22:23], v7 offset:37888
  s_waitcnt lgkmcnt(3)
  v_mfma_f32_32x32x16_bf16 v[64:79], v[12:15], v[8:11], v[64:79]
  ds_read_b128 v[8:11], v6 offset:40960
  ds_read_b64_tr_b16 v[12:13], v7 offset:40960
  ds_read_b64_tr_b16 v[14:15], v7 offset:41984
  s_waitcnt lgkmcnt(3)
  v_mfma_f32_32x32x16_bf16 v[64:79], v[20:23], v[16:19], v[64:79]
  ds_read_b128 v[16:19], v6 offset:45056
  ds_read_b64_tr_b16 v[20:21], v7 offset:45056
  ds_read_b64_tr_b16 v[22:23], v7 offset:46080
  s_waitcnt lgkmcnt(3)
  v_mfma_f32_32x32x16_bf16 v[64:79], v[12:15], v[8:11], v[64:79]
  s_barrier
  ds_read_b128 v[8:11], v6 offset:49152
  ds_read_b64_tr_b16 v[12:13], v7 offset:49152
  ds_read_b64_tr_b16 v[14:15], v7 offset:50176
  s_waitcnt lgkmcnt(3)
  v_mfma_f32_32x32x16_bf16 v[64:79], v[20:23], v[16:19], v[64:79]
  ds_read_b128 v[16:19], v6 offset:53248
  ds_read_b64_tr_b16 v[20:21], v7 offset:53248
  ds_read_b64_tr_b16 v[22:23], v7 offset:54272
  s_waitcnt lgkmcnt(3)
  v_mfma_f32_32x32x16_bf16 v[64:79], v[12:15], v[8:11], v[64:79]
  ds_read_b128 v[8:11], v6 offset:57344
  ds_read_b64_tr_b16 v[12:13], v7 offset:57344
  ds_read_b64_tr_b16 v[14:15], v7 offset:58368
  s_waitcnt lgkmcnt(3)
  v_mfma_f32_32x32x16_bf16 v[64:79], v[20:23], v[16:19], v[64:79]
  ds_read_b128 v[16:19], v6 offset:61440
  ds_read_b64_tr_b16 v[20:21], v7 offset:61440
  ds_read_b64_tr_b16 v[22:23], v7 offset:62464
  s_waitcnt lgkmcnt(3)
  v_mfma_f32_32x32x16_bf16 v[64:79], v[12:15], v[8:11], v[64:79]
  s_barrier
  ds_read_b128 v[8:11], v4 offset:0
  ds_read_b64_tr_b16 v[12:13], v5 offset:0
  ds_read_b64_tr_b16 v[14:15], v5 offset:1024
  s_waitcnt lgkmcnt(3)
  v_mfma_f32_32x32x16_bf16 v[64:79], v[20:23], v[16:19], v[64:79]
  ds_read_b128 v[16:19], v4 offset:4096
  ds_read_b64_tr_b16 v[20:21], v5 offset:4096
  ds_read_b64_tr_b16 v[22:23], v5 offset:5120
  s_waitcnt lgkmcnt(3)
  v_mfma_f32_32x32x16_bf16 v[64:79], v[12:15], v[8:11], v[64:79]
  ds_read_b128 v[8:11], v4 offset:8192
  ds_read_b64_tr_b16 v[12:13], v5 offset:8192
  ds_read_b64_tr_b16 v[14:15], v5 offset:9216
  s_waitcnt lgkmcnt(3)
  v_mfma_f32_32x32x16_bf16 v[64:79], v[20:23], v[16:19], v[64:79]
  ds_read_b128 v[16:19], v4 offset:12288
  ds_read_b64_tr_b16 v[20:21], v5 offset:12288
  ds_read_b64_tr_b16 v[22:23], v5 offset:13312
  s_waitcnt lgkmcnt(3)
  v_mfma_f32_32x32x16_bf16 v[64:79], v[12:15], v[8:11], v[64:79]
  s_barrier
  ds_read_b128 v[8:11], v4 offset:16384
  ds_read_b64_tr_b16 v[12:13], v5 offset:16384
  ds_read_b64_tr_b16 v[14:15], v5 offset:17408
  s_waitcnt lgkmcnt(3)
  v_mfma_f32_32x32x16_bf16 v[64:79], v[20:23], v[16:19], v[64:79]
  ds_read_b128 v[16:19], v4 offset:20480
  ds_read_b64_tr_b16 v[20:21], v5 offset:20480
  ds_read_b64_tr_b16 v[22:23], v5 offset:21504
  s_waitcnt lgkmcnt(3)
  v_mfma_f32_32x32x16_bf16 v[64:79], v[12:15], v[8:11], v[64:79]
  ds_read_b128 v[8:11], v4 offset:24576
  ds_read_b64_tr_b16 v[12:13], v5 offset:24576
  ds_read_b64_tr_b16 v[14:15], v5 offset:25600
  s_waitcnt lgkmcnt(3)
  v_mfma_f32_32x32x16_bf16 v[64:79], v[20:23], v[16:19], v[64:79]
  ds_read_b128 v[16:19], v4 offset:28672
  ds_read_b64_tr_b16 v[20:21], v5 offset:28672
  ds_read_b64_tr_b16 v[22:23], v5 offset:29696
  s_waitcnt lgkmcnt(3)
  v_mfma_f32_32x32x16_bf16 v[64:79], v[12:15], v[8:11], v[64:79]
  s_barrier
  ds_read_b128 v[8:11], v4 offset:32768
  ds_read_b64_tr_b16 v[12:13], v5 offset:32768
  ds_read_b64_tr_b16 v[14:15], v5 offset:33792
  s_waitcnt lgkmcnt(3)
  v_mfma_f32_32x32x16_bf16 v[64:79], v[20:23], v[16:19], v[64:79]
  ds_read_b128 v[16:19], v4 offset:36864
  ds_read_b64_tr_b16 v[20:21], v5 offset:36864
  ds_read_b64_tr_b16 v[22:23], v5 offset:37888
  s_waitcnt lgkmcnt(3)
  v_mfma_f32_32x32x16_bf16 v[64:79], v[12:15], v[8:11], v[64:79]
  ds_read_b128 v[8:11], v4 offset:40960
  ds_read_b64_tr_b16 v[12:13], v5 offset:40960
  ds_read_b64_tr_b16 v[14:15], v5 offset:41984
  s_waitcnt lgkmcnt(3)
  v_mfma_f32_32x32x16_bf16 v[64:79], v[20:23], v[16:19], v[64:79]
  ds_read_b128 v[16:19], v4 offset:45056
  ds_read_b64_tr_b16 v[20:21], v5 offset:45056
  ds_read_b64_tr_b16 v[22:23], v5 offset:46080
  s_waitcnt lgkmcnt(3)
  v_mfma_f32_32x32x16_bf16 v[64:79], v[12:15], v[8:11], v[64:79]
  s_barrier
  ds_read_b128 v[8:11], v4 offset:49152
  ds_read_b64_tr_b16 v[12:13], v5 offset:49152
  ds_read_b64_tr_b16 v[14:15], v5 offset:50176
  s_waitcnt lgkmcnt(3)
  v_mfma_f32_32x32x16_bf16 v[64:79], v[20:23], v[16:19], v[64:79]
  ds_read_b128 v[16:19], v4 offset:53248
  ds_read_b64_tr_b16 v[20:21], v5 offset:53248
  ds_read_b64_tr_b16 v[22:23], v5 offset:54272
  s_waitcnt lgkmcnt(3)
  v_mfma_f32_32x32x16_bf16 v[64:79], v[12:15], v[8:11], v[64:79]
  ds_read_b128 v[8:11], v4 offset:57344
  ds_read_b64_tr_b16 v[12:13], v5 offset:57344
  ds_read_b64_tr_b16 v[14:15], v5 offset:58368
  s_waitcnt lgkmcnt(3)
  v_mfma_f32_32x32x16_bf16 v[64:79], v[20:23], v[16:19], v[64:79]
  ds_read_b128 v[16:19], v4 offset:61440
  ds_read_b64_tr_b16 v[20:21], v5 offset:61440
  ds_read_b64_tr_b16 v[22:23], v5 offset:62464
  s_waitcnt lgkmcnt(3)
  v_mfma_f32_32x32x16_bf16 v[64:79], v[12:15], v[8:11], v[64:79]
  s_barrier
  ds_read_b128 v[8:11], v6 offset:0
  ds_read_b64_tr_b16 v[12:13], v7 offset:0
  ds_read_b64_tr_b16 v[14:15], v7 offset:1024
  s_waitcnt lgkmcnt(3)
  v_mfma_f32_32x32x16_bf16 v[64:79], v[20:23], v[16:19], v[64:79]
  ds_read_b128 v[16:19], v6 offset:4096
  ds_read_b64_tr_b16 v[20:21], v7 offset:4096
  ds_read_b64_tr_b16 v[22:23], v7 offset:5120
  s_waitcnt lgkmcnt(3)
  v_mfma_f32_32x32x16_bf16 v[64:79], v[12:15], v[8:11], v[64:79]
  ds_read_b128 v[8:11], v6 offset:8192
  ds_read_b64_tr_b16 v[12:13], v7 offset:8192
  ds_read_b64_tr_b16 v[14:15], v7 offset:9216
  s_waitcnt lgkmcnt(3)
  v_mfma_f32_32x32x16_bf16 v[64:79], v[20:23], v[16:19], v[64:79]
  ds_read_b128 v[16:19], v6 offset:12288
  ds_read_b64_tr_b16 v[20:21], v7 offset:12288
  ds_read_b64_tr_b16 v[22:23], v7 offset:13312
  s_waitcnt lgkmcnt(3)
  v_mfma_f32_32x32x16_bf16 v[64:79], v[12:15], v[8:11], v[64:79]
  s_barrier
  ds_read_b128 v[8:11], v6 offset:16384
  ds_read_b64_tr_b16 v[12:13], v7 offset:16384
  ds_read_b64_tr_b16 v[14:15], v7 offset:17408
  s_waitcnt lgkmcnt(3)
  v_mfma_f32_32x32x16_bf16 v[64:79], v[20:23], v[16:19], v[64:79]
  ds_read_b128 v[16:19], v6 offset:20480
  ds_read_b64_tr_b16 v[20:21], v7 offset:20480
  ds_read_b64_tr_b16 v[22:23], v7 offset:21504
  s_waitcnt lgkmcnt(3)
  v_mfma_f32_32x32x16_bf16 v[64:79], v[12:15], v[8:11], v[64:79]
  s_waitcnt lgkmcnt(0)
  v_mfma_f32_32x32x16_bf16 v[64:79], v[20:23], v[16:19], v[64:79]
  s_branch L_p5_epi
L_p5_ld:
  s_sub_u32 s60, s22, 4
  s_and_b32 s63, s60, 1
  s_lshl_b32 s59, s20, 1
  s_add_u32 s59, s59, s63
  s_mul_i32 s59, s59, 88064
  s_add_u32 s59, s59, 24117248
  s_lshr_b32 s58, s60, 1
  s_lshl_b32 s57, s58, 10
  s_add_u32 s61, s59, s57
  s_lshl_b32 s57, s58, 12
  s_lshl_b32 s56, s63, 10
  s_add_u32 s58, s57, s56
  s_lshl_b32 s60, s60, 10
  v_lshrrev_b32 v8, 3, v2
  v_bfe_u32 v9, v2, 4, 1
  v_lshlrev_b32 v9, 2, v9
  v_lshlrev_b32 v8, 10, v8
  v_and_b32 v10, 7, v2
  v_xor_b32 v9, v9, v10
  v_lshl_add_u32 v8, v9, 4, v8
  s_lshl_b32 s56, s21, 7
  s_lshl_b32 s57, s63, 13
  s_add_u32 s56, s56, s57
  s_cmp_ge_u32 s22, 6
  s_cbranch_scc1 Lrw_mega_kernel_50
  s_barrier
  s_add_u32 m0, s58, 0
  s_add_u32 s63, s61, 0
  buffer_load_dwordx4 v3, s[24:27], s63 offen sc1 lds
  s_add_u32 m0, s58, 8192
  s_add_u32 s63, s61, 2048
  buffer_load_dwordx4 v3, s[24:27], s63 offen sc1 lds
  s_add_u32 m0, s58, 16384
  s_add_u32 s63, s61, 4096
  buffer_load_dwordx4 v3, s[24:27], s63 offen sc1 lds
  s_add_u32 m0, s58, 24576
  s_add_u32 s63, s61, 6144
  buffer_load_dwordx4 v3, s[24:27], s63 offen sc1 lds
  s_add_u32 m0, s58, 32768
  s_add_u32 s63, s61, 8192
  buffer_load_dwordx4 v3, s[24:27], s63 offen sc1 lds
  s_add_u32 m0, s58, 40960
  s_add_u32 s63, s61, 10240
  buffer_load_dwordx4 v3, s[24:27], s63 offen sc1 lds
  s_add_u32 m0, s58, 49152
  s_add_u32 s63, s61, 12288
  buffer_load_dwordx4 v3, s[24:27], s63 offen sc1 lds
  s_add_u32 m0, s58, 57344
  s_add_u32 s63, s61, 14336
  buffer_load_dwordx4 v3, s[24:27], s63 offen sc1 lds
  s_waitcnt vmcnt(6)
  s_barrier
  s_add_u32 m0, s58, 65536
  s_add_u32 s63, s61, 16384
  buffer_load_dwordx4 v3, s[24:27], s63 offen sc1 lds
  s_add_u32 m0, s58, 73728
  s_add_u32 s63, s61, 18432
  buffer_load_dwordx4 v3, s[24:27], s63 offen sc1 lds
  s_add_u32 m0, s58, 81920
  s_add_u32 s63, s61, 20480
  buffer_load_dwordx4 v3, s[24:27], s63 offen sc1 lds
  s_add_u32 m0, s58, 90112
  s_add_u32 s63, s61, 22528
  buffer_load_dwordx4 v3, s[24:27], s63 offen sc1 lds
  s_waitcnt vmcnt(8)
  s_barrier
  s_add_u32 m0, s58, 98304
  s_add_u32 s63, s61, 24576
  buffer_load_dwordx4 v3, s[24:27], s63 offen sc1 lds
  s_add_u32 m0, s58, 106496
  s_add_u32 s63, s61, 26624
  buffer_load_dwordx4 v3, s[24:27], s63 offen sc1 lds
  s_add_u32 m0, s58, 114688
  s_add_u32 s63, s61, 28672
  buffer_load_dwordx4 v3, s[24:27], s63 offen sc1 lds
  s_add_u32 m0, s58, 122880
  s_add_u32 s63, s61, 30720
  buffer_load_dwordx4 v3, s[24:27], s63 offen sc1 lds
  s_waitcnt vmcnt(10)
  s_barrier
  s_add_u32 m0, s58, 0
  s_add_u32 s63, s61, 32768
  buffer_load_dwordx4 v3, s[24:27], s63 offen sc1 lds
  s_add_u32 m0, s58, 8192
  s_add_u32 s63, s61, 34816
  buffer_load_dwordx4 v3, s[24:27], s63 offen sc1 lds
  s_waitcnt vmcnt(10)
  s_barrier
  s_add_u32 m0, s58, 16384
  s_add_u32 s63, s61, 36864
  buffer_load_dwordx4 v3, s[24:27], s63 offen sc1 lds
  s_add_u32 m0, s58, 24576
  s_add_u32 s63, s61, 38912
  buffer_load_dwordx4 v3, s[24:27], s63 offen sc1 lds
  s_waitcnt vmcnt(10)
  s_barrier
  s_add_u32 m0, s58, 32768
  s_add_u32 s63, s61, 40960
  buffer_load_dwordx4 v3, s[24:27], s63 offen sc1 lds
  s_add_u32 m0, s58, 40960
  s_add_u32 s63, s61, 43008
  buffer_load_dwordx4 v3, s[24:27], s63 offen sc1 lds
  s_waitcnt vmcnt(10)
  s_barrier
  s_add_u32 m0, s58, 49152
  s_add_u32 s63, s61, 45056
  buffer_load_dwordx4 v3, s[24:27], s63 offen sc1 lds
  s_add_u32 m0, s58, 57344
  s_add_u32 s63, s61, 47104
  buffer_load_dwordx4 v3, s[24:27], s63 offen sc1 lds
  s_waitcnt vmcnt(10)
  s_barrier
  s_add_u32 m0, s60, 65536
  s_add_u32 s63, s59, 49152
  buffer_load_dwordx4 v3, s[24:27], s63 offen sc1 lds
  s_add_u32 m0, s60, 69632
  s_add_u32 s63, s59, 50176
  buffer_load_dwordx4 v3, s[24:27], s63 offen sc1 lds
  s_add_u32 m0, s60, 73728
  s_add_u32 s63, s59, 51200
  buffer_load_dwordx4 v3, s[24:27], s63 offen sc1 lds
  s_add_u32 m0, s60, 77824
  s_add_u32 s63, s59, 52224
  buffer_load_dwordx4 v3, s[24:27], s63 offen sc1 lds
  s_waitcnt vmcnt(12)
  s_barrier
  s_add_u32 m0, s60, 81920
  s_add_u32 s63, s59, 53248
  buffer_load_dwordx4 v3, s[24:27], s63 offen sc1 lds
  s_add_u32 m0, s60, 86016
  s_add_u32 s63, s59, 54272
  buffer_load_dwordx4 v3, s[24:27], s63 offen sc1 lds
  s_add_u32 m0, s60, 90112
  s_add_u32 s63, s59, 55296
  buffer_load_dwordx4 v3, s[24:27], s63 offen sc1 lds
  s_add_u32 m0, s60, 94208
  s_add_u32 s63, s59, 56320
  buffer_load_dwordx4 v3, s[24:27], s63 offen sc1 lds
  s_waitcnt vmcnt(14)
  s_barrier
  s_add_u32 m0, s60, 98304
  s_add_u32 s63, s59, 57344
  buffer_load_dwordx4 v3, s[24:27], s63 offen sc1 lds
  s_add_u32 m0, s60, 102400
  s_add_u32 s63, s59, 58368
  buffer_load_dwordx4 v3, s[24:27], s63 offen sc1 lds
  s_add_u32 m0, s60, 106496
  s_add_u32 s63, s59, 59392
  buffer_load_dwordx4 v3, s[24:27], s63 offen sc1 lds
  s_add_u32 m0, s60, 110592
  s_add_u32 s63, s59, 60416
  buffer_load_dwordx4 v3, s[24:27], s63 offen sc1 lds
  s_waitcnt vmcnt(16)
  s_barrier
  s_add_u32 m0, s60, 114688
  s_add_u32 s63, s59, 61440
  buffer_load_dwordx4 v3, s[24:27], s63 offen sc1 lds
  s_add_u32 m0, s60, 118784
  s_add_u32 s63, s59, 62464
  buffer_load_dwordx4 v3, s[24:27], s63 offen sc1 lds
  s_add_u32 m0, s60, 122880
  s_add_u32 s63, s59, 63488
  buffer_load_dwordx4 v3, s[24:27], s63 offen sc1 lds
  s_add_u32 m0, s60, 126976
  s_add_u32 s63, s59, 64512
  buffer_load_dwordx4 v3, s[24:27], s63 offen sc1 lds
  s_waitcnt vmcnt(18)
  s_barrier
  s_add_u32 m0, s60, 0
  s_add_u32 s63, s59, 65536
  buffer_load_dwordx4 v3, s[24:27], s63 offen sc1 lds
  s_add_u32 m0, s60, 4096
  s_add_u32 s63, s59, 66560
  buffer_load_dwordx4 v3, s[24:27], s63 offen sc1 lds
  s_add_u32 m0, s60, 8192
  s_add_u32 s63, s59, 67584
  buffer_load_dwordx4 v3, s[24:27], s63 offen sc1 lds
  s_add_u32 m0, s60, 12288
  s_add_u32 s63, s59, 68608
  buffer_load_dwordx4 v3, s[24:27], s63 offen sc1 lds
  s_waitcnt vmcnt(20)
  s_barrier
  s_add_u32 m0, s60, 16384
  s_add_u32 s63, s59, 69632
  buffer_load_dwordx4 v3, s[24:27], s63 offen sc1 lds
  s_add_u32 m0, s60, 20480
  s_add_u32 s63, s59, 70656
  buffer_load_dwordx4 v3, s[24:27], s63 offen sc1 lds
  s_add_u32 m0, s60, 24576
  s_add_u32 s63, s59, 71680
  buffer_load_dwordx4 v3, s[24:27], s63 offen sc1 lds
  s_add_u32 m0, s60, 28672
  s_add_u32 s63, s59, 72704
  buffer_load_dwordx4 v3, s[24:27], s63 offen sc1 lds
  s_waitcnt vmcnt(20)
  s_barrier
  s_add_u32 m0, s60, 32768
  s_add_u32 s63, s59, 73728
  buffer_load_dwordx4 v3, s[24:27], s63 offen sc1 lds
  s_add_u32 m0, s60, 36864
  s_add_u32 s63, s59, 74752
  buffer_load_dwordx4 v3, s[24:27], s63 offen sc1 lds
  s_add_u32 m0, s60, 40960
  s_add_u32 s63, s59, 75776
  buffer_load_dwordx4 v3, s[24:27], s63 offen sc1 lds
  s_add_u32 m0, s60, 45056
  s_add_u32 s63, s59, 76800
  buffer_load_dwordx4 v3, s[24:27], s63 offen sc1 lds
  s_waitcnt vmcnt(20)
  s_barrier
  s_add_u32 m0, s60, 49152
  s_add_u32 s63, s59, 77824
  buffer_load_dwordx4 v3, s[24:27], s63 offen sc1 lds
  s_add_u32 m0, s60, 53248
  s_add_u32 s63, s59, 78848
  buffer_load_dwordx4 v3, s[24:27], s63 offen sc1 lds
  s_add_u32 m0, s60, 57344
  s_add_u32 s63, s59, 79872
  buffer_load_dwordx4 v3, s[24:27], s63 offen sc1 lds
  s_add_u32 m0, s60, 61440
  s_add_u32 s63, s59, 80896
  buffer_load_dwordx4 v3, s[24:27], s63 offen sc1 lds
  s_waitcnt vmcnt(20)
  s_barrier
  s_add_u32 m0, s60, 65536
  s_add_u32 s63, s59, 81920
  buffer_load_dwordx4 v3, s[24:27], s63 offen sc1 lds
  s_add_u32 m0, s60, 69632
  s_add_u32 s63, s59, 82944
  buffer_load_dwordx4 v3, s[24:27], s63 offen sc1 lds
  s_add_u32 m0, s60, 73728
  s_add_u32 s63, s59, 83968
  buffer_load_dwordx4 v3, s[24:27], s63 offen sc1 lds
  s_add_u32 m0, s60, 77824
  s_add_u32 s63, s59, 84992
  buffer_load_dwordx4 v3, s[24:27], s63 offen sc1 lds
  s_waitcnt vmcnt(20)
  s_barrier
  s_add_u32 m0, s60, 81920
  s_add_u32 s63, s59, 86016
  buffer_load_dwordx4 v3, s[24:27], s63 offen sc1 lds
  s_add_u32 m0, s60, 86016
  s_add_u32 s63, s59, 87040
  buffer_load_dwordx4 v3, s[24:27], s63 offen sc1 lds
  s_waitcnt vmcnt(18)
  s_barrier
  s_waitcnt vmcnt(14)
  s_barrier
  s_waitcnt vmcnt(10)
  s_barrier
  s_waitcnt vmcnt(6)
  s_barrier
  s_waitcnt vmcnt(2)
  s_barrier
  s_waitcnt vmcnt(0)
  s_barrier
  s_branch L_p5_fin
Lrw_mega_kernel_50:
  s_barrier
  s_add_u32 m0, s58, 0
  s_add_u32 s63, s61, 0
  buffer_load_dwordx4 v3, s[24:27], s63 offen sc1 lds
  s_add_u32 m0, s58, 8192
  s_add_u32 s63, s61, 2048
  buffer_load_dwordx4 v3, s[24:27], s63 offen sc1 lds
  s_add_u32 m0, s58, 16384
  s_add_u32 s63, s61, 4096
  buffer_load_dwordx4 v3, s[24:27], s63 offen sc1 lds
  s_add_u32 m0, s58, 24576
  s_add_u32 s63, s61, 6144
  buffer_load_dwordx4 v3, s[24:27], s63 offen sc1 lds
  s_add_u32 m0, s58, 32768
  s_add_u32 s63, s61, 8192
  buffer_load_dwordx4 v3, s[24:27], s63 offen sc1 lds
  s_add_u32 m0, s58, 40960
  s_add_u32 s63, s61, 10240
  buffer_load_dwordx4 v3, s[24:27], s63 offen sc1 lds
  s_add_u32 m0, s58, 49152
  s_add_u32 s63, s61, 12288
  buffer_load_dwordx4 v3, s[24:27], s63 offen sc1 lds
  s_add_u32 m0, s58, 57344
  s_add_u32 s63, s61, 14336
  buffer_load_dwordx4 v3, s[24:27], s63 offen sc1 lds
  s_waitcnt vmcnt(6)
  s_barrier
  s_add_u32 m0, s58, 65536
  s_add_u32 s63, s61, 16384
  buffer_load_dwordx4 v3, s[24:27], s63 offen sc1 lds
  s_add_u32 m0, s58, 73728
  s_add_u32 s63, s61, 18432
  buffer_load_dwordx4 v3, s[24:27], s63 offen sc1 lds
  s_add_u32 m0, s58, 81920
  s_add_u32 s63, s61, 20480
  buffer_load_dwordx4 v3, s[24:27], s63 offen sc1 lds
  s_add_u32 m0, s58, 90112
  s_add_u32 s63, s61, 22528
  buffer_load_dwordx4 v3, s[24:27], s63 offen sc1 lds
  s_waitcnt vmcnt(8)
  s_barrier
  s_add_u32 m0, s58, 98304
  s_add_u32 s63, s61, 24576
  buffer_load_dwordx4 v3, s[24:27], s63 offen sc1 lds
  s_add_u32 m0, s58, 106496
  s_add_u32 s63, s61, 26624
  buffer_load_dwordx4 v3, s[24:27], s63 offen sc1 lds
  s_add_u32 m0, s58, 114688
  s_add_u32 s63, s61, 28672
  buffer_load_dwordx4 v3, s[24:27], s63 offen sc1 lds
  s_add_u32 m0, s58, 122880
  s_add_u32 s63, s61, 30720
  buffer_load_dwordx4 v3, s[24:27], s63 offen sc1 lds
  s_waitcnt vmcnt(10)
  s_barrier
  s_add_u32 m0, s58, 0
  s_add_u32 s63, s61, 32768
  buffer_load_dwordx4 v3, s[24:27], s63 offen sc1 lds
  s_add_u32 m0, s58, 8192
  s_add_u32 s63, s61, 34816
  buffer_load_dwordx4 v3, s[24:27], s63 offen sc1 lds
  s_waitcnt vmcnt(10)
  s_barrier
  s_add_u32 m0, s58, 16384
  s_add_u32 s63, s61, 36864
  buffer_load_dwordx4 v3, s[24:27], s63 offen sc1 lds
  s_add_u32 m0, s58, 24576
  s_add_u32 s63, s61, 38912
  buffer_load_dwordx4 v3, s[24:27], s63 offen sc1 lds
  s_waitcnt vmcnt(10)
  s_barrier
  s_add_u32 m0, s58, 32768
  s_add_u32 s63, s61, 40960
  buffer_load_dwordx4 v3, s[24:27], s63 offen sc1 lds
  s_add_u32 m0, s58, 40960
  s_add_u32 s63, s61, 43008
  buffer_load_dwordx4 v3, s[24:27], s63 offen sc1 lds
  s_waitcnt vmcnt(10)
  s_barrier
  s_add_u32 m0, s58, 49152
  s_add_u32 s63, s61, 45056
  buffer_load_dwordx4 v3, s[24:27], s63 offen sc1 lds
  s_add_u32 m0, s58, 57344
  s_add_u32 s63, s61, 47104
  buffer_load_dwordx4 v3, s[24:27], s63 offen sc1 lds
  s_waitcnt vmcnt(10)
  s_barrier
  s_add_u32 m0, s60, 65536
  s_add_u32 s63, s56, 786432
  buffer_load_dwordx4 v8, s[40:43], s63 offen lds
  s_add_u32 m0, s60, 69632
  s_add_u32 s63, s56, 802816
  buffer_load_dwordx4 v8, s[40:43], s63 offen lds
  s_add_u32 m0, s60, 73728
  s_add_u32 s63, s56, 819200
  buffer_load_dwordx4 v8, s[40:43], s63 offen lds
  s_add_u32 m0, s60, 77824
  s_add_u32 s63, s56, 835584
  buffer_load_dwordx4 v8, s[40:43], s63 offen lds
  s_waitcnt vmcnt(12)
  s_barrier
  s_add_u32 m0, s60, 81920
  s_add_u32 s63, s56, 851968
  buffer_load_dwordx4 v8, s[40:43], s63 offen lds
  s_add_u32 m0, s60, 86016
  s_add_u32 s63, s56, 868352
  buffer_load_dwordx4 v8, s[40:43], s63 offen lds
  s_add_u32 m0, s60, 90112
  s_add_u32 s63, s56, 884736
  buffer_load_dwordx4 v8, s[40:43], s63 offen lds
  s_add_u32 m0, s60, 94208
  s_add_u32 s63, s56, 901120
  buffer_load_dwordx4 v8, s[40:43], s63 offen lds
  s_waitcnt vmcnt(14)
  s_barrier
  s_add_u32 m0, s60, 98304
  s_add_u32 s63, s56, 917504
  buffer_load_dwordx4 v8, s[40:43], s63 offen lds
  s_add_u32 m0, s60, 102400
  s_add_u32 s63, s56, 933888
  buffer_load_dwordx4 v8, s[40:43], s63 offen lds
  s_add_u32 m0, s60, 106496
  s_add_u32 s63, s56, 950272
  buffer_load_dwordx4 v8, s[40:43], s63 offen lds
  s_add_u32 m0, s60, 110592
  s_add_u32 s63, s56, 966656
  buffer_load_dwordx4 v8, s[40:43], s63 offen lds
  s_waitcnt vmcnt(16)
  s_barrier
  s_add_u32 m0, s60, 114688
  s_add_u32 s63, s56, 983040
  buffer_load_dwordx4 v8, s[40:43], s63 offen lds
  s_add_u32 m0, s60, 118784
  s_add_u32 s63, s56, 999424
  buffer_load_dwordx4 v8, s[40:43], s63 offen lds
  s_add_u32 m0, s60, 122880
  s_add_u32 s63, s56, 1015808
  buffer_load_dwordx4 v8, s[40:43], s63 offen lds
  s_add_u32 m0, s60, 126976
  s_add_u32 s63, s56, 1032192
  buffer_load_dwordx4 v8, s[40:43], s63 offen lds
  s_waitcnt vmcnt(18)
  s_barrier
  s_add_u32 m0, s60, 0
  s_add_u32 s63, s56, 1048576
  buffer_load_dwordx4 v8, s[40:43], s63 offen lds
  s_add_u32 m0, s60, 4096
  s_add_u32 s63, s56, 1064960
  buffer_load_dwordx4 v8, s[40:43], s63 offen lds
  s_add_u32 m0, s60, 8192
  s_add_u32 s63, s56, 1081344
  buffer_load_dwordx4 v8, s[40:43], s63 offen lds
  s_add_u32 m0, s60, 12288
  s_add_u32 s63, s56, 1097728
  buffer_load_dwordx4 v8, s[40:43], s63 offen lds
  s_waitcnt vmcnt(20)
  s_barrier
  s_add_u32 m0, s60, 16384
  s_add_u32 s63, s56, 1114112
  buffer_load_dwordx4 v8, s[40:43], s63 offen lds
  s_add_u32 m0, s60, 20480
  s_add_u32 s63, s56, 1130496
  buffer_load_dwordx4 v8, s[40:43], s63 offen lds
  s_add_u32 m0, s60, 24576
  s_add_u32 s63, s56, 1146880
  buffer_load_dwordx4 v8, s[40:43], s63 offen lds
  s_add_u32 m0, s60, 28672
  s_add_u32 s63, s56, 1163264
  buffer_load_dwordx4 v8, s[40:43], s63 offen lds
  s_waitcnt vmcnt(20)
  s_barrier
  s_add_u32 m0, s60, 32768
  s_add_u32 s63, s56, 1179648
  buffer_load_dwordx4 v8, s[40:43], s63 offen lds
  s_add_u32 m0, s60, 36864
  s_add_u32 s63, s56, 1196032
  buffer_load_dwordx4 v8, s[40:43], s63 offen lds
  s_add_u32 m0, s60, 40960
  s_add_u32 s63, s56, 1212416
  buffer_load_dwordx4 v8, s[40:43], s63 offen lds
  s_add_u32 m0, s60, 45056
  s_add_u32 s63, s56, 1228800
  buffer_load_dwordx4 v8, s[40:43], s63 offen lds
  s_waitcnt vmcnt(20)
  s_barrier
  s_add_u32 m0, s60, 49152
  s_add_u32 s63, s56, 1245184
  buffer_load_dwordx4 v8, s[40:43], s63 offen lds
  s_add_u32 m0, s60, 53248
  s_add_u32 s63, s56, 1261568
  buffer_load_dwordx4 v8, s[40:43], s63 offen lds
  s_add_u32 m0, s60, 57344
  s_add_u32 s63, s56, 1277952
  buffer_load_dwordx4 v8, s[40:43], s63 offen lds
  s_add_u32 m0, s60, 61440
  s_add_u32 s63, s56, 1294336
  buffer_load_dwordx4 v8, s[40:43], s63 offen lds
  s_waitcnt vmcnt(20)
  s_barrier
  s_add_u32 m0, s60, 65536
  s_add_u32 s63, s56, 1310720
  buffer_load_dwordx4 v8, s[40:43], s63 offen lds
  s_add_u32 m0, s60, 69632
  s_add_u32 s63, s56, 1327104
  buffer_load_dwordx4 v8, s[40:43], s63 offen lds
  s_add_u32 m0, s60, 73728
  s_add_u32 s63, s56, 1343488
  buffer_load_dwordx4 v8, s[40:43], s63 offen lds
  s_add_u32 m0, s60, 77824
  s_add_u32 s63, s56, 1359872
  buffer_load_dwordx4 v8, s[40:43], s63 offen lds
  s_waitcnt vmcnt(20)
  s_barrier
  s_add_u32 m0, s60, 81920
  s_add_u32 s63, s56, 1376256
  buffer_load_dwordx4 v8, s[40:43], s63 offen lds
  s_add_u32 m0, s60, 86016
  s_add_u32 s63, s56, 1392640
  buffer_load_dwordx4 v8, s[40:43], s63 offen lds
  s_waitcnt vmcnt(18)
  s_barrier
  s_waitcnt vmcnt(14)
  s_barrier
  s_waitcnt vmcnt(10)
  s_barrier
  s_waitcnt vmcnt(6)
  s_barrier
  s_waitcnt vmcnt(2)
  s_barrier
  s_waitcnt vmcnt(0)
  s_barrier
  s_branch L_p5_fin
L_p5_epi:
  s_waitcnt vmcnt(0) lgkmcnt(0)
  s_mov_b32 s12, s10
  s_and_b32 s13, s11, 0xffff
  s_mov_b32 s14, 0x200000
  s_mov_b32 s15, 0x20000
  v_and_b32 v8, 31, v2
  v_lshlrev_b32 v8, 10, v8
  v_lshl_add_u32 v8, v31, 4, v8
  s_lshl_b32 s53, s54, 15
  s_lshl_b32 s52, s57, 6
  s_add_u32 s53, s53, s52
  v_add_u32 v8, s53, v8
  v_lshlrev_b32 v32, 16, v160
  v_and_b32 v33, 0xffff0000, v160
  v_lshlrev_b32 v34, 16, v161
  v_and_b32 v35, 0xffff0000, v161
  v_lshlrev_b32 v36, 16, v162
  v_and_b32 v37, 0xffff0000, v162
  v_lshlrev_b32 v38, 16, v163
  v_and_b32 v39, 0xffff0000, v163
  v_lshlrev_b32 v40, 16, v164
  v_and_b32 v41, 0xffff0000, v164
  v_lshlrev_b32 v42, 16, v165
  v_and_b32 v43, 0xffff0000, v165
  v_lshlrev_b32 v44, 16, v166
  v_and_b32 v45, 0xffff0000, v166
  v_lshlrev_b32 v46, 16, v167
  v_and_b32 v47, 0xffff0000, v167
  v_fmac_f32 v32, v128, v64
  v_fmac_f32 v33, v129, v65
  v_fmac_f32 v34, v130, v66
  v_fmac_f32 v35, v131, v67
  v_fmac_f32 v36, v132, v68
  v_fmac_f32 v37, v133, v69
  v_fmac_f32 v38, v134, v70
  v_fmac_f32 v39, v135, v71
  v_fmac_f32 v40, v136, v72
  v_fmac_f32 v41, v137, v73
  v_fmac_f32 v42, v138, v74
  v_fmac_f32 v43, v139, v75
  v_fmac_f32 v44, v140, v76
  v_fmac_f32 v45, v141, v77
  v_fmac_f32 v46, v142, v78
  v_fmac_f32 v47, v143, v79
  v_cvt_pk_bf16_f32 v170, v32, v33
  v_cvt_pk_bf16_f32 v171, v34, v35
  v_cvt_pk_bf16_f32 v172, v36, v37
  v_cvt_pk_bf16_f32 v173, v38, v39
  v_cvt_pk_bf16_f32 v174, v40, v41
  v_cvt_pk_bf16_f32 v175, v42, v43
  v_cvt_pk_bf16_f32 v176, v44, v45
  v_cvt_pk_bf16_f32 v177, v46, v47
  s_nop 1
  v_permlane32_swap_b32 v170, v172
  v_permlane32_swap_b32 v171, v173
  v_permlane32_swap_b32 v174, v176
  v_permlane32_swap_b32 v175, v177
  buffer_store_dwordx4 v[170:173], v8, s[12:15], 0 offen
  buffer_store_dwordx4 v[174:177], v8, s[12:15], 0 offen offset:32
L_p5_fin:
L_end:
  s_endpgm
.section .rodata,"a"
.p2align 6
.amdhsa_kernel mega_kernel
  .amdhsa_next_free_vgpr 256
  .amdhsa_next_free_sgpr 74
  .amdhsa_accum_offset 256
  .amdhsa_group_segment_fixed_size 0
  .amdhsa_kernarg_size 96
  .amdhsa_user_sgpr_count 2
  .amdhsa_user_sgpr_kernarg_segment_ptr 1
  .amdhsa_system_sgpr_workgroup_id_x 1
  .amdhsa_float_denorm_mode_32 3
.end_amdhsa_kernel
.text
L_text_end:
  s_endpgm
```
